```python
import torch

def _softmax(x, axis=-1):
    return torch.softmax(x, dim=axis)
def _gelu(x):
    return torch.nn.functional.gelu(x, approximate="tanh")
def _silu(x):
    return torch.nn.functional.silu(x)
def _sigmoid(x):
    return torch.sigmoid(x)
def _layernorm(x, axis=-1, eps=1e-5):
    m = x.mean(dim=axis, keepdim=True)
    v = x.var(dim=axis, keepdim=True, unbiased=False)
    return (x - m) / torch.sqrt(v + eps)
def _scatter_add(tgt, idx, src, axis=0):
    return tgt.clone().index_add_(axis, idx, src)
def _segment_sum(src, seg, n):
    out = torch.zeros((n,) + src.shape[1:], dtype=src.dtype)
    return out.index_add_(0, seg, src)
def _pad(x, pw):
    flat = tuple(v for pair in reversed(pw) for v in pair)
    return torch.nn.functional.pad(x, flat)

kernel_name = 'parallel_sum__mha_block__glu_gated_geglu__prompt'

def setup_inputs():

    _w = (lambda a: (lambda t: t.to(torch.bfloat16) if t.is_floating_point() else t)(torch.as_tensor(a)))
    def _A_setup():
        B, S, D, H = 1, 2048, 448, 16
        return {
            "x": _w((lambda *s: torch.randn(*s, dtype=torch.bfloat16) * 0.05)(B, S, D)),
            "wqkv": _w((lambda *s: torch.randn(*s, dtype=torch.bfloat16) * 0.05)(D, 3 * D)),
            "wo": _w((lambda *s: torch.randn(*s, dtype=torch.bfloat16) * 0.05)(D, D)),
        }
    _A_in = _A_setup()

    def _B_setup():
        B, S, Dm, Df = 1, 2048, 448, 1792
        return {
            "x": _w((lambda *s: torch.randn(*s, dtype=torch.bfloat16) * 0.05)(B, S, Dm)),
            "w_gate": _w((lambda *s: torch.randn(*s, dtype=torch.bfloat16) * 0.4)(Dm, Df) * (Dm ** -0.5)),
            "w_up": _w((lambda *s: torch.randn(*s, dtype=torch.bfloat16) * 0.4)(Dm, Df) * (Dm ** -0.5)),
            "w_down": _w((lambda *s: torch.randn(*s, dtype=torch.bfloat16) * 0.4)(Df, Dm) * (Df ** -0.5)),
        }
    _B_in = _B_setup()

    return {
        "A_x": _A_in["x"],
        "A_wqkv": _A_in["wqkv"],
        "A_wo": _A_in["wo"],
        "B_x": _B_in["x"],
        "B_w_gate": _B_in["w_gate"],
        "B_w_up": _B_in["w_up"],
        "B_w_down": _B_in["w_down"],
    }

def reference(A_x, A_wqkv, A_wo, B_x, B_w_gate, B_w_up, B_w_down):
    def _A_ref(x, wqkv, wo):
        B, S, D = x.shape
        H = 16
        Dh = D // H
        qkv = (lambda x, *d: x.permute(*d))((x @ wqkv).reshape(B, S, 3, H, Dh), 2, 0, 3, 1, 4)
        q, k, v = qkv[0], qkv[1], qkv[2]
        scores = torch.einsum("bhqd,bhkd->bhqk", q, k) * (Dh ** -0.5)
        p = _softmax(scores, axis=-1)
        o = torch.einsum("bhqk,bhkd->bhqd", p, v)
        return (lambda x, *d: x.permute(*d))(o, 0, 2, 1, 3).reshape(B, S, D) @ wo

    def _B_ref(x, w_gate, w_up, w_down):
        g = torch.einsum("bsd,df->bsf", x, w_gate)
        u = torch.einsum("bsd,df->bsf", x, w_up)
        h = _gelu(g) * u
        return torch.einsum("bsf,fd->bsd", h, w_down)

    x = A_x
    xn = _layernorm(x, axis=-1)
    return x + _A_ref(xn, A_wqkv, A_wo) + _B_ref(xn, B_w_gate, B_w_up, B_w_down)
```

```asm
; @launch grid=(256,1,1) block=(512,1,1) lds=163840
.amdgcn_target "amdgcn-amd-amdhsa--gfx950"
.text
.globl parallel_sum__mha_block__glu_gated_geglu__prompt_kernel
.p2align 8
.type parallel_sum__mha_block__glu_gated_geglu__prompt_kernel,@function
parallel_sum__mha_block__glu_gated_geglu__prompt_kernel:
  s_cmp_ge_u32 s2, 256
  s_cbranch_scc1 L_end
  s_load_dwordx16 s[4:19], s[0:1], 0
  s_load_dwordx4 s[20:23], s[0:1], 64
  s_memrealtime s[48:49]
  v_lshrrev_b32 v1, 6, v0
  s_nop 0
  v_readfirstlane_b32 s3, v1
  v_and_b32 v0, 63, v0
  v_lshlrev_b32 v15, 4, v0
  s_getpc_b64 s[44:45]
L_pcbase:
  s_mov_b32 s46, L_code_end-L_pcbase
  s_mov_b32 s47, 0x00020000
  s_and_b32 s57, s2, 0x38
  s_add_u32 s57, s57, s3
  s_lshl_b32 s57, s57, 10
  buffer_load_dwordx4 v[204:207], v15, s[44:47], s57 offen
  s_and_b32 s54, s2, 1
  s_lshl_b32 s54, s54, 3
  s_bfe_u32 s74, s2, 0x30003
  s_add_u32 s74, s74, s54
  s_lshr_b32 s55, s2, 6
  s_lshr_b32 s53, s2, 7
  s_lshl_b32 s76, s55, 1
  s_add_u32 s76, s76, s74
  s_sub_u32 s54, s76, 14
  s_cmp_ge_u32 s76, 14
  s_cselect_b32 s76, s54, s76
  s_sub_u32 s54, s76, 7
  s_cmp_ge_u32 s76, 7
  s_cselect_b32 s76, s54, s76
  s_and_b32 s75, s2, 6
  s_and_b32 s55, s55, 1
  s_add_u32 s75, s75, s55
  v_lshrrev_b32 v232, 3, v0
  v_and_b32 v233, 7, v0
  v_mul_u32_u24 v1, 896, v232
  v_lshl_add_u32 v1, v233, 4, v1
  s_lshl_b32 s54, s74, 3
  s_add_u32 s54, s54, s3
  s_mul_i32 s54, s54, 14336
  v_add_u32 v1, s54, v1
  v_add_u32 v199, 7168, v1
  s_lshl_b32 s67, s76, 7
  s_add_u32 s68, s67, 128
  s_cmp_eq_u32 s68, 896
  s_cselect_b32 s68, 0, s68
  s_add_u32 s69, s68, 128
  s_cmp_eq_u32 s69, 896
  s_cselect_b32 s69, 0, s69
  s_add_u32 s70, s69, 128
  s_cmp_eq_u32 s70, 896
  s_cselect_b32 s70, 0, s70
  s_add_u32 s71, s70, 128
  s_cmp_eq_u32 s71, 896
  s_cselect_b32 s71, 0, s71
  s_add_u32 s72, s71, 128
  s_cmp_eq_u32 s72, 896
  s_cselect_b32 s72, 0, s72
  s_add_u32 s73, s72, 128
  s_cmp_eq_u32 s73, 896
  s_cselect_b32 s73, 0, s73
  s_lshr_b32 s52, s3, 2
  s_and_b32 s77, s3, 3
  s_waitcnt lgkmcnt(0)
  s_mov_b32 s24, s4
  s_mov_b32 s25, s5
  s_mov_b32 s26, 1835008
  s_mov_b32 s27, 0x00020000
  buffer_load_dwordx4 v[128:131], v1, s[24:27], s67 offen
  buffer_load_dwordx4 v[132:135], v1, s[24:27], s68 offen
  buffer_load_dwordx4 v[136:139], v1, s[24:27], s69 offen
  buffer_load_dwordx4 v[140:143], v1, s[24:27], s70 offen
  buffer_load_dwordx4 v[144:147], v1, s[24:27], s71 offen
  buffer_load_dwordx4 v[148:151], v1, s[24:27], s72 offen
  buffer_load_dwordx4 v[152:155], v1, s[24:27], s73 offen
  s_mov_b32 s28, s6
  s_mov_b32 s29, s7
  s_mov_b32 s30, 1204224
  s_mov_b32 s31, 0x00020000
  s_mul_i32 s54, s75, 112
  s_mul_i32 s55, s53, 896
  s_add_u32 s54, s54, s55
  s_add_u32 s28, s28, s54
  s_addc_u32 s29, s29, 0
  s_sub_u32 s30, s30, s54
  s_lshl_b32 s59, s3, 10
  s_lshl_b32 s54, s3, 4
  s_add_u32 s67, s67, s54
  s_mul_i32 s60, s67, 1344
  s_add_u32 s68, s68, s54
  s_mul_i32 s61, s68, 1344
  s_add_u32 s69, s69, s54
  s_mul_i32 s62, s69, 1344
  s_add_u32 s70, s70, s54
  s_mul_i32 s63, s70, 1344
  s_add_u32 s71, s71, s54
  s_mul_i32 s64, s71, 1344
  s_add_u32 s72, s72, s54
  s_mul_i32 s65, s72, 1344
  s_add_u32 s73, s73, s54
  s_mul_i32 s66, s73, 1344
  s_mov_b64 s[0:1], s[20:21]
  s_or_b32 s48, s48, 1
  v_mov_b32 v240, s48
  v_mov_b32 v241, s49
  v_mov_b32 v247, 0
  s_mov_b32 s36, s12
  s_mov_b32 s37, s13
  s_mov_b32 s38, 1605632
  s_mov_b32 s39, 0x00020000
  s_mov_b32 s40, s14
  s_mov_b32 s41, s15
  s_mov_b32 s42, 1605632
  s_mov_b32 s43, 0x00020000
  s_mov_b32 s32, s22
  s_mov_b32 s33, s23
  s_mov_b32 s34, 33554432
  s_mov_b32 s35, 0x00020000
  s_lshl_b32 s54, s75, 7
  s_lshl_b32 s55, s53, 10
  s_add_u32 s55, s55, s54
  s_lshl_b32 s56, s52, 1
  s_add_u32 s36, s36, s55
  s_addc_u32 s37, s37, 0
  s_sub_u32 s38, s38, s55
  s_add_u32 s40, s40, s55
  s_addc_u32 s41, s41, 0
  s_sub_u32 s42, s42, s55
  s_lshr_b32 s4, s55, 5
  s_add_u32 s4, s4, s56
  s_add_u32 s54, s54, 2048
  s_lshl_b32 s57, s75, 6
  s_add_u32 s57, s57, 3072
  s_cmp_eq_u32 s53, 0
  s_cselect_b32 s54, s54, s57
  s_cselect_b32 s56, s56, s52
  s_sub_u32 s6, s54, s55
  s_lshr_b32 s5, s54, 5
  s_add_u32 s5, s5, s56
  s_lshl_b32 s54, s3, 4
  v_subrev_u32 v199, s54, v199
  buffer_load_dwordx4 v[156:159], v199, s[24:27], s67 offen
  buffer_load_dwordx4 v[160:163], v199, s[24:27], s68 offen
  buffer_load_dwordx4 v[164:167], v199, s[24:27], s69 offen
  buffer_load_dwordx4 v[168:171], v199, s[24:27], s70 offen
  buffer_load_dwordx4 v[172:175], v199, s[24:27], s71 offen
  buffer_load_dwordx4 v[176:179], v199, s[24:27], s72 offen
  buffer_load_dwordx4 v[180:183], v199, s[24:27], s73 offen
  s_mul_i32 s67, s67, 1792
  s_mul_i32 s68, s68, 1792
  s_mul_i32 s69, s69, 1792
  s_mul_i32 s70, s70, 1792
  s_mul_i32 s71, s71, 1792
  s_mul_i32 s72, s72, 1792
  s_mul_i32 s73, s73, 1792
  v_lshlrev_b32 v235, 1, v232
  v_and_b32 v235, 4, v235
  v_xor_b32 v235, v235, v233
  v_lshlrev_b32 v235, 4, v235
  v_mul_u32_u24 v2, 2688, v232
  v_add_u32 v2, v2, v235
  v_mul_u32_u24 v3, 3584, v232
  v_add_u32 v3, v3, v235
  v_xor_b32 v4, 32, v3
  v_lshrrev_b32 v208, 5, v0
  v_bfe_u32 v209, v0, 4, 1
  v_bfe_u32 v210, v0, 2, 2
  v_and_b32 v211, 3, v0
  v_bfe_u32 v212, v0, 3, 1
  v_lshlrev_b32 v212, 6, v212
  s_mul_i32 s54, s52, 56
  v_lshl_add_u32 v213, v211, 3, s54
  v_lshl_add_u32 v213, v209, 5, v213
  v_xor_b32 v213, v213, v212
  v_lshl_add_u32 v213, v210, 7, v213
  v_lshl_add_u32 v5, v208, 10, v213
  s_lshl_b32 s54, s52, 6
  v_lshl_add_u32 v213, v211, 3, s54
  v_lshl_add_u32 v214, v209, 5, v212
  v_xor_b32 v213, v213, v214
  v_lshl_add_u32 v213, v210, 7, v213
  v_lshl_add_u32 v213, v208, 10, v213
  v_lshl_add_u32 v8, v209, 13, v213
  v_xor_b32 v11, 32, v8
  v_add_u32 v6, 0x10000, v5
  v_add_u32 v7, 0x20000, v5
  v_add_u32 v9, 0x10000, v8
  v_add_u32 v10, 0x20000, v8
  v_add_u32 v12, 0x10000, v11
  v_add_u32 v13, 0x20000, v11
  v_sub_u32 v253, 0, v208
  v_not_b32 v252, v253
  v_lshlrev_b32 v254, 6, v208
  v_xor_b32 v254, v254, v15
  v_xor_b32 v255, 128, v254
  s_lshl_b32 s54, s3, 11
  v_lshrrev_b32 v213, 1, v232
  v_xor_b32 v213, v213, v233
  v_lshl_add_u32 v214, v232, 7, s54
  v_lshl_add_u32 v16, v213, 4, v214
  v_xor_b32 v18, 64, v16
  v_add_u32 v18, 1024, v18
  v_add_u32 v17, 65536, v16
  v_add_u32 v19, 65536, v18
  v_and_b32 v213, 31, v0
  v_bfe_u32 v214, v0, 1, 3
  v_xor_b32 v214, v214, v208
  s_lshl_b32 s54, s77, 12
  v_lshl_add_u32 v236, v213, 7, s54
  v_lshl_add_u32 v236, v214, 4, v236
  v_xor_b32 v237, 32, v236
  v_xor_b32 v238, 64, v236
  v_xor_b32 v239, 96, v236
  s_lshl_b32 s54, s3, 6
  v_lshl_add_u32 v234, v232, 2, s54
  s_lshl_b32 s54, s77, 7
  v_lshl_add_u32 v246, v213, 2, s54
  s_mov_b32 s54, 0x3f803f80
  s_mov_b32 s55, 0x00003f80
  s_mov_b32 s56, 0x3f800000
  s_mov_b32 s44, s0
  s_mov_b32 s45, s1
  s_mov_b32 s46, 256
  s_mov_b32 s47, 0x00020000
  s_or_b32 s57, s2, s3
  s_min_u32 s57, s57, 1
  s_lshl_b32 s57, s57, 12
  buffer_store_dwordx2 v[240:241], v247, s[44:47], s57 offen sc1
  v_mov_b32 v20, 0
  v_mov_b32 v21, 0
  s_waitcnt vmcnt(14)
  v_dot2c_f32_bf16 v20, s54, v128
  v_dot2c_f32_bf16 v21, v128, v128
  v_dot2c_f32_bf16 v20, s54, v129
  v_dot2c_f32_bf16 v21, v129, v129
  v_dot2c_f32_bf16 v20, s54, v130
  v_dot2c_f32_bf16 v21, v130, v130
  v_dot2c_f32_bf16 v20, s54, v131
  v_dot2c_f32_bf16 v21, v131, v131
  s_waitcnt vmcnt(13)
  v_dot2c_f32_bf16 v20, s54, v132
  v_dot2c_f32_bf16 v21, v132, v132
  v_dot2c_f32_bf16 v20, s54, v133
  v_dot2c_f32_bf16 v21, v133, v133
  v_dot2c_f32_bf16 v20, s54, v134
  v_dot2c_f32_bf16 v21, v134, v134
  v_dot2c_f32_bf16 v20, s54, v135
  v_dot2c_f32_bf16 v21, v135, v135
  s_waitcnt vmcnt(12)
  v_dot2c_f32_bf16 v20, s54, v136
  v_dot2c_f32_bf16 v21, v136, v136
  v_dot2c_f32_bf16 v20, s54, v137
  v_dot2c_f32_bf16 v21, v137, v137
  v_dot2c_f32_bf16 v20, s54, v138
  v_dot2c_f32_bf16 v21, v138, v138
  v_dot2c_f32_bf16 v20, s54, v139
  v_dot2c_f32_bf16 v21, v139, v139
  s_waitcnt vmcnt(11)
  v_dot2c_f32_bf16 v20, s54, v140
  v_dot2c_f32_bf16 v21, v140, v140
  v_dot2c_f32_bf16 v20, s54, v141
  v_dot2c_f32_bf16 v21, v141, v141
  v_dot2c_f32_bf16 v20, s54, v142
  v_dot2c_f32_bf16 v21, v142, v142
  v_dot2c_f32_bf16 v20, s54, v143
  v_dot2c_f32_bf16 v21, v143, v143
  s_waitcnt vmcnt(10)
  v_dot2c_f32_bf16 v20, s54, v144
  v_dot2c_f32_bf16 v21, v144, v144
  v_dot2c_f32_bf16 v20, s54, v145
  v_dot2c_f32_bf16 v21, v145, v145
  v_dot2c_f32_bf16 v20, s54, v146
  v_dot2c_f32_bf16 v21, v146, v146
  v_dot2c_f32_bf16 v20, s54, v147
  v_dot2c_f32_bf16 v21, v147, v147
  s_waitcnt vmcnt(9)
  v_dot2c_f32_bf16 v20, s54, v148
  v_dot2c_f32_bf16 v21, v148, v148
  v_dot2c_f32_bf16 v20, s54, v149
  v_dot2c_f32_bf16 v21, v149, v149
  v_dot2c_f32_bf16 v20, s54, v150
  v_dot2c_f32_bf16 v21, v150, v150
  v_dot2c_f32_bf16 v20, s54, v151
  v_dot2c_f32_bf16 v21, v151, v151
  s_waitcnt vmcnt(8)
  v_dot2c_f32_bf16 v20, s54, v152
  v_dot2c_f32_bf16 v21, v152, v152
  v_dot2c_f32_bf16 v20, s54, v153
  v_dot2c_f32_bf16 v21, v153, v153
  v_dot2c_f32_bf16 v20, s54, v154
  v_dot2c_f32_bf16 v21, v154, v154
  v_dot2c_f32_bf16 v20, s54, v155
  v_dot2c_f32_bf16 v21, v155, v155
  s_nop 1
  v_add_f32_dpp v20, v20, v20 quad_perm:[1,0,3,2] row_mask:0xf bank_mask:0xf
  v_add_f32_dpp v21, v21, v21 quad_perm:[1,0,3,2] row_mask:0xf bank_mask:0xf
  s_nop 0
  v_add_f32_dpp v20, v20, v20 quad_perm:[2,3,0,1] row_mask:0xf bank_mask:0xf
  v_add_f32_dpp v21, v21, v21 quad_perm:[2,3,0,1] row_mask:0xf bank_mask:0xf
  s_nop 0
  v_add_f32_dpp v20, v20, v20 row_half_mirror row_mask:0xf bank_mask:0xf
  v_add_f32_dpp v21, v21, v21 row_half_mirror row_mask:0xf bank_mask:0xf
  v_mul_f32 v22, 3138537765, v20
  v_mul_f32 v21, 991054117, v21
  v_fma_f32 v21, -v22, v22, v21
  v_max_f32 v21, 0, v21
  v_add_f32 v235, 925353388, v21
  v_dot2_f32_bf16 v24, v128, s55, v22
  v_dot2_f32_bf16 v28, v128, s56, v22
  v_dot2_f32_bf16 v25, v129, s55, v22
  v_dot2_f32_bf16 v29, v129, s56, v22
  v_dot2_f32_bf16 v26, v130, s55, v22
  v_dot2_f32_bf16 v30, v130, s56, v22
  v_dot2_f32_bf16 v27, v131, s55, v22
  v_dot2_f32_bf16 v31, v131, s56, v22
  v_cvt_pk_bf16_f32 v128, v24, v28
  v_cvt_pk_bf16_f32 v129, v25, v29
  v_cvt_pk_bf16_f32 v130, v26, v30
  v_cvt_pk_bf16_f32 v131, v27, v31
  ds_write_b128 v16, v[128:131] offset:0
  s_add_u32 m0, s59, 114688
  s_nop 0
  buffer_load_dwordx4 v2, s[28:31], s60 offen lds
  v_dot2_f32_bf16 v24, v132, s55, v22
  v_dot2_f32_bf16 v28, v132, s56, v22
  v_dot2_f32_bf16 v25, v133, s55, v22
  v_dot2_f32_bf16 v29, v133, s56, v22
  v_dot2_f32_bf16 v26, v134, s55, v22
  v_dot2_f32_bf16 v30, v134, s56, v22
  v_dot2_f32_bf16 v27, v135, s55, v22
  v_dot2_f32_bf16 v31, v135, s56, v22
  v_cvt_pk_bf16_f32 v132, v24, v28
  v_cvt_pk_bf16_f32 v133, v25, v29
  v_cvt_pk_bf16_f32 v134, v26, v30
  v_cvt_pk_bf16_f32 v135, v27, v31
  ds_write_b128 v16, v[132:135] offset:16384
  s_add_u32 m0, s59, 122880
  s_nop 0
  buffer_load_dwordx4 v2, s[28:31], s61 offen lds
  v_dot2_f32_bf16 v24, v136, s55, v22
  v_dot2_f32_bf16 v28, v136, s56, v22
  v_dot2_f32_bf16 v25, v137, s55, v22
  v_dot2_f32_bf16 v29, v137, s56, v22
  v_dot2_f32_bf16 v26, v138, s55, v22
  v_dot2_f32_bf16 v30, v138, s56, v22
  v_dot2_f32_bf16 v27, v139, s55, v22
  v_dot2_f32_bf16 v31, v139, s56, v22
  v_cvt_pk_bf16_f32 v136, v24, v28
  v_cvt_pk_bf16_f32 v137, v25, v29
  v_cvt_pk_bf16_f32 v138, v26, v30
  v_cvt_pk_bf16_f32 v139, v27, v31
  ds_write_b128 v16, v[136:139] offset:32768
  s_add_u32 m0, s59, 131072
  s_nop 0
  buffer_load_dwordx4 v2, s[28:31], s62 offen lds
  v_dot2_f32_bf16 v24, v140, s55, v22
  v_dot2_f32_bf16 v28, v140, s56, v22
  v_dot2_f32_bf16 v25, v141, s55, v22
  v_dot2_f32_bf16 v29, v141, s56, v22
  v_dot2_f32_bf16 v26, v142, s55, v22
  v_dot2_f32_bf16 v30, v142, s56, v22
  v_dot2_f32_bf16 v27, v143, s55, v22
  v_dot2_f32_bf16 v31, v143, s56, v22
  v_cvt_pk_bf16_f32 v140, v24, v28
  v_cvt_pk_bf16_f32 v141, v25, v29
  v_cvt_pk_bf16_f32 v142, v26, v30
  v_cvt_pk_bf16_f32 v143, v27, v31
  ds_write_b128 v16, v[140:143] offset:49152
  s_add_u32 m0, s59, 139264
  s_nop 0
  buffer_load_dwordx4 v2, s[28:31], s63 offen lds
  v_dot2_f32_bf16 v24, v144, s55, v22
  v_dot2_f32_bf16 v28, v144, s56, v22
  v_dot2_f32_bf16 v25, v145, s55, v22
  v_dot2_f32_bf16 v29, v145, s56, v22
  v_dot2_f32_bf16 v26, v146, s55, v22
  v_dot2_f32_bf16 v30, v146, s56, v22
  v_dot2_f32_bf16 v27, v147, s55, v22
  v_dot2_f32_bf16 v31, v147, s56, v22
  v_cvt_pk_bf16_f32 v144, v24, v28
  v_cvt_pk_bf16_f32 v145, v25, v29
  v_cvt_pk_bf16_f32 v146, v26, v30
  v_cvt_pk_bf16_f32 v147, v27, v31
  ds_write_b128 v17, v[144:147] offset:0
  s_add_u32 m0, s59, 147456
  s_nop 0
  buffer_load_dwordx4 v2, s[28:31], s64 offen lds
  v_dot2_f32_bf16 v24, v148, s55, v22
  v_dot2_f32_bf16 v28, v148, s56, v22
  v_dot2_f32_bf16 v25, v149, s55, v22
  v_dot2_f32_bf16 v29, v149, s56, v22
  v_dot2_f32_bf16 v26, v150, s55, v22
  v_dot2_f32_bf16 v30, v150, s56, v22
  v_dot2_f32_bf16 v27, v151, s55, v22
  v_dot2_f32_bf16 v31, v151, s56, v22
  v_cvt_pk_bf16_f32 v148, v24, v28
  v_cvt_pk_bf16_f32 v149, v25, v29
  v_cvt_pk_bf16_f32 v150, v26, v30
  v_cvt_pk_bf16_f32 v151, v27, v31
  ds_write_b128 v17, v[148:151] offset:16384
  s_add_u32 m0, s59, 155648
  s_nop 0
  buffer_load_dwordx4 v2, s[28:31], s65 offen lds
  v_dot2_f32_bf16 v24, v152, s55, v22
  v_dot2_f32_bf16 v28, v152, s56, v22
  v_dot2_f32_bf16 v25, v153, s55, v22
  v_dot2_f32_bf16 v29, v153, s56, v22
  v_dot2_f32_bf16 v26, v154, s55, v22
  v_dot2_f32_bf16 v30, v154, s56, v22
  v_dot2_f32_bf16 v27, v155, s55, v22
  v_dot2_f32_bf16 v31, v155, s56, v22
  v_cvt_pk_bf16_f32 v152, v24, v28
  v_cvt_pk_bf16_f32 v153, v25, v29
  v_cvt_pk_bf16_f32 v154, v26, v30
  v_cvt_pk_bf16_f32 v155, v27, v31
  ds_write_b128 v17, v[152:155] offset:32768
  v_mov_b32 v20, 0
  v_mov_b32 v21, 0
  s_waitcnt vmcnt(13)
  v_dot2c_f32_bf16 v20, s54, v156
  v_dot2c_f32_bf16 v21, v156, v156
  v_dot2c_f32_bf16 v20, s54, v157
  v_dot2c_f32_bf16 v21, v157, v157
  v_dot2c_f32_bf16 v20, s54, v158
  v_dot2c_f32_bf16 v21, v158, v158
  v_dot2c_f32_bf16 v20, s54, v159
  v_dot2c_f32_bf16 v21, v159, v159
  s_waitcnt vmcnt(12)
  v_dot2c_f32_bf16 v20, s54, v160
  v_dot2c_f32_bf16 v21, v160, v160
  v_dot2c_f32_bf16 v20, s54, v161
  v_dot2c_f32_bf16 v21, v161, v161
  v_dot2c_f32_bf16 v20, s54, v162
  v_dot2c_f32_bf16 v21, v162, v162
  v_dot2c_f32_bf16 v20, s54, v163
  v_dot2c_f32_bf16 v21, v163, v163
  s_waitcnt vmcnt(11)
  v_dot2c_f32_bf16 v20, s54, v164
  v_dot2c_f32_bf16 v21, v164, v164
  v_dot2c_f32_bf16 v20, s54, v165
  v_dot2c_f32_bf16 v21, v165, v165
  v_dot2c_f32_bf16 v20, s54, v166
  v_dot2c_f32_bf16 v21, v166, v166
  v_dot2c_f32_bf16 v20, s54, v167
  v_dot2c_f32_bf16 v21, v167, v167
  s_waitcnt vmcnt(10)
  v_dot2c_f32_bf16 v20, s54, v168
  v_dot2c_f32_bf16 v21, v168, v168
  v_dot2c_f32_bf16 v20, s54, v169
  v_dot2c_f32_bf16 v21, v169, v169
  v_dot2c_f32_bf16 v20, s54, v170
  v_dot2c_f32_bf16 v21, v170, v170
  v_dot2c_f32_bf16 v20, s54, v171
  v_dot2c_f32_bf16 v21, v171, v171
  s_waitcnt vmcnt(9)
  v_dot2c_f32_bf16 v20, s54, v172
  v_dot2c_f32_bf16 v21, v172, v172
  v_dot2c_f32_bf16 v20, s54, v173
  v_dot2c_f32_bf16 v21, v173, v173
  v_dot2c_f32_bf16 v20, s54, v174
  v_dot2c_f32_bf16 v21, v174, v174
  v_dot2c_f32_bf16 v20, s54, v175
  v_dot2c_f32_bf16 v21, v175, v175
  s_waitcnt vmcnt(8)
  v_dot2c_f32_bf16 v20, s54, v176
  v_dot2c_f32_bf16 v21, v176, v176
  v_dot2c_f32_bf16 v20, s54, v177
  v_dot2c_f32_bf16 v21, v177, v177
  v_dot2c_f32_bf16 v20, s54, v178
  v_dot2c_f32_bf16 v21, v178, v178
  v_dot2c_f32_bf16 v20, s54, v179
  v_dot2c_f32_bf16 v21, v179, v179
  s_waitcnt vmcnt(7)
  v_dot2c_f32_bf16 v20, s54, v180
  v_dot2c_f32_bf16 v21, v180, v180
  v_dot2c_f32_bf16 v20, s54, v181
  v_dot2c_f32_bf16 v21, v181, v181
  v_dot2c_f32_bf16 v20, s54, v182
  v_dot2c_f32_bf16 v21, v182, v182
  v_dot2c_f32_bf16 v20, s54, v183
  v_dot2c_f32_bf16 v21, v183, v183
  s_nop 1
  v_add_f32_dpp v20, v20, v20 quad_perm:[1,0,3,2] row_mask:0xf bank_mask:0xf
  v_add_f32_dpp v21, v21, v21 quad_perm:[1,0,3,2] row_mask:0xf bank_mask:0xf
  s_nop 0
  v_add_f32_dpp v20, v20, v20 quad_perm:[2,3,0,1] row_mask:0xf bank_mask:0xf
  v_add_f32_dpp v21, v21, v21 quad_perm:[2,3,0,1] row_mask:0xf bank_mask:0xf
  s_nop 0
  v_add_f32_dpp v20, v20, v20 row_half_mirror row_mask:0xf bank_mask:0xf
  v_add_f32_dpp v21, v21, v21 row_half_mirror row_mask:0xf bank_mask:0xf
  v_mul_f32 v22, 3138537765, v20
  v_mul_f32 v21, 991054117, v21
  v_fma_f32 v21, -v22, v22, v21
  v_max_f32 v21, 0, v21
  v_add_f32 v244, 925353388, v21
  v_dot2_f32_bf16 v24, v156, s55, v22
  v_dot2_f32_bf16 v28, v156, s56, v22
  v_dot2_f32_bf16 v25, v157, s55, v22
  v_dot2_f32_bf16 v29, v157, s56, v22
  v_dot2_f32_bf16 v26, v158, s55, v22
  v_dot2_f32_bf16 v30, v158, s56, v22
  v_dot2_f32_bf16 v27, v159, s55, v22
  v_dot2_f32_bf16 v31, v159, s56, v22
  v_cvt_pk_bf16_f32 v156, v24, v28
  v_cvt_pk_bf16_f32 v157, v25, v29
  v_cvt_pk_bf16_f32 v158, v26, v30
  v_cvt_pk_bf16_f32 v159, v27, v31
  ds_write_b128 v18, v[156:159] offset:0
  v_dot2_f32_bf16 v24, v160, s55, v22
  v_dot2_f32_bf16 v28, v160, s56, v22
  v_dot2_f32_bf16 v25, v161, s55, v22
  v_dot2_f32_bf16 v29, v161, s56, v22
  v_dot2_f32_bf16 v26, v162, s55, v22
  v_dot2_f32_bf16 v30, v162, s56, v22
  v_dot2_f32_bf16 v27, v163, s55, v22
  v_dot2_f32_bf16 v31, v163, s56, v22
  v_cvt_pk_bf16_f32 v160, v24, v28
  v_cvt_pk_bf16_f32 v161, v25, v29
  v_cvt_pk_bf16_f32 v162, v26, v30
  v_cvt_pk_bf16_f32 v163, v27, v31
  ds_write_b128 v18, v[160:163] offset:16384
  v_dot2_f32_bf16 v24, v164, s55, v22
  v_dot2_f32_bf16 v28, v164, s56, v22
  v_dot2_f32_bf16 v25, v165, s55, v22
  v_dot2_f32_bf16 v29, v165, s56, v22
  v_dot2_f32_bf16 v26, v166, s55, v22
  v_dot2_f32_bf16 v30, v166, s56, v22
  v_dot2_f32_bf16 v27, v167, s55, v22
  v_dot2_f32_bf16 v31, v167, s56, v22
  v_cvt_pk_bf16_f32 v164, v24, v28
  v_cvt_pk_bf16_f32 v165, v25, v29
  v_cvt_pk_bf16_f32 v166, v26, v30
  v_cvt_pk_bf16_f32 v167, v27, v31
  ds_write_b128 v18, v[164:167] offset:32768
  v_dot2_f32_bf16 v24, v168, s55, v22
  v_dot2_f32_bf16 v28, v168, s56, v22
  v_dot2_f32_bf16 v25, v169, s55, v22
  v_dot2_f32_bf16 v29, v169, s56, v22
  v_dot2_f32_bf16 v26, v170, s55, v22
  v_dot2_f32_bf16 v30, v170, s56, v22
  v_dot2_f32_bf16 v27, v171, s55, v22
  v_dot2_f32_bf16 v31, v171, s56, v22
  v_cvt_pk_bf16_f32 v168, v24, v28
  v_cvt_pk_bf16_f32 v169, v25, v29
  v_cvt_pk_bf16_f32 v170, v26, v30
  v_cvt_pk_bf16_f32 v171, v27, v31
  ds_write_b128 v18, v[168:171] offset:49152
  v_dot2_f32_bf16 v24, v172, s55, v22
  v_dot2_f32_bf16 v28, v172, s56, v22
  v_dot2_f32_bf16 v25, v173, s55, v22
  v_dot2_f32_bf16 v29, v173, s56, v22
  v_dot2_f32_bf16 v26, v174, s55, v22
  v_dot2_f32_bf16 v30, v174, s56, v22
  v_dot2_f32_bf16 v27, v175, s55, v22
  v_dot2_f32_bf16 v31, v175, s56, v22
  v_cvt_pk_bf16_f32 v172, v24, v28
  v_cvt_pk_bf16_f32 v173, v25, v29
  v_cvt_pk_bf16_f32 v174, v26, v30
  v_cvt_pk_bf16_f32 v175, v27, v31
  ds_write_b128 v19, v[172:175] offset:0
  v_dot2_f32_bf16 v24, v176, s55, v22
  v_dot2_f32_bf16 v28, v176, s56, v22
  v_dot2_f32_bf16 v25, v177, s55, v22
  v_dot2_f32_bf16 v29, v177, s56, v22
  v_dot2_f32_bf16 v26, v178, s55, v22
  v_dot2_f32_bf16 v30, v178, s56, v22
  v_dot2_f32_bf16 v27, v179, s55, v22
  v_dot2_f32_bf16 v31, v179, s56, v22
  v_cvt_pk_bf16_f32 v176, v24, v28
  v_cvt_pk_bf16_f32 v177, v25, v29
  v_cvt_pk_bf16_f32 v178, v26, v30
  v_cvt_pk_bf16_f32 v179, v27, v31
  ds_write_b128 v19, v[176:179] offset:16384
  v_dot2_f32_bf16 v24, v180, s55, v22
  v_dot2_f32_bf16 v28, v180, s56, v22
  v_dot2_f32_bf16 v25, v181, s55, v22
  v_dot2_f32_bf16 v29, v181, s56, v22
  v_dot2_f32_bf16 v26, v182, s55, v22
  v_dot2_f32_bf16 v30, v182, s56, v22
  v_dot2_f32_bf16 v27, v183, s55, v22
  v_dot2_f32_bf16 v31, v183, s56, v22
  v_cvt_pk_bf16_f32 v180, v24, v28
  v_cvt_pk_bf16_f32 v181, v25, v29
  v_cvt_pk_bf16_f32 v182, v26, v30
  v_cvt_pk_bf16_f32 v183, v27, v31
  ds_write_b128 v19, v[180:183] offset:32768
  s_add_u32 s56, s67, s6
  s_mul_i32 s57, s53, 896
  s_add_u32 s57, s57, s60
  buffer_load_dword v200, v2, s[28:31], s57 offen
  buffer_load_dword v201, v3, s[36:39], s67 offen
  buffer_load_dword v202, v3, s[40:43], s67 offen
  buffer_load_dword v203, v3, s[36:39], s56 offen
  buffer_load_dword v199, v3, s[40:43], s56 offen
  s_waitcnt vmcnt(8)
  s_waitcnt lgkmcnt(0)
  s_barrier
  s_cmp_lg_u32 s53, 0
  s_cbranch_scc1 L_p1C
  ds_read_b128 v[16:19], v236 offset:0
  ds_read_b64_tr_b16 v[208:209], v6 offset:49152
  ds_read_b64_tr_b16 v[210:211], v6 offset:49664
  ds_read_b128 v[20:23], v237 offset:0
  ds_read_b64_tr_b16 v[212:213], v6 offset:51200
  ds_read_b64_tr_b16 v[214:215], v6 offset:51712
  ds_read_b128 v[24:27], v238 offset:0
  ds_read_b64_tr_b16 v[216:217], v6 offset:53248
  ds_read_b64_tr_b16 v[218:219], v6 offset:53760
  ds_read_b128 v[28:31], v239 offset:0
  ds_read_b64_tr_b16 v[220:221], v6 offset:55296
  ds_read_b64_tr_b16 v[222:223], v6 offset:55808
  ds_read_b128 v[32:35], v236 offset:16384
  ds_read_b128 v[36:39], v237 offset:16384
  ds_read_b128 v[40:43], v238 offset:16384
  ds_read_b128 v[44:47], v239 offset:16384
  s_setprio 3
  ds_read_b64_tr_b16 v[224:225], v6 offset:57344
  ds_read_b64_tr_b16 v[226:227], v6 offset:57856
  s_waitcnt lgkmcnt(15)
  v_mfma_f32_32x32x16_bf16 v[128:143], v[208:211], v[16:19], 0
  ds_read_b64_tr_b16 v[228:229], v6 offset:59392
  ds_read_b64_tr_b16 v[230:231], v6 offset:59904
  s_waitcnt lgkmcnt(14)
  v_mfma_f32_32x32x16_bf16 v[128:143], v[212:215], v[20:23], v[128:143]
  s_setprio 2
  ds_read_b64_tr_b16 v[208:209], v6 offset:61440
  ds_read_b64_tr_b16 v[210:211], v6 offset:61952
  s_waitcnt lgkmcnt(13)
  v_mfma_f32_32x32x16_bf16 v[128:143], v[216:219], v[24:27], v[128:143]
  s_waitcnt lgkmcnt(6)
  s_barrier
  ds_read_b64_tr_b16 v[212:213], v6 offset:63488
  ds_read_b64_tr_b16 v[214:215], v6 offset:64000
  ds_read_b128 v[48:51], v236 offset:32768
  ds_read_b128 v[52:55], v237 offset:32768
  ds_read_b128 v[56:59], v238 offset:32768
  v_mfma_f32_32x32x16_bf16 v[128:143], v[220:223], v[28:31], v[128:143]
  s_add_u32 m0, s59, 8192
  s_nop 0
  buffer_load_dwordx4 v2, s[28:31], s66 offen lds
  s_add_u32 m0, s59, 16384
  s_setprio 1
  ds_read_b64_tr_b16 v[216:217], v7 offset:0
  ds_read_b64_tr_b16 v[218:219], v7 offset:512
  ds_read_b128 v[60:63], v239 offset:32768
  ds_read_b128 v[64:67], v236 offset:49152
  ds_read_b128 v[68:71], v237 offset:49152
  s_waitcnt lgkmcnt(14)
  v_mfma_f32_32x32x16_bf16 v[128:143], v[224:227], v[32:35], v[128:143]
  buffer_load_dwordx4 v3, s[36:39], s67 offen lds
  s_add_u32 m0, s59, 24576
  ds_read_b64_tr_b16 v[220:221], v7 offset:2048
  ds_read_b64_tr_b16 v[222:223], v7 offset:2560
  ds_read_b128 v[72:75], v238 offset:49152
  ds_read_b128 v[76:79], v239 offset:49152
  v_add_u32 v236, 65536, v236
  v_add_u32 v237, 65536, v237
  v_add_u32 v238, 65536, v238
  v_add_u32 v239, 65536, v239
  ds_read_b128 v[80:83], v236 offset:0
  s_waitcnt lgkmcnt(15)
  v_mfma_f32_32x32x16_bf16 v[128:143], v[228:231], v[36:39], v[128:143]
  buffer_load_dwordx4 v4, s[40:43], s67 offen lds
  ds_write_b32 v234, v235
  ds_write_b32 v234, v244 offset:32
  s_setprio 0
  ds_read_b64_tr_b16 v[224:225], v7 offset:4096
  ds_read_b64_tr_b16 v[226:227], v7 offset:4608
  ds_read_b128 v[84:87], v237 offset:0
  ds_read_b128 v[88:91], v238 offset:0
  ds_read_b128 v[92:95], v239 offset:0
  v_mfma_f32_32x32x16_bf16 v[128:143], v[208:211], v[40:43], v[128:143]
  s_mov_b32 s10, s77
  s_lshl_b32 s54, s74, 2
  s_add_u32 s77, s77, s54
  s_lshl_b32 s54, s75, 1
  s_add_u32 s54, s54, s52
  s_lshl_b32 s11, s54, 6
  ds_read_b64_tr_b16 v[228:229], v7 offset:6144
  ds_read_b64_tr_b16 v[230:231], v7 offset:6656
  ds_read_b128 v[96:99], v236 offset:16384
  ds_read_b128 v[100:103], v237 offset:16384
  ds_read_b128 v[104:107], v238 offset:16384
  s_waitcnt lgkmcnt(15)
  v_mfma_f32_32x32x16_bf16 v[128:143], v[212:215], v[44:47], v[128:143]
  s_add_u32 s11, s11, s77
  s_mul_i32 s11, s11, 3
  s_add_u32 s11, s11, s53
  s_lshl_b32 s11, s11, 11
  s_mul_i32 s12, s75, 3
  s_add_u32 s12, s12, s53
  s_lshl_b32 s12, s12, 4
  s_waitcnt lgkmcnt(5)
  s_waitcnt vmcnt(8)
  s_barrier
  s_setprio 3
  ds_read_b64_tr_b16 v[208:209], v7 offset:8192
  ds_read_b64_tr_b16 v[210:211], v7 offset:8704
  ds_read_b128 v[108:111], v239 offset:16384
  ds_read_b128 v[112:115], v236 offset:32768
  ds_read_b128 v[116:119], v237 offset:32768
  v_mfma_f32_32x32x16_bf16 v[128:143], v[216:219], v[48:51], v[128:143]
  s_add_u32 m0, s59, 32768
  s_nop 0
  buffer_load_dwordx4 v3, s[36:39], s68 offen lds
  s_add_u32 m0, s59, 40960
  s_add_u32 s12, s12, s74
  s_lshl_b32 s12, s12, 3
  s_add_u32 s12, s12, 25165824
  ds_read_b64_tr_b16 v[212:213], v7 offset:10240
  ds_read_b64_tr_b16 v[214:215], v7 offset:10752
  ds_read_b128 v[120:123], v238 offset:32768
  ds_read_b128 v[124:127], v239 offset:32768
  v_mfma_f32_32x32x16_bf16 v[128:143], v[220:223], v[52:55], v[128:143]
  buffer_load_dwordx4 v4, s[40:43], s68 offen lds
  s_add_u32 m0, s59, 49152
  s_lshl_b32 s15, s74, 5
  s_add_u32 s15, s15, s75
  s_lshl_b32 s15, s15, 3
  s_add_u32 s15, s15, 25231360
  s_lshl_b32 s20, s53, 6
  ds_read_b64_tr_b16 v[216:217], v7 offset:12288
  ds_read_b64_tr_b16 v[218:219], v7 offset:12800
  v_mfma_f32_32x32x16_bf16 v[128:143], v[224:227], v[56:59], v[128:143]
  buffer_load_dwordx4 v3, s[36:39], s69 offen lds
  s_add_u32 m0, s59, 57344
  s_add_u32 s20, s20, s15
  s_add_u32 s20, s20, 128
  s_cmp_eq_u32 s3, 0
  s_cselect_b32 s12, s12, 0x7f000000
  s_cselect_b32 s15, s15, 0x7f000000
  s_cselect_b32 s20, s20, 0x7f000000
  s_setprio 2
  ds_read_b64_tr_b16 v[220:221], v7 offset:14336
  ds_read_b64_tr_b16 v[222:223], v7 offset:14848
  s_waitcnt lgkmcnt(15)
  v_mfma_f32_32x32x16_bf16 v[128:143], v[228:231], v[60:63], v[128:143]
  buffer_load_dwordx4 v4, s[40:43], s69 offen lds
  s_mul_i32 s54, s77, 144
  s_add_u32 s13, s54, s4
  ds_read_b64_tr_b16 v[224:225], v7 offset:16384
  ds_read_b64_tr_b16 v[226:227], v7 offset:16896
  s_waitcnt lgkmcnt(13)
  v_mfma_f32_32x32x16_bf16 v[128:143], v[208:211], v[64:67], v[128:143]
  s_lshl_b32 s13, s13, 10
  s_add_u32 s13, s13, 8388608
  ds_read_b64_tr_b16 v[228:229], v7 offset:18432
  ds_read_b64_tr_b16 v[230:231], v7 offset:18944
  s_waitcnt lgkmcnt(10)
  v_mfma_f32_32x32x16_bf16 v[128:143], v[212:215], v[68:71], v[128:143]
  s_add_u32 s14, s54, s5
  s_lshl_b32 s14, s14, 10
  s_add_u32 s14, s14, 8388608
  s_setprio 1
  ds_read_b64_tr_b16 v[208:209], v7 offset:20480
  ds_read_b64_tr_b16 v[210:211], v7 offset:20992
  s_waitcnt lgkmcnt(8)
  v_mfma_f32_32x32x16_bf16 v[128:143], v[216:219], v[72:75], v[128:143]
  s_mov_b32 s58, 262144
  buffer_load_dwordx2 v[240:241], v247, s[44:47], 0 offen sc1
  ds_read_b64_tr_b16 v[212:213], v7 offset:22528
  ds_read_b64_tr_b16 v[214:215], v7 offset:23040
  s_waitcnt lgkmcnt(8)
  v_mfma_f32_32x32x16_bf16 v[128:143], v[220:223], v[76:79], v[128:143]
  ds_read_b32 v251, v246
  ds_read_b64_tr_b16 v[216:217], v7 offset:24576
  ds_read_b64_tr_b16 v[218:219], v7 offset:25088
  s_waitcnt lgkmcnt(9)
  v_mfma_f32_32x32x16_bf16 v[128:143], v[224:227], v[80:83], v[128:143]
  s_add_u32 m0, s59, 65536
  s_nop 0
  buffer_load_dwordx4 v3, s[36:39], s70 offen lds
  s_setprio 0
  ds_read_b64_tr_b16 v[220:221], v7 offset:26624
  ds_read_b64_tr_b16 v[222:223], v7 offset:27136
  s_waitcnt lgkmcnt(9)
  v_mfma_f32_32x32x16_bf16 v[128:143], v[228:231], v[84:87], v[128:143]
  s_add_u32 m0, s59, 73728
  s_nop 0
  buffer_load_dwordx4 v4, s[40:43], s70 offen lds
  ds_read_b64_tr_b16 v[224:225], v7 offset:28672
  ds_read_b64_tr_b16 v[226:227], v7 offset:29184
  s_waitcnt lgkmcnt(9)
  v_mfma_f32_32x32x16_bf16 v[128:143], v[208:211], v[88:91], v[128:143]
  ds_read_b64_tr_b16 v[228:229], v7 offset:30720
  ds_read_b64_tr_b16 v[230:231], v7 offset:31232
  s_waitcnt lgkmcnt(9)
  v_mfma_f32_32x32x16_bf16 v[128:143], v[212:215], v[92:95], v[128:143]
  s_waitcnt vmcnt(7)
  s_barrier
  s_setprio 3
  ds_read_b64_tr_b16 v[208:209], v5 offset:8192
  ds_read_b64_tr_b16 v[210:211], v5 offset:8704
  s_waitcnt lgkmcnt(8)
  v_mfma_f32_32x32x16_bf16 v[128:143], v[216:219], v[96:99], v[128:143]
  v_rsq_f32 v248, v251
  s_nop 0
  v_mul_f32 v249, 3222493025, v248
  ds_read_b64_tr_b16 v[212:213], v5 offset:10240
  ds_read_b64_tr_b16 v[214:215], v5 offset:10752
  s_waitcnt lgkmcnt(8)
  v_mfma_f32_32x32x16_bf16 v[128:143], v[220:223], v[100:103], v[128:143]
  v_mul_f32 v250, v248, v248
  v_mul_f32 v250, v250, v248
  v_mul_f32 v250, 3184710632, v250
  ds_read_b64_tr_b16 v[216:217], v5 offset:12288
  ds_read_b64_tr_b16 v[218:219], v5 offset:12800
  s_waitcnt lgkmcnt(8)
  v_mfma_f32_32x32x16_bf16 v[128:143], v[224:227], v[104:107], v[128:143]
  s_setprio 2
  ds_read_b64_tr_b16 v[220:221], v5 offset:14336
  ds_read_b64_tr_b16 v[222:223], v5 offset:14848
  s_waitcnt lgkmcnt(8)
  v_mfma_f32_32x32x16_bf16 v[128:143], v[228:231], v[108:111], v[128:143]
  ds_read_b64_tr_b16 v[224:225], v8 offset:16384
  ds_read_b64_tr_b16 v[226:227], v8 offset:16896
  s_waitcnt lgkmcnt(8)
  v_mfma_f32_32x32x16_bf16 v[128:143], v[208:211], v[112:115], v[128:143]
  s_add_u32 m0, s59, 81920
  s_nop 0
  buffer_load_dwordx4 v3, s[36:39], s71 offen lds
  ds_read_b64_tr_b16 v[228:229], v11 offset:16384
  ds_read_b64_tr_b16 v[230:231], v11 offset:16896
  s_waitcnt lgkmcnt(8)
  v_mfma_f32_32x32x16_bf16 v[128:143], v[212:215], v[116:119], v[128:143]
  s_add_u32 m0, s59, 90112
  s_nop 0
  buffer_load_dwordx4 v4, s[40:43], s71 offen lds
  s_setprio 1
  ds_read_b64_tr_b16 v[208:209], v8 offset:18432
  ds_read_b64_tr_b16 v[210:211], v8 offset:18944
  s_waitcnt lgkmcnt(8)
  v_mfma_f32_32x32x16_bf16 v[128:143], v[216:219], v[120:123], v[128:143]
  ds_read_b64_tr_b16 v[212:213], v11 offset:18432
  ds_read_b64_tr_b16 v[214:215], v11 offset:18944
  s_waitcnt lgkmcnt(8)
  v_mfma_f32_32x32x16_bf16 v[128:143], v[220:223], v[124:127], v[128:143]
  ds_read_b64_tr_b16 v[216:217], v8 offset:20480
  ds_read_b64_tr_b16 v[218:219], v8 offset:20992
  s_waitcnt lgkmcnt(6)
  v_mfma_f32_32x32x16_bf16 v[144:159], v[224:227], v[16:19], 0
  s_setprio 0
  ds_read_b64_tr_b16 v[220:221], v11 offset:20480
  ds_read_b64_tr_b16 v[222:223], v11 offset:20992
  v_mfma_f32_32x32x16_bf16 v[160:175], v[228:231], v[16:19], 0
  v_mul_f32 v235, 1049335798, v248
  s_nop 2
  v_mul_f32 v128, v128, v235
  v_mul_f32 v129, v129, v235
  ds_read_b64_tr_b16 v[224:225], v8 offset:22528
  ds_read_b64_tr_b16 v[226:227], v8 offset:23040
  s_waitcnt lgkmcnt(6)
  v_mfma_f32_32x32x16_bf16 v[144:159], v[208:211], v[20:23], v[144:159]
  v_cvt_pk_bf16_f32 v128, v128, v129
  v_mul_f32 v130, v130, v235
  v_mul_f32 v131, v131, v235
  v_cvt_pk_bf16_f32 v129, v130, v131
  v_mul_f32 v132, v132, v235
  v_mul_f32 v133, v133, v235
  ds_read_b64_tr_b16 v[228:229], v11 offset:22528
  ds_read_b64_tr_b16 v[230:231], v11 offset:23040
  v_mfma_f32_32x32x16_bf16 v[160:175], v[212:215], v[20:23], v[160:175]
  v_cvt_pk_bf16_f32 v130, v132, v133
  v_mul_f32 v134, v134, v235
  v_mul_f32 v135, v135, v235
  v_cvt_pk_bf16_f32 v131, v134, v135
  buffer_store_dwordx4 v[128:131], v15, s[32:35], s11 offen offset:0 sc1
  v_mul_f32 v136, v136, v235
  v_mul_f32 v137, v137, v235
  s_waitcnt vmcnt(6)
  s_barrier
  s_setprio 3
  ds_read_b64_tr_b16 v[208:209], v8 offset:32768
  ds_read_b64_tr_b16 v[210:211], v8 offset:33280
  s_waitcnt lgkmcnt(6)
  v_mfma_f32_32x32x16_bf16 v[144:159], v[216:219], v[24:27], v[144:159]
  s_add_u32 m0, s59, 98304
  s_nop 0
  buffer_load_dwordx4 v3, s[36:39], s72 offen lds
  s_add_u32 m0, s59, 106496
  v_cvt_pk_bf16_f32 v132, v136, v137
  v_mul_f32 v138, v138, v235
  v_mul_f32 v139, v139, v235
  ds_read_b64_tr_b16 v[212:213], v11 offset:32768
  ds_read_b64_tr_b16 v[214:215], v11 offset:33280
  v_mfma_f32_32x32x16_bf16 v[160:175], v[220:223], v[24:27], v[160:175]
  buffer_load_dwordx4 v4, s[40:43], s72 offen lds
  v_cvt_pk_bf16_f32 v133, v138, v139
  v_mul_f32 v140, v140, v235
  v_mul_f32 v141, v141, v235
  v_cvt_pk_bf16_f32 v134, v140, v141
  v_mul_f32 v142, v142, v235
  v_mul_f32 v143, v143, v235
  ds_read_b64_tr_b16 v[216:217], v8 offset:34816
  ds_read_b64_tr_b16 v[218:219], v8 offset:35328
  s_waitcnt lgkmcnt(6)
  v_mfma_f32_32x32x16_bf16 v[144:159], v[224:227], v[28:31], v[144:159]
  v_cvt_pk_bf16_f32 v135, v142, v143
  v_and_b32 v134, v134, v252
  v_and_b32 v135, v135, v252
  buffer_store_dwordx4 v[132:135], v15, s[32:35], s11 offen offset:1024 sc1
  s_and_b32 s54, s2, 7
  s_lshl_b32 s55, s54, 1
  ds_read_b64_tr_b16 v[220:221], v11 offset:34816
  ds_read_b64_tr_b16 v[222:223], v11 offset:35328
  v_mfma_f32_32x32x16_bf16 v[160:175], v[228:231], v[28:31], v[160:175]
  s_add_u32 s55, s55, s53
  s_bfe_u32 s56, s2, 0x40003
  s_lshl_b32 s56, s56, 2
  s_add_u32 s56, s56, s10
  s_lshl_b32 s77, s54, 2
  s_bfe_u32 s54, s2, 0x20003
  s_add_u32 s77, s77, s54
  s_setprio 2
  ds_read_b64_tr_b16 v[224:225], v8 offset:36864
  ds_read_b64_tr_b16 v[226:227], v8 offset:37376
  s_waitcnt lgkmcnt(6)
  v_mfma_f32_32x32x16_bf16 v[144:159], v[208:211], v[32:35], v[144:159]
  s_lshr_b32 s78, s2, 5
  s_lshl_b32 s78, s78, 7
  s_mul_i32 s21, s55, 393216
  s_mul_i32 s74, s56, 6144
  s_add_u32 s74, s74, s21
  s_mul_i32 s54, s52, 196608
  ds_read_b64_tr_b16 v[228:229], v11 offset:36864
  ds_read_b64_tr_b16 v[230:231], v11 offset:37376
  v_mfma_f32_32x32x16_bf16 v[160:175], v[212:215], v[32:35], v[160:175]
  s_add_u32 s21, s21, s54
  s_add_u32 s21, s21, 2048
  s_sub_u32 s23, s10, s52
  s_add_u32 s23, s23, 1
  s_mul_i32 s22, s52, 49152
  s_mul_i32 s75, s56, 144
  s_lshl_b32 s54, s55, 1
  ds_read_b64_tr_b16 v[208:209], v8 offset:38912
  ds_read_b64_tr_b16 v[210:211], v8 offset:39424
  s_waitcnt lgkmcnt(6)
  v_mfma_f32_32x32x16_bf16 v[144:159], v[216:219], v[36:39], v[144:159]
  s_add_u32 s75, s75, s54
  s_lshl_b32 s75, s75, 10
  s_add_u32 s75, s75, 8503296
  s_bfe_u32 s76, s2, 0x40003
  s_lshl_b32 s76, s76, 4
  s_add_u32 s76, s76, s55
  ds_read_b64_tr_b16 v[212:213], v11 offset:38912
  ds_read_b64_tr_b16 v[214:215], v11 offset:39424
  v_mfma_f32_32x32x16_bf16 v[160:175], v[220:223], v[36:39], v[160:175]
  s_lshl_b32 s76, s76, 3
  s_add_u32 s76, s76, 25296896
  s_cmp_eq_u32 s3, 0
  s_cselect_b32 s76, s76, 0x7f000000
  s_bfe_u32 s4, s2, 0x40003
  s_lshl_b32 s4, s4, 2
  s_add_u32 s4, s4, s23
  s_setprio 1
  ds_read_b64_tr_b16 v[216:217], v8 offset:49152
  ds_read_b64_tr_b16 v[218:219], v8 offset:49664
  s_waitcnt lgkmcnt(6)
  v_mfma_f32_32x32x16_bf16 v[144:159], v[224:227], v[40:43], v[144:159]
L_non0_chk:
  s_waitcnt vmcnt(8)
  v_readfirstlane_b32 s48, v240
  s_nop 0
  s_cmp_lg_u32 s48, 0
  s_cbranch_scc0 L_non0_spin
L_non0_ok:
  s_add_u32 m0, s59, 114688
  s_nop 0
  buffer_load_dwordx4 v3, s[36:39], s73 offen lds
  s_add_u32 m0, s59, 122880
  s_add_u32 s4, s4, 31
  ds_read_b64_tr_b16 v[220:221], v11 offset:49152
  ds_read_b64_tr_b16 v[222:223], v11 offset:49664
  v_mfma_f32_32x32x16_bf16 v[160:175], v[228:231], v[40:43], v[160:175]
  buffer_load_dwordx4 v4, s[40:43], s73 offen lds
  s_and_b32 s4, s4, 31
  s_sub_u32 s5, s23, 1
  s_cmp_eq_u32 s23, 0
  s_cselect_b32 s5, 11, s5
  s_lshl_b32 s5, s5, 12
  s_add_u32 s5, s5, s22
  ds_read_b64_tr_b16 v[224:225], v8 offset:51200
  ds_read_b64_tr_b16 v[226:227], v8 offset:51712
  s_waitcnt lgkmcnt(6)
  v_mfma_f32_32x32x16_bf16 v[144:159], v[208:211], v[44:47], v[144:159]
  s_lshr_b32 s54, s55, 1
  s_mul_i32 s54, s54, 384
  s_add_u32 s54, s54, 25165824
  s_cmp_eq_u32 s3, 0
  s_cselect_b32 s54, s54, 0x7f000000
  v_min_u32 v236, 47, v0
  ds_read_b64_tr_b16 v[228:229], v11 offset:51200
  ds_read_b64_tr_b16 v[230:231], v11 offset:51712
  v_mfma_f32_32x32x16_bf16 v[160:175], v[212:215], v[44:47], v[160:175]
  v_lshl_add_u32 v14, v236, 3, s54
  s_lshr_b32 s54, s77, 1
  s_lshl_b32 s57, s54, 8
  s_add_u32 s57, s57, 25231360
  v_and_b32 v236, 31, v0
  v_lshrrev_b32 v237, 1, v236
  v_or_b32 v237, 23, v237
  s_setprio 0
  ds_read_b64_tr_b16 v[208:209], v8 offset:53248
  ds_read_b64_tr_b16 v[210:211], v8 offset:53760
  s_waitcnt lgkmcnt(6)
  v_mfma_f32_32x32x16_bf16 v[144:159], v[216:219], v[48:51], v[144:159]
  v_and_b32 v236, v236, v237
  v_lshl_add_u32 v236, v236, 3, s57
  ds_read_b64_tr_b16 v[212:213], v11 offset:53248
  ds_read_b64_tr_b16 v[214:215], v11 offset:53760
  v_mfma_f32_32x32x16_bf16 v[160:175], v[220:223], v[48:51], v[160:175]
  s_lshl_b32 s54, s54, 7
  s_add_u32 s54, s54, 25296896
  v_and_b32 v237, 15, v0
  ds_read_b64_tr_b16 v[216:217], v8 offset:55296
  ds_read_b64_tr_b16 v[218:219], v8 offset:55808
  s_waitcnt lgkmcnt(6)
  v_mfma_f32_32x32x16_bf16 v[144:159], v[224:227], v[52:55], v[144:159]
  v_lshl_add_u32 v237, v237, 3, s54
  v_bfi_b32 v1, v253, v237, v236
  ds_read_b64_tr_b16 v[220:221], v11 offset:55296
  ds_read_b64_tr_b16 v[222:223], v11 offset:55808
  v_mfma_f32_32x32x16_bf16 v[160:175], v[228:231], v[52:55], v[160:175]
  s_cmp_lg_u32 s52, 0
  s_cselect_b64 vcc, -1, 0
  s_cmp_lg_u32 s52, 0
  s_cselect_b32 s75, s75, 0x7f000000
  s_waitcnt vmcnt(2)
  s_barrier
  s_setprio 3
  ds_read_b64_tr_b16 v[224:225], v9 offset:0
  ds_read_b64_tr_b16 v[226:227], v9 offset:512
  s_waitcnt lgkmcnt(6)
  v_mfma_f32_32x32x16_bf16 v[144:159], v[208:211], v[56:59], v[144:159]
  s_mov_b64 exec, 1
  buffer_store_dwordx2 v[240:241], v247, s[32:35], s12 offen offset:0 sc1
  s_mov_b64 exec, -1
  ds_read_b64_tr_b16 v[228:229], v12 offset:0
  ds_read_b64_tr_b16 v[230:231], v12 offset:512
  v_mfma_f32_32x32x16_bf16 v[160:175], v[212:215], v[56:59], v[160:175]
  s_add_u32 s36, s36, s6
  s_addc_u32 s37, s37, 0
  s_sub_u32 s38, s38, s6
  ds_read_b64_tr_b16 v[208:209], v9 offset:2048
  ds_read_b64_tr_b16 v[210:211], v9 offset:2560
  s_waitcnt lgkmcnt(6)
  v_mfma_f32_32x32x16_bf16 v[144:159], v[216:219], v[60:63], v[144:159]
  s_add_u32 s40, s40, s6
  s_addc_u32 s41, s41, 0
  ds_read_b64_tr_b16 v[212:213], v12 offset:2048
  ds_read_b64_tr_b16 v[214:215], v12 offset:2560
  v_mfma_f32_32x32x16_bf16 v[160:175], v[220:223], v[60:63], v[160:175]
  s_sub_u32 s42, s42, s6
  s_add_u32 m0, s59, 16384
  s_nop 0
  buffer_load_dwordx4 v3, s[36:39], s67 offen lds
  s_setprio 2
  ds_read_b64_tr_b16 v[216:217], v9 offset:4096
  ds_read_b64_tr_b16 v[218:219], v9 offset:4608
  s_waitcnt lgkmcnt(6)
  v_mfma_f32_32x32x16_bf16 v[144:159], v[224:227], v[64:67], v[144:159]
  s_add_u32 m0, s59, 24576
  s_nop 0
  buffer_load_dwordx4 v4, s[40:43], s67 offen lds
  ds_read_b64_tr_b16 v[220:221], v12 offset:4096
  ds_read_b64_tr_b16 v[222:223], v12 offset:4608
  v_mfma_f32_32x32x16_bf16 v[160:175], v[228:231], v[64:67], v[160:175]
  ds_read_b64_tr_b16 v[224:225], v9 offset:6144
  ds_read_b64_tr_b16 v[226:227], v9 offset:6656
  s_waitcnt lgkmcnt(6)
  v_mfma_f32_32x32x16_bf16 v[144:159], v[208:211], v[68:71], v[144:159]
  ds_read_b64_tr_b16 v[228:229], v12 offset:6144
  ds_read_b64_tr_b16 v[230:231], v12 offset:6656
  v_mfma_f32_32x32x16_bf16 v[160:175], v[212:215], v[68:71], v[160:175]
  s_setprio 1
  ds_read_b64_tr_b16 v[208:209], v9 offset:16384
  ds_read_b64_tr_b16 v[210:211], v9 offset:16896
  s_waitcnt lgkmcnt(6)
  v_mfma_f32_32x32x16_bf16 v[144:159], v[216:219], v[72:75], v[144:159]
  s_add_u32 m0, s59, 32768
  s_nop 0
  buffer_load_dwordx4 v3, s[36:39], s68 offen lds
  ds_read_b64_tr_b16 v[212:213], v12 offset:16384
  ds_read_b64_tr_b16 v[214:215], v12 offset:16896
  v_mfma_f32_32x32x16_bf16 v[160:175], v[220:223], v[72:75], v[160:175]
  s_add_u32 m0, s59, 40960
  s_nop 0
  buffer_load_dwordx4 v4, s[40:43], s68 offen lds
  ds_read_b64_tr_b16 v[216:217], v9 offset:18432
  ds_read_b64_tr_b16 v[218:219], v9 offset:18944
  s_waitcnt lgkmcnt(6)
  v_mfma_f32_32x32x16_bf16 v[144:159], v[224:227], v[76:79], v[144:159]
  ds_read_b64_tr_b16 v[220:221], v12 offset:18432
  ds_read_b64_tr_b16 v[222:223], v12 offset:18944
  v_mfma_f32_32x32x16_bf16 v[160:175], v[228:231], v[76:79], v[160:175]
  s_setprio 0
  ds_read_b64_tr_b16 v[224:225], v9 offset:20480
  ds_read_b64_tr_b16 v[226:227], v9 offset:20992
  s_waitcnt lgkmcnt(6)
  v_mfma_f32_32x32x16_bf16 v[144:159], v[208:211], v[80:83], v[144:159]
  ds_read_b64_tr_b16 v[228:229], v12 offset:20480
  ds_read_b64_tr_b16 v[230:231], v12 offset:20992
  v_mfma_f32_32x32x16_bf16 v[160:175], v[212:215], v[80:83], v[160:175]
  ds_read_b64_tr_b16 v[208:209], v9 offset:22528
  ds_read_b64_tr_b16 v[210:211], v9 offset:23040
  s_waitcnt lgkmcnt(6)
  v_mfma_f32_32x32x16_bf16 v[144:159], v[216:219], v[84:87], v[144:159]
  ds_read_b64_tr_b16 v[212:213], v12 offset:22528
  ds_read_b64_tr_b16 v[214:215], v12 offset:23040
  v_mfma_f32_32x32x16_bf16 v[160:175], v[220:223], v[84:87], v[160:175]
  s_waitcnt vmcnt(5)
  s_barrier
  s_setprio 3
  ds_read_b64_tr_b16 v[216:217], v9 offset:32768
  ds_read_b64_tr_b16 v[218:219], v9 offset:33280
  s_waitcnt lgkmcnt(6)
  v_mfma_f32_32x32x16_bf16 v[144:159], v[224:227], v[88:91], v[144:159]
  s_add_u32 m0, s59, 65536
  s_nop 0
  buffer_load_dwordx4 v3, s[36:39], s69 offen lds
  ds_read_b64_tr_b16 v[220:221], v12 offset:32768
  ds_read_b64_tr_b16 v[222:223], v12 offset:33280
  v_mfma_f32_32x32x16_bf16 v[160:175], v[228:231], v[88:91], v[160:175]
  s_add_u32 m0, s59, 73728
  s_nop 0
  buffer_load_dwordx4 v4, s[40:43], s69 offen lds
  ds_read_b64_tr_b16 v[224:225], v9 offset:34816
  ds_read_b64_tr_b16 v[226:227], v9 offset:35328
  s_waitcnt lgkmcnt(6)
  v_mfma_f32_32x32x16_bf16 v[144:159], v[208:211], v[92:95], v[144:159]
  v_mov_b32 v236, -1
  v_mov_b32 v237, -1
  ds_read_b64_tr_b16 v[228:229], v12 offset:34816
  ds_read_b64_tr_b16 v[230:231], v12 offset:35328
  v_mfma_f32_32x32x16_bf16 v[160:175], v[212:215], v[92:95], v[160:175]
  v_mov_b32 v238, -1
  v_mov_b32 v239, -1
  buffer_store_dwordx4 v[236:239], v15, s[32:35], s75 offen offset:0 sc1
  s_setprio 2
  ds_read_b64_tr_b16 v[208:209], v9 offset:36864
  ds_read_b64_tr_b16 v[210:211], v9 offset:37376
  s_waitcnt lgkmcnt(6)
  v_mfma_f32_32x32x16_bf16 v[144:159], v[216:219], v[96:99], v[144:159]
  buffer_store_dwordx4 v[236:239], v15, s[32:35], s75 offen offset:1024 sc1
  s_nop 1
  v_lshrrev_b32 v236, 3, v0
  v_and_b32 v237, 7, v0
  v_lshlrev_b32 v238, 1, v236
  v_and_b32 v238, 4, v238
  v_xor_b32 v238, v238, v237
  ds_read_b64_tr_b16 v[212:213], v12 offset:36864
  ds_read_b64_tr_b16 v[214:215], v12 offset:37376
  v_mfma_f32_32x32x16_bf16 v[160:175], v[220:223], v[96:99], v[160:175]
  v_mul_u32_u24 v6, 896, v236
  v_lshl_add_u32 v6, v238, 4, v6
  v_add_u32 v7, 6144, v6
  v_add_u32 v254, 147456, v15
  v_and_b32 v236, 3, v0
  v_lshlrev_b32 v242, 3, v236
  v_bfe_u32 v236, v0, 4, 1
  ds_read_b64_tr_b16 v[216:217], v9 offset:38912
  ds_read_b64_tr_b16 v[218:219], v9 offset:39424
  s_waitcnt lgkmcnt(6)
  v_mfma_f32_32x32x16_bf16 v[144:159], v[224:227], v[100:103], v[144:159]
  v_lshl_add_u32 v242, v236, 5, v242
  v_bfe_u32 v237, v0, 3, 1
  v_lshl_add_u32 v242, v237, 6, v242
  v_bfe_u32 v239, v0, 2, 2
  v_lshl_add_u32 v242, v239, 7, v242
  v_lshrrev_b32 v238, 5, v0
  ds_read_b64_tr_b16 v[220:221], v12 offset:38912
  ds_read_b64_tr_b16 v[222:223], v12 offset:39424
  v_mfma_f32_32x32x16_bf16 v[160:175], v[228:231], v[100:103], v[160:175]
  v_lshl_add_u32 v242, v238, 9, v242
  s_lshl_b32 s55, s3, 13
  s_add_u32 s55, s55, 98304
  v_add_u32 v242, s55, v242
  v_xor_b32 v243, 64, v242
  v_add_u32 v246, s22, v15
  v_and_b32 v237, 1, v0
  s_setprio 1
  ds_read_b64_tr_b16 v[224:225], v9 offset:49152
  ds_read_b64_tr_b16 v[226:227], v9 offset:49664
  s_waitcnt lgkmcnt(6)
  v_mfma_f32_32x32x16_bf16 v[144:159], v[208:211], v[104:107], v[144:159]
  s_add_u32 m0, s59, 131072
  s_nop 0
  buffer_load_dwordx4 v3, s[36:39], s70 offen lds
  ds_read_b64_tr_b16 v[228:229], v12 offset:49152
  ds_read_b64_tr_b16 v[230:231], v12 offset:49664
  v_mfma_f32_32x32x16_bf16 v[160:175], v[212:215], v[104:107], v[160:175]
  s_add_u32 m0, s59, 139264
  s_nop 0
  buffer_load_dwordx4 v4, s[40:43], s70 offen lds
  v_xor_b32 v238, v238, v237
  ds_read_b64_tr_b16 v[208:209], v9 offset:51200
  ds_read_b64_tr_b16 v[210:211], v9 offset:51712
  s_waitcnt lgkmcnt(6)
  v_mfma_f32_32x32x16_bf16 v[144:159], v[216:219], v[108:111], v[144:159]
  v_mul_u32_u24 v2, 1152, v236
  v_lshl_add_u32 v2, v237, 9, v2
  ds_read_b64_tr_b16 v[212:213], v12 offset:51200
  ds_read_b64_tr_b16 v[214:215], v12 offset:51712
  v_mfma_f32_32x32x16_bf16 v[160:175], v[220:223], v[108:111], v[160:175]
  v_lshl_add_u32 v2, v238, 6, v2
  v_lshl_add_u32 v2, v239, 4, v2
  v_bfe_u32 v237, v0, 1, 1
  s_setprio 0
  ds_read_b64_tr_b16 v[216:217], v9 offset:53248
  ds_read_b64_tr_b16 v[218:219], v9 offset:53760
  s_waitcnt lgkmcnt(6)
  v_mfma_f32_32x32x16_bf16 v[144:159], v[224:227], v[112:115], v[144:159]
  v_lshl_add_u32 v2, v237, 3, v2
  v_add_u32 v2, s22, v2
  ds_read_b64_tr_b16 v[220:221], v12 offset:53248
  ds_read_b64_tr_b16 v[222:223], v12 offset:53760
  v_mfma_f32_32x32x16_bf16 v[160:175], v[228:231], v[112:115], v[160:175]
  v_add_u32 v2, 2048, v2
  v_xor_b32 v5, 128, v2
  ds_read_b64_tr_b16 v[224:225], v9 offset:55296
  ds_read_b64_tr_b16 v[226:227], v9 offset:55808
  s_waitcnt lgkmcnt(6)
  v_mfma_f32_32x32x16_bf16 v[144:159], v[208:211], v[116:119], v[144:159]
  ds_read_b64_tr_b16 v[228:229], v12 offset:55296
  ds_read_b64_tr_b16 v[230:231], v12 offset:55808
  v_mfma_f32_32x32x16_bf16 v[160:175], v[212:215], v[116:119], v[160:175]
  s_waitcnt vmcnt(6)
  s_barrier
  s_setprio 3
  ds_read_b64_tr_b16 v[208:209], v8 offset:16384
  ds_read_b64_tr_b16 v[210:211], v8 offset:16896
  s_waitcnt lgkmcnt(6)
  v_mfma_f32_32x32x16_bf16 v[144:159], v[216:219], v[120:123], v[144:159]
  s_add_u32 m0, s59, 147456
  s_nop 0
  buffer_load_dwordx4 v3, s[36:39], s71 offen lds
  ds_read_b64_tr_b16 v[212:213], v11 offset:16384
  ds_read_b64_tr_b16 v[214:215], v11 offset:16896
  v_mfma_f32_32x32x16_bf16 v[160:175], v[220:223], v[120:123], v[160:175]
  s_add_u32 m0, s59, 155648
  s_nop 0
  buffer_load_dwordx4 v4, s[40:43], s71 offen lds
  ds_read_b64_tr_b16 v[216:217], v8 offset:18432
  ds_read_b64_tr_b16 v[218:219], v8 offset:18944
  s_waitcnt lgkmcnt(6)
  v_mfma_f32_32x32x16_bf16 v[144:159], v[224:227], v[124:127], v[144:159]
  ds_read_b64_tr_b16 v[220:221], v11 offset:18432
  ds_read_b64_tr_b16 v[222:223], v11 offset:18944
  v_mfma_f32_32x32x16_bf16 v[160:175], v[228:231], v[124:127], v[160:175]
  s_setprio 2
  ds_read_b64_tr_b16 v[224:225], v8 offset:20480
  ds_read_b64_tr_b16 v[226:227], v8 offset:20992
  s_waitcnt lgkmcnt(6)
  v_mfma_f32_32x32x16_bf16 v[176:191], v[208:211], v[16:19], 0
  ds_read_b64_tr_b16 v[228:229], v11 offset:20480
  ds_read_b64_tr_b16 v[230:231], v11 offset:20992
  v_mfma_f32_32x32x16_bf16 v[192:207], v[212:215], v[16:19], 0
  s_nop 0
  v_mul_f32 v236, v144, v144
  v_mul_f32 v237, v145, v145
  v_mul_f32 v238, v146, v146
  ds_read_b64_tr_b16 v[208:209], v8 offset:22528
  ds_read_b64_tr_b16 v[210:211], v8 offset:23040
  s_waitcnt lgkmcnt(6)
  v_mfma_f32_32x32x16_bf16 v[176:191], v[216:219], v[20:23], v[176:191]
  v_mul_f32 v239, v147, v147
  v_fma_f32 v236, v236, v250, v249
  v_fma_f32 v237, v237, v250, v249
  v_fma_f32 v238, v238, v250, v249
  v_fma_f32 v239, v239, v250, v249
  v_mul_f32 v236, v236, v144
  ds_read_b64_tr_b16 v[212:213], v11 offset:22528
  ds_read_b64_tr_b16 v[214:215], v11 offset:23040
  v_mfma_f32_32x32x16_bf16 v[192:207], v[220:223], v[20:23], v[192:207]
  v_mul_f32 v237, v237, v145
  v_mul_f32 v238, v238, v146
  v_mul_f32 v239, v239, v147
  v_exp_f32 v236, v236
  v_exp_f32 v237, v237
  v_exp_f32 v238, v238
  v_exp_f32 v239, v239
  s_setprio 1
  ds_read_b64_tr_b16 v[216:217], v8 offset:32768
  ds_read_b64_tr_b16 v[218:219], v8 offset:33280
  s_waitcnt lgkmcnt(6)
  v_mfma_f32_32x32x16_bf16 v[176:191], v[224:227], v[24:27], v[176:191]
  s_add_u32 m0, s59, 98304
  s_nop 0
  buffer_load_dwordx4 v3, s[36:39], s72 offen lds
  s_add_u32 m0, s59, 106496
  v_mul_f32 v144, v144, v152
  v_mul_f32 v145, v145, v153
  v_mul_f32 v146, v146, v154
  ds_read_b64_tr_b16 v[220:221], v11 offset:32768
  ds_read_b64_tr_b16 v[222:223], v11 offset:33280
  v_mfma_f32_32x32x16_bf16 v[192:207], v[228:231], v[24:27], v[192:207]
  buffer_load_dwordx4 v4, s[40:43], s72 offen lds
  v_mul_f32 v147, v147, v155
  v_fma_f32 v236, v236, v251, v251
  v_fma_f32 v237, v237, v251, v251
  v_fma_f32 v238, v238, v251, v251
  v_fma_f32 v239, v239, v251, v251
  v_rcp_f32 v236, v236
  ds_read_b64_tr_b16 v[224:225], v8 offset:34816
  ds_read_b64_tr_b16 v[226:227], v8 offset:35328
  s_waitcnt lgkmcnt(6)
  v_mfma_f32_32x32x16_bf16 v[176:191], v[208:211], v[28:31], v[176:191]
  v_rcp_f32 v237, v237
  v_rcp_f32 v238, v238
  v_rcp_f32 v239, v239
  v_mul_f32 v144, v144, v236
  v_mul_f32 v145, v145, v237
  v_mul_f32 v146, v146, v238
  ds_read_b64_tr_b16 v[228:229], v11 offset:34816
  ds_read_b64_tr_b16 v[230:231], v11 offset:35328
  v_mfma_f32_32x32x16_bf16 v[192:207], v[212:215], v[28:31], v[192:207]
  v_mul_f32 v147, v147, v239
  v_mul_f32 v236, v148, v148
  v_mul_f32 v237, v149, v149
  v_mul_f32 v238, v150, v150
  v_mul_f32 v239, v151, v151
  v_fma_f32 v236, v236, v250, v249
  v_fma_f32 v237, v237, v250, v249
  s_setprio 0
  ds_read_b64_tr_b16 v[208:209], v8 offset:36864
  ds_read_b64_tr_b16 v[210:211], v8 offset:37376
  s_waitcnt lgkmcnt(6)
  v_mfma_f32_32x32x16_bf16 v[176:191], v[216:219], v[32:35], v[176:191]
  v_fma_f32 v238, v238, v250, v249
  v_fma_f32 v239, v239, v250, v249
  v_mul_f32 v236, v236, v148
  v_mul_f32 v237, v237, v149
  v_mul_f32 v238, v238, v150
  v_mul_f32 v239, v239, v151
  ds_read_b64_tr_b16 v[212:213], v11 offset:36864
  ds_read_b64_tr_b16 v[214:215], v11 offset:37376
  v_mfma_f32_32x32x16_bf16 v[192:207], v[220:223], v[32:35], v[192:207]
  v_exp_f32 v236, v236
  v_exp_f32 v237, v237
  v_exp_f32 v238, v238
  v_exp_f32 v239, v239
  v_mul_f32 v148, v148, v156
  v_mul_f32 v149, v149, v157
  v_mul_f32 v150, v150, v158
  ds_read_b64_tr_b16 v[216:217], v8 offset:38912
  ds_read_b64_tr_b16 v[218:219], v8 offset:39424
  s_waitcnt lgkmcnt(6)
  v_mfma_f32_32x32x16_bf16 v[176:191], v[224:227], v[36:39], v[176:191]
  v_mul_f32 v151, v151, v159
  v_fma_f32 v236, v236, v251, v251
  v_fma_f32 v237, v237, v251, v251
  v_fma_f32 v238, v238, v251, v251
  v_fma_f32 v239, v239, v251, v251
  v_rcp_f32 v236, v236
  ds_read_b64_tr_b16 v[220:221], v11 offset:38912
  ds_read_b64_tr_b16 v[222:223], v11 offset:39424
  v_mfma_f32_32x32x16_bf16 v[192:207], v[228:231], v[36:39], v[192:207]
  v_rcp_f32 v237, v237
  v_rcp_f32 v238, v238
  v_rcp_f32 v239, v239
  v_mul_f32 v148, v148, v236
  v_mul_f32 v149, v149, v237
  v_mul_f32 v150, v150, v238
  v_mul_f32 v151, v151, v239
  s_waitcnt vmcnt(4)
  s_barrier
  s_setprio 3
  ds_read_b64_tr_b16 v[224:225], v9 offset:0
  ds_read_b64_tr_b16 v[226:227], v9 offset:512
  s_waitcnt lgkmcnt(6)
  v_mfma_f32_32x32x16_bf16 v[176:191], v[208:211], v[40:43], v[176:191]
  s_add_u32 m0, s59, 114688
  s_nop 0
  buffer_load_dwordx4 v3, s[36:39], s73 offen lds
  s_add_u32 m0, s59, 122880
  v_cvt_pk_bf16_f32 v152, v144, v145
  v_cvt_pk_bf16_f32 v153, v146, v147
  v_cvt_pk_bf16_f32 v154, v148, v149
  ds_read_b64_tr_b16 v[228:229], v12 offset:0
  ds_read_b64_tr_b16 v[230:231], v12 offset:512
  v_mfma_f32_32x32x16_bf16 v[192:207], v[212:215], v[40:43], v[192:207]
  buffer_load_dwordx4 v4, s[40:43], s73 offen lds
  v_cvt_pk_bf16_f32 v155, v150, v151
  ds_read_b64_tr_b16 v[208:209], v9 offset:2048
  ds_read_b64_tr_b16 v[210:211], v9 offset:2560
  s_waitcnt lgkmcnt(6)
  v_mfma_f32_32x32x16_bf16 v[176:191], v[216:219], v[44:47], v[176:191]
  buffer_store_dwordx4 v[152:155], v15, s[32:35], s13 offen offset:0 sc1
  v_mul_f32 v236, v160, v160
  v_mul_f32 v237, v161, v161
  v_mul_f32 v238, v162, v162
  v_mul_f32 v239, v163, v163
  v_fma_f32 v236, v236, v250, v249
  ds_read_b64_tr_b16 v[212:213], v12 offset:2048
  ds_read_b64_tr_b16 v[214:215], v12 offset:2560
  v_mfma_f32_32x32x16_bf16 v[192:207], v[220:223], v[44:47], v[192:207]
  v_fma_f32 v237, v237, v250, v249
  v_fma_f32 v238, v238, v250, v249
  v_fma_f32 v239, v239, v250, v249
  v_mul_f32 v236, v236, v160
  v_mul_f32 v237, v237, v161
  v_mul_f32 v238, v238, v162
  v_mul_f32 v239, v239, v163
  s_setprio 2
  ds_read_b64_tr_b16 v[216:217], v9 offset:4096
  ds_read_b64_tr_b16 v[218:219], v9 offset:4608
  s_waitcnt lgkmcnt(6)
  v_mfma_f32_32x32x16_bf16 v[176:191], v[224:227], v[48:51], v[176:191]
  v_exp_f32 v236, v236
  v_exp_f32 v237, v237
  v_exp_f32 v238, v238
  v_exp_f32 v239, v239
  v_mul_f32 v160, v160, v168
  v_mul_f32 v161, v161, v169
  ds_read_b64_tr_b16 v[220:221], v12 offset:4096
  ds_read_b64_tr_b16 v[222:223], v12 offset:4608
  v_mfma_f32_32x32x16_bf16 v[192:207], v[228:231], v[48:51], v[192:207]
  v_mul_f32 v162, v162, v170
  v_mul_f32 v163, v163, v171
  v_fma_f32 v236, v236, v251, v251
  v_fma_f32 v237, v237, v251, v251
  v_fma_f32 v238, v238, v251, v251
  v_fma_f32 v239, v239, v251, v251
  v_rcp_f32 v236, v236
  ds_read_b64_tr_b16 v[224:225], v9 offset:6144
  ds_read_b64_tr_b16 v[226:227], v9 offset:6656
  s_waitcnt lgkmcnt(6)
  v_mfma_f32_32x32x16_bf16 v[176:191], v[208:211], v[52:55], v[176:191]
  buffer_load_dwordx2 v[244:245], v14, s[32:35], 0 offen sc1
  v_rcp_f32 v237, v237
  v_rcp_f32 v238, v238
  v_rcp_f32 v239, v239
  v_mul_f32 v160, v160, v236
  v_mul_f32 v161, v161, v237
  ds_read_b64_tr_b16 v[228:229], v12 offset:6144
  ds_read_b64_tr_b16 v[230:231], v12 offset:6656
  v_mfma_f32_32x32x16_bf16 v[192:207], v[212:215], v[52:55], v[192:207]
  v_mul_f32 v162, v162, v238
  v_mul_f32 v163, v163, v239
  v_mul_f32 v236, v164, v164
  v_mul_f32 v237, v165, v165
  v_mul_f32 v238, v166, v166
  v_mul_f32 v239, v167, v167
  v_fma_f32 v236, v236, v250, v249
  s_setprio 1
  ds_read_b64_tr_b16 v[208:209], v10 offset:0
  ds_read_b64_tr_b16 v[210:211], v10 offset:512
  s_waitcnt lgkmcnt(6)
  v_mfma_f32_32x32x16_bf16 v[176:191], v[216:219], v[56:59], v[176:191]
  v_fma_f32 v237, v237, v250, v249
  v_fma_f32 v238, v238, v250, v249
  v_fma_f32 v239, v239, v250, v249
  v_mul_f32 v236, v236, v164
  v_mul_f32 v237, v237, v165
  v_mul_f32 v238, v238, v166
  ds_read_b64_tr_b16 v[212:213], v13 offset:0
  ds_read_b64_tr_b16 v[214:215], v13 offset:512
  v_mfma_f32_32x32x16_bf16 v[192:207], v[220:223], v[56:59], v[192:207]
  v_mul_f32 v239, v239, v167
  v_exp_f32 v236, v236
  v_exp_f32 v237, v237
  v_exp_f32 v238, v238
  v_exp_f32 v239, v239
  v_mul_f32 v164, v164, v172
  v_mul_f32 v165, v165, v173
  ds_read_b64_tr_b16 v[216:217], v10 offset:2048
  ds_read_b64_tr_b16 v[218:219], v10 offset:2560
  s_waitcnt lgkmcnt(6)
  v_mfma_f32_32x32x16_bf16 v[176:191], v[224:227], v[60:63], v[176:191]
  v_mul_f32 v166, v166, v174
  v_mul_f32 v167, v167, v175
  v_fma_f32 v236, v236, v251, v251
  v_fma_f32 v237, v237, v251, v251
  v_fma_f32 v238, v238, v251, v251
  v_fma_f32 v239, v239, v251, v251
  ds_read_b64_tr_b16 v[220:221], v13 offset:2048
  ds_read_b64_tr_b16 v[222:223], v13 offset:2560
  v_mfma_f32_32x32x16_bf16 v[192:207], v[228:231], v[60:63], v[192:207]
  v_rcp_f32 v236, v236
  v_rcp_f32 v237, v237
  v_rcp_f32 v238, v238
  v_rcp_f32 v239, v239
  v_mul_f32 v164, v164, v236
  v_mul_f32 v165, v165, v237
  v_mul_f32 v166, v166, v238
  s_setprio 0
  ds_read_b64_tr_b16 v[224:225], v10 offset:4096
  ds_read_b64_tr_b16 v[226:227], v10 offset:4608
  s_waitcnt lgkmcnt(6)
  v_mfma_f32_32x32x16_bf16 v[176:191], v[208:211], v[64:67], v[176:191]
  v_mul_f32 v167, v167, v239
  v_cvt_pk_bf16_f32 v168, v160, v161
  v_cvt_pk_bf16_f32 v169, v162, v163
  v_cvt_pk_bf16_f32 v170, v164, v165
  v_cvt_pk_bf16_f32 v171, v166, v167
  buffer_store_dwordx4 v[168:171], v15, s[32:35], s13 offen offset:1024 sc1
  ds_read_b64_tr_b16 v[228:229], v13 offset:4096
  ds_read_b64_tr_b16 v[230:231], v13 offset:4608
  v_mfma_f32_32x32x16_bf16 v[192:207], v[212:215], v[64:67], v[192:207]
  ds_read_b64_tr_b16 v[208:209], v10 offset:6144
  ds_read_b64_tr_b16 v[210:211], v10 offset:6656
  s_waitcnt lgkmcnt(6)
  v_mfma_f32_32x32x16_bf16 v[176:191], v[216:219], v[68:71], v[176:191]
  ds_read_b64_tr_b16 v[212:213], v13 offset:6144
  ds_read_b64_tr_b16 v[214:215], v13 offset:6656
  v_mfma_f32_32x32x16_bf16 v[192:207], v[220:223], v[68:71], v[192:207]
  s_cmp_lg_u32 s3, 0
  s_cbranch_scc1 L_pa0_ok
L_pa0_chk:
  s_waitcnt vmcnt(1)
  v_cmp_ne_u64 s[48:49], v[244:245], v[240:241]
  s_nop 0
  s_cmp_eq_u64 s[48:49], 0
  s_cbranch_scc0 L_pa0_spin
L_pa0_ok:
  s_waitcnt vmcnt(5)
  s_barrier
  s_setprio 3
  ds_read_b64_tr_b16 v[216:217], v10 offset:16384
  ds_read_b64_tr_b16 v[218:219], v10 offset:16896
  s_waitcnt lgkmcnt(6)
  v_mfma_f32_32x32x16_bf16 v[176:191], v[224:227], v[72:75], v[176:191]
  buffer_load_dwordx4 v[128:131], v15, s[32:35], s74 offen offset:0 sc1
  ds_read_b64_tr_b16 v[220:221], v13 offset:16384
  ds_read_b64_tr_b16 v[222:223], v13 offset:16896
  v_mfma_f32_32x32x16_bf16 v[192:207], v[228:231], v[72:75], v[192:207]
  buffer_load_dwordx4 v[132:135], v15, s[32:35], s74 offen offset:1024 sc1
  ds_read_b64_tr_b16 v[224:225], v10 offset:18432
  ds_read_b64_tr_b16 v[226:227], v10 offset:18944
  s_waitcnt lgkmcnt(6)
  v_mfma_f32_32x32x16_bf16 v[176:191], v[208:211], v[76:79], v[176:191]
  buffer_load_dwordx4 v[136:139], v15, s[32:35], s74 offen offset:2048 sc1
  ds_read_b64_tr_b16 v[228:229], v13 offset:18432
  ds_read_b64_tr_b16 v[230:231], v13 offset:18944
  v_mfma_f32_32x32x16_bf16 v[192:207], v[212:215], v[76:79], v[192:207]
  buffer_load_dwordx4 v[140:143], v15, s[32:35], s74 offen offset:3072 sc1
  s_mul_i32 s54, s4, 6144
  s_add_u32 s57, s4, 31
  s_add_u32 s54, s54, s21
  s_and_b32 s57, s57, 31
  s_mul_i32 s57, s57, 6144
  s_add_u32 s57, s57, s21
  s_setprio 2
  ds_read_b64_tr_b16 v[208:209], v10 offset:20480
  ds_read_b64_tr_b16 v[210:211], v10 offset:20992
  s_waitcnt lgkmcnt(6)
  v_mfma_f32_32x32x16_bf16 v[176:191], v[216:219], v[80:83], v[176:191]
  s_add_u32 s4, s4, 4
  s_and_b32 s4, s4, 31
  ds_read_b64_tr_b16 v[212:213], v13 offset:20480
  ds_read_b64_tr_b16 v[214:215], v13 offset:20992
  v_mfma_f32_32x32x16_bf16 v[192:207], v[220:223], v[80:83], v[192:207]
  s_cmp_eq_u32 s23, 0
  s_cselect_b32 s54, 2130706432, s54
  s_cmp_lt_u32 s23, 2
  s_cselect_b32 s57, 2130706432, s57
  ds_read_b64_tr_b16 v[216:217], v10 offset:22528
  ds_read_b64_tr_b16 v[218:219], v10 offset:23040
  s_waitcnt lgkmcnt(6)
  v_mfma_f32_32x32x16_bf16 v[176:191], v[224:227], v[84:87], v[176:191]
  s_bitcmp1_b32 s54, 30
  s_cselect_b32 m0, 0x30000, s5
  s_nop 0
  buffer_load_dwordx4 v15, s[32:35], s54 offen offset:0 sc1 lds
  ds_read_b64_tr_b16 v[220:221], v13 offset:22528
  ds_read_b64_tr_b16 v[222:223], v13 offset:23040
  v_mfma_f32_32x32x16_bf16 v[192:207], v[228:231], v[84:87], v[192:207]
  s_bitcmp1_b32 s54, 30
  s_cselect_b32 m0, 0x30000, s5
  s_nop 0
  buffer_load_dwordx4 v15, s[32:35], s54 offen offset:1024 sc1 lds
  s_setprio 1
  ds_read_b64_tr_b16 v[224:225], v9 offset:32768
  ds_read_b64_tr_b16 v[226:227], v9 offset:33280
  s_waitcnt lgkmcnt(6)
  v_mfma_f32_32x32x16_bf16 v[176:191], v[208:211], v[88:91], v[176:191]
  s_bitcmp1_b32 s57, 30
  s_cselect_b32 m0, 0x30000, s5
  s_nop 0
  buffer_load_dwordx4 v15, s[32:35], s57 offen offset:2048 sc1 lds
  ds_read_b64_tr_b16 v[228:229], v12 offset:32768
  ds_read_b64_tr_b16 v[230:231], v12 offset:33280
  v_mfma_f32_32x32x16_bf16 v[192:207], v[212:215], v[88:91], v[192:207]
  s_bitcmp1_b32 s57, 30
  s_cselect_b32 m0, 0x30000, s5
  s_nop 0
  buffer_load_dwordx4 v15, s[32:35], s57 offen offset:3072 sc1 lds
  ds_read_b64_tr_b16 v[208:209], v9 offset:34816
  ds_read_b64_tr_b16 v[210:211], v9 offset:35328
  s_waitcnt lgkmcnt(6)
  v_mfma_f32_32x32x16_bf16 v[176:191], v[216:219], v[92:95], v[176:191]
  s_add_u32 s5, s5, 16384
  s_sub_u32 s54, s5, 49152
  ds_read_b64_tr_b16 v[212:213], v12 offset:34816
  ds_read_b64_tr_b16 v[214:215], v12 offset:35328
  v_mfma_f32_32x32x16_bf16 v[192:207], v[220:223], v[92:95], v[192:207]
  s_cmp_ge_i32 s54, s22
  s_cselect_b32 s5, s54, s5
  s_setprio 0
  ds_read_b64_tr_b16 v[216:217], v9 offset:36864
  ds_read_b64_tr_b16 v[218:219], v9 offset:37376
  s_waitcnt lgkmcnt(6)
  v_mfma_f32_32x32x16_bf16 v[176:191], v[224:227], v[96:99], v[176:191]
  ds_read_b64_tr_b16 v[220:221], v12 offset:36864
  ds_read_b64_tr_b16 v[222:223], v12 offset:37376
  v_mfma_f32_32x32x16_bf16 v[192:207], v[228:231], v[96:99], v[192:207]
  ds_read_b64_tr_b16 v[224:225], v9 offset:38912
  ds_read_b64_tr_b16 v[226:227], v9 offset:39424
  s_waitcnt lgkmcnt(6)
  v_mfma_f32_32x32x16_bf16 v[176:191], v[208:211], v[100:103], v[176:191]
  ds_read_b64_tr_b16 v[228:229], v12 offset:38912
  ds_read_b64_tr_b16 v[230:231], v12 offset:39424
  v_mfma_f32_32x32x16_bf16 v[192:207], v[212:215], v[100:103], v[192:207]
  s_waitcnt vmcnt(8)
  s_barrier
  s_setprio 3
  ds_read_b64_tr_b16 v[208:209], v9 offset:49152
  ds_read_b64_tr_b16 v[210:211], v9 offset:49664
  s_waitcnt lgkmcnt(6)
  v_mfma_f32_32x32x16_bf16 v[176:191], v[216:219], v[104:107], v[176:191]
  s_mov_b64 exec, 1
  buffer_store_dwordx2 v[240:241], v247, s[32:35], s15 offen offset:0 sc1
  s_mov_b64 exec, -1
  ds_read_b64_tr_b16 v[212:213], v12 offset:49152
  ds_read_b64_tr_b16 v[214:215], v12 offset:49664
  v_mfma_f32_32x32x16_bf16 v[192:207], v[220:223], v[104:107], v[192:207]
  s_mul_i32 s54, s4, 6144
  s_add_u32 s57, s4, 31
  s_add_u32 s54, s54, s21
  s_and_b32 s57, s57, 31
  s_mul_i32 s57, s57, 6144
  s_add_u32 s57, s57, s21
  s_add_u32 s4, s4, 4
  ds_read_b64_tr_b16 v[216:217], v9 offset:51200
  ds_read_b64_tr_b16 v[218:219], v9 offset:51712
  s_waitcnt lgkmcnt(6)
  v_mfma_f32_32x32x16_bf16 v[176:191], v[224:227], v[108:111], v[176:191]
  s_and_b32 s4, s4, 31
  s_mov_b32 m0, s5
  s_nop 0
  buffer_load_dwordx4 v15, s[32:35], s54 offen offset:0 sc1 lds
  s_setprio 2
  ds_read_b64_tr_b16 v[220:221], v12 offset:51200
  ds_read_b64_tr_b16 v[222:223], v12 offset:51712
  v_mfma_f32_32x32x16_bf16 v[192:207], v[228:231], v[108:111], v[192:207]
  s_mov_b32 m0, s5
  s_nop 0
  buffer_load_dwordx4 v15, s[32:35], s54 offen offset:1024 sc1 lds
  ds_read_b64_tr_b16 v[224:225], v9 offset:53248
  ds_read_b64_tr_b16 v[226:227], v9 offset:53760
  s_waitcnt lgkmcnt(6)
  v_mfma_f32_32x32x16_bf16 v[176:191], v[208:211], v[112:115], v[176:191]
  s_mov_b32 m0, s5
  s_nop 0
  buffer_load_dwordx4 v15, s[32:35], s57 offen offset:2048 sc1 lds
  ds_read_b64_tr_b16 v[228:229], v12 offset:53248
  ds_read_b64_tr_b16 v[230:231], v12 offset:53760
  v_mfma_f32_32x32x16_bf16 v[192:207], v[212:215], v[112:115], v[192:207]
  s_mov_b32 m0, s5
  s_nop 0
  buffer_load_dwordx4 v15, s[32:35], s57 offen offset:3072 sc1 lds
  s_add_u32 s5, s5, 16384
  s_sub_u32 s54, s5, 49152
  s_cmp_ge_i32 s54, s22
  s_cselect_b32 s5, s54, s5
  s_mul_i32 s54, s4, 6144
  s_setprio 1
  ds_read_b64_tr_b16 v[208:209], v9 offset:55296
  ds_read_b64_tr_b16 v[210:211], v9 offset:55808
  s_waitcnt lgkmcnt(6)
  v_mfma_f32_32x32x16_bf16 v[176:191], v[216:219], v[116:119], v[176:191]
  s_add_u32 s57, s4, 31
  s_add_u32 s54, s54, s21
  s_and_b32 s57, s57, 31
  s_mul_i32 s57, s57, 6144
  s_add_u32 s57, s57, s21
  s_add_u32 s4, s4, 4
  ds_read_b64_tr_b16 v[212:213], v12 offset:55296
  ds_read_b64_tr_b16 v[214:215], v12 offset:55808
  v_mfma_f32_32x32x16_bf16 v[192:207], v[220:223], v[116:119], v[192:207]
  s_and_b32 s4, s4, 31
  s_mov_b32 m0, s5
  s_nop 0
  buffer_load_dwordx4 v15, s[32:35], s54 offen offset:0 sc1 lds
  s_waitcnt lgkmcnt(4)
  v_mfma_f32_32x32x16_bf16 v[176:191], v[224:227], v[120:123], v[176:191]
  s_mov_b32 m0, s5
  s_nop 0
  buffer_load_dwordx4 v15, s[32:35], s54 offen offset:1024 sc1 lds
  s_setprio 0
  v_mfma_f32_32x32x16_bf16 v[192:207], v[228:231], v[120:123], v[192:207]
  s_mov_b32 m0, s5
  s_nop 0
  buffer_load_dwordx4 v15, s[32:35], s57 offen offset:2048 sc1 lds
  s_waitcnt lgkmcnt(0)
  v_mfma_f32_32x32x16_bf16 v[176:191], v[208:211], v[124:127], v[176:191]
  s_mov_b32 m0, s5
  s_nop 0
  buffer_load_dwordx4 v15, s[32:35], s57 offen offset:3072 sc1 lds
  v_mfma_f32_32x32x16_bf16 v[192:207], v[212:215], v[124:127], v[192:207]
  s_add_u32 s5, s5, 16384
  s_sub_u32 s54, s5, 49152
  s_cmp_ge_i32 s54, s22
  s_cselect_b32 s5, s54, s5
  s_nop 3
  v_mul_f32 v236, v176, v176
  v_mul_f32 v237, v177, v177
  v_mul_f32 v238, v178, v178
  v_mul_f32 v239, v179, v179
  v_fma_f32 v236, v236, v250, v249
  v_fma_f32 v237, v237, v250, v249
  v_fma_f32 v238, v238, v250, v249
  v_fma_f32 v239, v239, v250, v249
  v_mul_f32 v236, v236, v176
  v_mul_f32 v237, v237, v177
  v_mul_f32 v238, v238, v178
  v_mul_f32 v239, v239, v179
  v_exp_f32 v236, v236
  v_exp_f32 v237, v237
  v_exp_f32 v238, v238
  v_exp_f32 v239, v239
  v_mul_f32 v176, v176, v184
  v_mul_f32 v177, v177, v185
  v_mul_f32 v178, v178, v186
  v_mul_f32 v179, v179, v187
  v_fma_f32 v236, v236, v251, v251
  v_fma_f32 v237, v237, v251, v251
  v_fma_f32 v238, v238, v251, v251
  v_fma_f32 v239, v239, v251, v251
  v_rcp_f32 v236, v236
  v_rcp_f32 v237, v237
  v_rcp_f32 v238, v238
  v_rcp_f32 v239, v239
  v_mul_f32 v176, v176, v236
  v_mul_f32 v177, v177, v237
  v_mul_f32 v178, v178, v238
  v_mul_f32 v179, v179, v239
  v_mul_f32 v236, v180, v180
  v_mul_f32 v237, v181, v181
  v_mul_f32 v238, v182, v182
  v_mul_f32 v239, v183, v183
  v_fma_f32 v236, v236, v250, v249
  v_fma_f32 v237, v237, v250, v249
  v_fma_f32 v238, v238, v250, v249
  v_fma_f32 v239, v239, v250, v249
  v_mul_f32 v236, v236, v180
  v_mul_f32 v237, v237, v181
  v_mul_f32 v238, v238, v182
  v_mul_f32 v239, v239, v183
  v_exp_f32 v236, v236
  v_exp_f32 v237, v237
  v_exp_f32 v238, v238
  v_exp_f32 v239, v239
  v_mul_f32 v180, v180, v188
  v_mul_f32 v181, v181, v189
  v_mul_f32 v182, v182, v190
  v_mul_f32 v183, v183, v191
  v_fma_f32 v236, v236, v251, v251
  v_fma_f32 v237, v237, v251, v251
  v_fma_f32 v238, v238, v251, v251
  v_fma_f32 v239, v239, v251, v251
  v_rcp_f32 v236, v236
  v_rcp_f32 v237, v237
  v_rcp_f32 v238, v238
  v_rcp_f32 v239, v239
  v_mul_f32 v180, v180, v236
  v_mul_f32 v181, v181, v237
  v_mul_f32 v182, v182, v238
  s_mov_b32 s28, s16
  v_mul_f32 v183, v183, v239
  v_cvt_pk_bf16_f32 v184, v176, v177
  s_mov_b32 s29, s17
  v_cvt_pk_bf16_f32 v185, v178, v179
  v_cvt_pk_bf16_f32 v186, v180, v181
  s_mov_b32 s30, 1605632
  v_cvt_pk_bf16_f32 v187, v182, v183
  buffer_store_dwordx4 v[184:187], v15, s[32:35], s14 offen offset:0 sc1
  s_mov_b32 s31, 0x00020000
  v_mul_f32 v236, v192, v192
  v_mul_f32 v237, v193, v193
  s_mov_b32 s36, s18
  v_mul_f32 v238, v194, v194
  v_mul_f32 v239, v195, v195
  s_mov_b32 s37, s19
  v_fma_f32 v236, v236, v250, v249
  v_fma_f32 v237, v237, v250, v249
  v_fma_f32 v238, v238, v250, v249
  s_mov_b32 s38, 1835008
  v_fma_f32 v239, v239, v250, v249
  v_mul_f32 v236, v236, v192
  s_mov_b32 s39, 0x00020000
  v_mul_f32 v237, v237, v193
  v_mul_f32 v238, v238, v194
  s_cmp_lt_u32 s2, 224
  v_mul_f32 v239, v239, v195
  v_exp_f32 v236, v236
  s_cselect_b32 s65, 1, 0
  v_exp_f32 v237, v237
  v_exp_f32 v238, v238
  s_bfe_u32 s55, s2, 0x20003
  v_exp_f32 v239, v239
  v_mul_f32 v192, v192, v200
  s_lshr_b32 s56, s2, 5
  v_mul_f32 v193, v193, v201
  v_mul_f32 v194, v194, v202
  v_mul_f32 v195, v195, v203
  s_lshl_b32 s66, s55, 1
  v_fma_f32 v236, v236, v251, v251
  v_fma_f32 v237, v237, v251, v251
  s_add_u32 s66, s66, s56
  v_fma_f32 v238, v238, v251, v251
  v_fma_f32 v239, v239, v251, v251
  s_add_u32 s62, s55, s56
  v_rcp_f32 v236, v236
  v_rcp_f32 v237, v237
  s_and_b32 s62, s62, 3
  v_rcp_f32 v238, v238
  v_rcp_f32 v239, v239
  s_sub_u32 s56, s66, 10
  v_mul_f32 v192, v192, v236
  v_mul_f32 v193, v193, v237
  s_cmp_ge_u32 s66, 10
  v_mul_f32 v194, v194, v238
  v_mul_f32 v195, v195, v239
  v_mul_f32 v236, v196, v196
  s_cselect_b32 s66, s56, s66
  v_mul_f32 v237, v197, v197
  v_mul_f32 v238, v198, v198
  s_sub_u32 s56, s66, 10
  v_mul_f32 v239, v199, v199
  v_fma_f32 v236, v236, v250, v249
  s_cmp_ge_u32 s66, 10
  v_fma_f32 v237, v237, v250, v249
  v_fma_f32 v238, v238, v250, v249
  s_cselect_b32 s66, s56, s66
  v_fma_f32 v239, v239, v250, v249
  v_mul_f32 v236, v236, v196
  s_add_u32 s66, s66, 4
  v_mul_f32 v237, v237, v197
  v_mul_f32 v238, v238, v198
  s_lshl_b32 s63, s62, 3
  v_mul_f32 v239, v239, v199
  v_exp_f32 v236, v236
  v_exp_f32 v237, v237
  s_add_u32 s63, s63, s3
  v_exp_f32 v238, v238
  v_exp_f32 v239, v239
  s_mul_i32 s63, s63, 14336
  v_mul_f32 v196, v196, v204
  v_mul_f32 v197, v197, v205
  s_add_u32 s63, s63, s78
  v_mul_f32 v198, v198, v206
  v_mul_f32 v199, v199, v207
  s_lshl_b32 s62, s62, 13
  v_fma_f32 v236, v236, v251, v251
  v_fma_f32 v237, v237, v251, v251
  s_mul_i32 s61, s77, 294912
  v_fma_f32 v238, v238, v251, v251
  v_fma_f32 v239, v239, v251, v251
  s_add_u32 s61, s61, 8388608
  v_rcp_f32 v236, v236
  v_rcp_f32 v237, v237
  v_rcp_f32 v238, v238
  s_lshl_b32 s55, s3, 10
  v_rcp_f32 v239, v239
  v_mul_f32 v196, v196, v236
  s_add_u32 s61, s61, s55
  v_mul_f32 v197, v197, v237
  v_mul_f32 v198, v198, v238
  s_add_u32 s62, s62, s61
  v_mul_f32 v199, v199, v239
  v_cvt_pk_bf16_f32 v200, v192, v193
  s_lshl_b32 s64, s3, 13
  v_cvt_pk_bf16_f32 v201, v194, v195
  v_cvt_pk_bf16_f32 v202, v196, v197
  s_add_u32 s64, s64, 98304
  v_cvt_pk_bf16_f32 v203, v198, v199
  buffer_store_dwordx4 v[200:203], v15, s[32:35], s14 offen offset:1024 sc1
  s_mov_b32 s60, 0
  s_branch L_fin
L_p1C:
  ds_read_b128 v[16:19], v236 offset:0
  ds_read_b64_tr_b16 v[208:209], v6 offset:49152
  ds_read_b64_tr_b16 v[210:211], v6 offset:49664
  ds_read_b128 v[20:23], v237 offset:0
  ds_read_b64_tr_b16 v[212:213], v6 offset:51200
  ds_read_b64_tr_b16 v[214:215], v6 offset:51712
  ds_read_b128 v[24:27], v238 offset:0
  ds_read_b64_tr_b16 v[216:217], v6 offset:53248
  ds_read_b64_tr_b16 v[218:219], v6 offset:53760
  ds_read_b128 v[28:31], v239 offset:0
  ds_read_b64_tr_b16 v[220:221], v6 offset:55296
  ds_read_b64_tr_b16 v[222:223], v6 offset:55808
  ds_read_b128 v[32:35], v236 offset:16384
  ds_read_b128 v[36:39], v237 offset:16384
  ds_read_b128 v[40:43], v238 offset:16384
  ds_read_b128 v[44:47], v239 offset:16384
  s_setprio 3
  ds_read_b64_tr_b16 v[224:225], v6 offset:57344
  ds_read_b64_tr_b16 v[226:227], v6 offset:57856
  s_waitcnt lgkmcnt(15)
  v_mfma_f32_32x32x16_bf16 v[128:143], v[208:211], v[16:19], 0
  ds_read_b64_tr_b16 v[228:229], v6 offset:59392
  ds_read_b64_tr_b16 v[230:231], v6 offset:59904
  s_waitcnt lgkmcnt(14)
  v_mfma_f32_32x32x16_bf16 v[128:143], v[212:215], v[20:23], v[128:143]
  s_setprio 2
  ds_read_b64_tr_b16 v[208:209], v6 offset:61440
  ds_read_b64_tr_b16 v[210:211], v6 offset:61952
  s_waitcnt lgkmcnt(13)
  v_mfma_f32_32x32x16_bf16 v[128:143], v[216:219], v[24:27], v[128:143]
  s_waitcnt lgkmcnt(6)
  s_barrier
  ds_read_b64_tr_b16 v[212:213], v6 offset:63488
  ds_read_b64_tr_b16 v[214:215], v6 offset:64000
  ds_read_b128 v[48:51], v236 offset:32768
  ds_read_b128 v[52:55], v237 offset:32768
  ds_read_b128 v[56:59], v238 offset:32768
  v_mfma_f32_32x32x16_bf16 v[128:143], v[220:223], v[28:31], v[128:143]
  s_add_u32 m0, s59, 8192
  s_nop 0
  buffer_load_dwordx4 v2, s[28:31], s66 offen lds
  s_add_u32 s28, s28, 896
  s_addc_u32 s29, s29, 0
  s_setprio 1
  ds_read_b64_tr_b16 v[216:217], v7 offset:0
  ds_read_b64_tr_b16 v[218:219], v7 offset:512
  ds_read_b128 v[60:63], v239 offset:32768
  ds_read_b128 v[64:67], v236 offset:49152
  ds_read_b128 v[68:71], v237 offset:49152
  s_waitcnt lgkmcnt(14)
  v_mfma_f32_32x32x16_bf16 v[128:143], v[224:227], v[32:35], v[128:143]
  s_sub_u32 s30, s30, 896
  s_add_u32 m0, s59, 16384
  ds_read_b64_tr_b16 v[220:221], v7 offset:2048
  ds_read_b64_tr_b16 v[222:223], v7 offset:2560
  ds_read_b128 v[72:75], v238 offset:49152
  ds_read_b128 v[76:79], v239 offset:49152
  v_add_u32 v236, 65536, v236
  v_add_u32 v237, 65536, v237
  v_add_u32 v238, 65536, v238
  v_add_u32 v239, 65536, v239
  ds_read_b128 v[80:83], v236 offset:0
  s_waitcnt lgkmcnt(15)
  v_mfma_f32_32x32x16_bf16 v[128:143], v[228:231], v[36:39], v[128:143]
  buffer_load_dwordx4 v2, s[28:31], s60 offen lds
  s_add_u32 m0, s59, 24576
  ds_write_b32 v234, v235
  s_setprio 0
  ds_read_b64_tr_b16 v[224:225], v7 offset:4096
  ds_read_b64_tr_b16 v[226:227], v7 offset:4608
  ds_read_b128 v[84:87], v237 offset:0
  ds_read_b128 v[88:91], v238 offset:0
  ds_read_b128 v[92:95], v239 offset:0
  v_mfma_f32_32x32x16_bf16 v[128:143], v[208:211], v[40:43], v[128:143]
  buffer_load_dwordx4 v2, s[28:31], s61 offen lds
  ds_write_b32 v234, v244 offset:32
  s_mov_b32 s10, s77
  s_lshl_b32 s54, s74, 2
  s_add_u32 s77, s77, s54
  s_lshl_b32 s54, s75, 1
  ds_read_b64_tr_b16 v[228:229], v7 offset:6144
  ds_read_b64_tr_b16 v[230:231], v7 offset:6656
  ds_read_b128 v[96:99], v236 offset:16384
  ds_read_b128 v[100:103], v237 offset:16384
  ds_read_b128 v[104:107], v238 offset:16384
  s_waitcnt lgkmcnt(15)
  v_mfma_f32_32x32x16_bf16 v[128:143], v[212:215], v[44:47], v[128:143]
  s_add_u32 s54, s54, s52
  s_lshl_b32 s11, s54, 6
  s_add_u32 s11, s11, s77
  s_mul_i32 s11, s11, 3
  s_add_u32 s11, s11, s53
  s_lshl_b32 s11, s11, 11
  s_mul_i32 s12, s75, 3
  s_waitcnt lgkmcnt(6)
  s_waitcnt vmcnt(8)
  s_barrier
  s_setprio 3
  ds_read_b64_tr_b16 v[208:209], v7 offset:8192
  ds_read_b64_tr_b16 v[210:211], v7 offset:8704
  ds_read_b128 v[108:111], v239 offset:16384
  ds_read_b128 v[112:115], v236 offset:32768
  ds_read_b128 v[116:119], v237 offset:32768
  v_mfma_f32_32x32x16_bf16 v[128:143], v[216:219], v[48:51], v[128:143]
  s_add_u32 m0, s59, 32768
  s_nop 0
  buffer_load_dwordx4 v2, s[28:31], s62 offen lds
  s_add_u32 m0, s59, 40960
  s_add_u32 s12, s12, s53
  s_lshl_b32 s12, s12, 4
  s_add_u32 s12, s12, s74
  ds_read_b64_tr_b16 v[212:213], v7 offset:10240
  ds_read_b64_tr_b16 v[214:215], v7 offset:10752
  ds_read_b128 v[120:123], v238 offset:32768
  ds_read_b128 v[124:127], v239 offset:32768
  v_mfma_f32_32x32x16_bf16 v[128:143], v[220:223], v[52:55], v[128:143]
  buffer_load_dwordx4 v2, s[28:31], s63 offen lds
  s_add_u32 m0, s59, 49152
  s_lshl_b32 s12, s12, 3
  s_add_u32 s12, s12, 25165824
  s_lshl_b32 s15, s74, 5
  s_add_u32 s15, s15, s75
  s_lshl_b32 s15, s15, 3
  ds_read_b64_tr_b16 v[216:217], v7 offset:12288
  ds_read_b64_tr_b16 v[218:219], v7 offset:12800
  v_mfma_f32_32x32x16_bf16 v[128:143], v[224:227], v[56:59], v[128:143]
  buffer_load_dwordx4 v2, s[28:31], s64 offen lds
  s_add_u32 s15, s15, 25231360
  s_lshl_b32 s20, s53, 6
  s_add_u32 s20, s20, s15
  s_add_u32 s20, s20, 128
  s_cmp_eq_u32 s3, 0
  s_cselect_b32 s12, s12, 0x7f000000
  s_cselect_b32 s15, s15, 0x7f000000
  s_cselect_b32 s20, s20, 0x7f000000
  s_setprio 2
  ds_read_b64_tr_b16 v[220:221], v7 offset:14336
  ds_read_b64_tr_b16 v[222:223], v7 offset:14848
  s_waitcnt lgkmcnt(15)
  v_mfma_f32_32x32x16_bf16 v[128:143], v[228:231], v[60:63], v[128:143]
  s_mul_i32 s54, s77, 144
  s_add_u32 s13, s54, s4
  s_lshl_b32 s13, s13, 10
  ds_read_b64_tr_b16 v[224:225], v7 offset:16384
  ds_read_b64_tr_b16 v[226:227], v7 offset:16896
  s_waitcnt lgkmcnt(13)
  v_mfma_f32_32x32x16_bf16 v[128:143], v[208:211], v[64:67], v[128:143]
  s_add_u32 m0, s59, 57344
  s_nop 0
  buffer_load_dwordx4 v2, s[28:31], s65 offen lds
  ds_read_b64_tr_b16 v[228:229], v7 offset:18432
  ds_read_b64_tr_b16 v[230:231], v7 offset:18944
  s_waitcnt lgkmcnt(10)
  v_mfma_f32_32x32x16_bf16 v[128:143], v[212:215], v[68:71], v[128:143]
  s_add_u32 s13, s13, 8388608
  s_add_u32 s14, s54, s5
  s_lshl_b32 s14, s14, 10
  s_setprio 1
  ds_read_b64_tr_b16 v[208:209], v7 offset:20480
  ds_read_b64_tr_b16 v[210:211], v7 offset:20992
  s_waitcnt lgkmcnt(8)
  v_mfma_f32_32x32x16_bf16 v[128:143], v[216:219], v[72:75], v[128:143]
  s_add_u32 s14, s14, 8388608
  s_mov_b32 s58, 262144
  ds_read_b64_tr_b16 v[212:213], v7 offset:22528
  ds_read_b64_tr_b16 v[214:215], v7 offset:23040
  s_waitcnt lgkmcnt(8)
  v_mfma_f32_32x32x16_bf16 v[128:143], v[220:223], v[76:79], v[128:143]
  buffer_load_dwordx2 v[240:241], v247, s[44:47], 0 offen sc1
  ds_read_b32 v251, v246
  ds_read_b64_tr_b16 v[216:217], v7 offset:24576
  ds_read_b64_tr_b16 v[218:219], v7 offset:25088
  s_waitcnt lgkmcnt(9)
  v_mfma_f32_32x32x16_bf16 v[128:143], v[224:227], v[80:83], v[128:143]
  s_add_u32 m0, s59, 65536
  s_nop 0
  buffer_load_dwordx4 v2, s[28:31], s66 offen lds
  s_setprio 0
  ds_read_b64_tr_b16 v[220:221], v7 offset:26624
  ds_read_b64_tr_b16 v[222:223], v7 offset:27136
  s_waitcnt lgkmcnt(9)
  v_mfma_f32_32x32x16_bf16 v[128:143], v[228:231], v[84:87], v[128:143]
  ds_read_b64_tr_b16 v[224:225], v7 offset:28672
  ds_read_b64_tr_b16 v[226:227], v7 offset:29184
  s_waitcnt lgkmcnt(9)
  v_mfma_f32_32x32x16_bf16 v[128:143], v[208:211], v[88:91], v[128:143]
  ds_read_b64_tr_b16 v[228:229], v7 offset:30720
  ds_read_b64_tr_b16 v[230:231], v7 offset:31232
  s_waitcnt lgkmcnt(9)
  v_mfma_f32_32x32x16_bf16 v[128:143], v[212:215], v[92:95], v[128:143]
  s_waitcnt vmcnt(6)
  s_barrier
  s_setprio 3
  ds_read_b64_tr_b16 v[208:209], v5 offset:8192
  ds_read_b64_tr_b16 v[210:211], v5 offset:8704
  s_waitcnt lgkmcnt(8)
  v_mfma_f32_32x32x16_bf16 v[128:143], v[216:219], v[96:99], v[128:143]
  s_add_u32 m0, s59, 73728
  s_nop 0
  buffer_load_dwordx4 v3, s[36:39], s67 offen lds
  ds_read_b64_tr_b16 v[212:213], v5 offset:10240
  ds_read_b64_tr_b16 v[214:215], v5 offset:10752
  s_waitcnt lgkmcnt(8)
  v_mfma_f32_32x32x16_bf16 v[128:143], v[220:223], v[100:103], v[128:143]
  s_add_u32 m0, s59, 81920
  s_nop 0
  buffer_load_dwordx4 v4, s[40:43], s67 offen lds
  v_rsq_f32 v248, v251
  ds_read_b64_tr_b16 v[216:217], v5 offset:12288
  ds_read_b64_tr_b16 v[218:219], v5 offset:12800
  s_waitcnt lgkmcnt(8)
  v_mfma_f32_32x32x16_bf16 v[128:143], v[224:227], v[104:107], v[128:143]
  v_mul_f32 v249, 3222493025, v248
  v_mul_f32 v250, v248, v248
  s_setprio 2
  ds_read_b64_tr_b16 v[220:221], v5 offset:14336
  ds_read_b64_tr_b16 v[222:223], v5 offset:14848
  s_waitcnt lgkmcnt(8)
  v_mfma_f32_32x32x16_bf16 v[128:143], v[228:231], v[108:111], v[128:143]
  v_mul_f32 v250, v250, v248
  v_mul_f32 v250, 3184710632, v250
  ds_read_b64_tr_b16 v[224:225], v5 offset:16384
  ds_read_b64_tr_b16 v[226:227], v5 offset:16896
  s_waitcnt lgkmcnt(8)
  v_mfma_f32_32x32x16_bf16 v[128:143], v[208:211], v[112:115], v[128:143]
  ds_read_b64_tr_b16 v[228:229], v5 offset:18432
  ds_read_b64_tr_b16 v[230:231], v5 offset:18944
  s_waitcnt lgkmcnt(8)
  v_mfma_f32_32x32x16_bf16 v[128:143], v[212:215], v[116:119], v[128:143]
  s_setprio 1
  ds_read_b64_tr_b16 v[208:209], v5 offset:20480
  ds_read_b64_tr_b16 v[210:211], v5 offset:20992
  s_waitcnt lgkmcnt(8)
  v_mfma_f32_32x32x16_bf16 v[128:143], v[216:219], v[120:123], v[128:143]
  ds_read_b64_tr_b16 v[212:213], v5 offset:22528
  ds_read_b64_tr_b16 v[214:215], v5 offset:23040
  s_waitcnt lgkmcnt(8)
  v_mfma_f32_32x32x16_bf16 v[128:143], v[220:223], v[124:127], v[128:143]
  ds_read_b64_tr_b16 v[216:217], v5 offset:24576
  ds_read_b64_tr_b16 v[218:219], v5 offset:25088
  s_waitcnt lgkmcnt(6)
  v_mfma_f32_32x32x16_bf16 v[144:159], v[224:227], v[16:19], 0
  s_add_u32 m0, s59, 90112
  s_nop 0
  buffer_load_dwordx4 v3, s[36:39], s68 offen lds
  s_setprio 0
  ds_read_b64_tr_b16 v[220:221], v5 offset:26624
  ds_read_b64_tr_b16 v[222:223], v5 offset:27136
  v_mfma_f32_32x32x16_bf16 v[144:159], v[228:231], v[20:23], v[144:159]
  s_add_u32 m0, s59, 98304
  s_nop 0
  buffer_load_dwordx4 v4, s[40:43], s68 offen lds
  v_and_b32 v235, 0x3f803f80, v253
  ds_read_b64_tr_b16 v[224:225], v5 offset:28672
  ds_read_b64_tr_b16 v[226:227], v5 offset:29184
  s_waitcnt lgkmcnt(6)
  v_mfma_f32_32x32x16_bf16 v[144:159], v[208:211], v[24:27], v[144:159]
  v_mul_f32 v128, v128, v248
  v_mul_f32 v129, v129, v248
  v_cvt_pk_bf16_f32 v128, v128, v129
  v_mul_f32 v130, v130, v248
  v_mul_f32 v131, v131, v248
  v_cvt_pk_bf16_f32 v129, v130, v131
  ds_read_b64_tr_b16 v[228:229], v5 offset:30720
  ds_read_b64_tr_b16 v[230:231], v5 offset:31232
  v_mfma_f32_32x32x16_bf16 v[144:159], v[212:215], v[28:31], v[144:159]
  v_mul_f32 v132, v132, v248
  v_mul_f32 v133, v133, v248
  v_cvt_pk_bf16_f32 v130, v132, v133
  v_mul_f32 v134, v134, v248
  v_mul_f32 v135, v135, v248
  v_cvt_pk_bf16_f32 v131, v134, v135
  buffer_store_dwordx4 v[128:131], v15, s[32:35], s11 offen offset:0 sc1
  s_waitcnt vmcnt(8)
  s_barrier
  s_setprio 3
  ds_read_b64_tr_b16 v[208:209], v5 offset:32768
  ds_read_b64_tr_b16 v[210:211], v5 offset:33280
  s_waitcnt lgkmcnt(6)
  v_mfma_f32_32x32x16_bf16 v[144:159], v[216:219], v[32:35], v[144:159]
  v_mul_f32 v136, v136, v248
  v_mul_f32 v137, v137, v248
  v_cvt_pk_bf16_f32 v132, v136, v137
  v_mul_f32 v138, v138, v248
  v_mul_f32 v139, v139, v248
  v_cvt_pk_bf16_f32 v133, v138, v139
  ds_read_b64_tr_b16 v[212:213], v5 offset:34816
  ds_read_b64_tr_b16 v[214:215], v5 offset:35328
  v_mfma_f32_32x32x16_bf16 v[144:159], v[220:223], v[36:39], v[144:159]
  v_mul_f32 v140, v140, v248
  v_mul_f32 v141, v141, v248
  v_cvt_pk_bf16_f32 v134, v140, v141
  v_mul_f32 v142, v142, v248
  v_mul_f32 v143, v143, v248
  v_cvt_pk_bf16_f32 v135, v142, v143
  v_and_or_b32 v134, v134, v252, v235
  ds_read_b64_tr_b16 v[216:217], v5 offset:36864
  ds_read_b64_tr_b16 v[218:219], v5 offset:37376
  s_waitcnt lgkmcnt(6)
  v_mfma_f32_32x32x16_bf16 v[144:159], v[224:227], v[40:43], v[144:159]
  v_and_or_b32 v135, v135, v252, v235
  buffer_store_dwordx4 v[132:135], v15, s[32:35], s11 offen offset:1024 sc1
  v_and_b32 v236, 2, v232
  v_and_b32 v237, 3, v233
  v_xor_b32 v236, v236, v237
  v_mul_u32_u24 v232, 3584, v232
  s_setprio 2
  ds_read_b64_tr_b16 v[220:221], v5 offset:38912
  ds_read_b64_tr_b16 v[222:223], v5 offset:39424
  v_mfma_f32_32x32x16_bf16 v[144:159], v[228:231], v[44:47], v[144:159]
  v_lshl_add_u32 v232, v236, 4, v232
  s_lshl_b32 s54, s52, 5
  v_lshl_add_u32 v236, v237, 3, s54
  v_and_b32 v237, 8, v0
  v_lshlrev_b32 v237, 2, v237
  v_xor_b32 v236, v236, v237
  v_bfe_u32 v237, v0, 4, 1
  ds_read_b64_tr_b16 v[224:225], v5 offset:40960
  ds_read_b64_tr_b16 v[226:227], v5 offset:41472
  s_waitcnt lgkmcnt(6)
  v_mfma_f32_32x32x16_bf16 v[144:159], v[208:211], v[48:51], v[144:159]
  s_add_u32 m0, s59, 106496
  s_nop 0
  buffer_load_dwordx4 v3, s[36:39], s69 offen lds
  s_add_u32 m0, s59, 114688
  v_lshl_add_u32 v236, v237, 6, v236
  v_bfe_u32 v237, v0, 2, 2
  v_lshl_add_u32 v236, v237, 7, v236
  ds_read_b64_tr_b16 v[228:229], v5 offset:43008
  ds_read_b64_tr_b16 v[230:231], v5 offset:43520
  v_mfma_f32_32x32x16_bf16 v[144:159], v[212:215], v[52:55], v[144:159]
  buffer_load_dwordx4 v4, s[40:43], s69 offen lds
  v_lshrrev_b32 v237, 5, v0
  v_lshl_add_u32 v236, v237, 10, v236
  v_add_u32 v233, 0x10000, v236
  v_add_u32 v234, 0x20000, v236
  s_mov_b32 s50, 0x0f0f0f0f
  s_mov_b32 s51, 0x0f0f0f0f
  s_setprio 1
  ds_read_b64_tr_b16 v[208:209], v5 offset:45056
  ds_read_b64_tr_b16 v[210:211], v5 offset:45568
  s_waitcnt lgkmcnt(6)
  v_mfma_f32_32x32x16_bf16 v[144:159], v[216:219], v[56:59], v[144:159]
  s_and_b32 s54, s2, 7
  s_lshl_b32 s55, s54, 1
  s_add_u32 s55, s55, s53
  s_bfe_u32 s56, s2, 0x40003
  s_lshl_b32 s56, s56, 2
  s_add_u32 s56, s56, s10
  ds_read_b64_tr_b16 v[212:213], v5 offset:47104
  ds_read_b64_tr_b16 v[214:215], v5 offset:47616
  v_mfma_f32_32x32x16_bf16 v[144:159], v[220:223], v[60:63], v[144:159]
  s_lshl_b32 s77, s54, 2
  s_bfe_u32 s54, s2, 0x20003
  s_add_u32 s77, s77, s54
  s_lshr_b32 s78, s2, 5
  s_lshl_b32 s78, s78, 7
  s_mul_i32 s21, s55, 393216
  s_mul_i32 s74, s56, 6144
  ds_read_b64_tr_b16 v[216:217], v5 offset:49152
  ds_read_b64_tr_b16 v[218:219], v5 offset:49664
  s_waitcnt lgkmcnt(6)
  v_mfma_f32_32x32x16_bf16 v[144:159], v[224:227], v[64:67], v[144:159]
L_non1_chk:
  s_waitcnt vmcnt(9)
  v_readfirstlane_b32 s48, v240
  s_nop 0
  s_cmp_lg_u32 s48, 0
  s_cbranch_scc0 L_non1_spin
L_non1_ok:
  s_add_u32 s74, s74, s21
  s_mul_i32 s54, s52, 196608
  s_add_u32 s21, s21, s54
  s_add_u32 s21, s21, 2048
  s_setprio 0
  ds_read_b64_tr_b16 v[220:221], v5 offset:51200
  ds_read_b64_tr_b16 v[222:223], v5 offset:51712
  v_mfma_f32_32x32x16_bf16 v[144:159], v[228:231], v[68:71], v[144:159]
  s_sub_u32 s23, s10, s52
  s_add_u32 s23, s23, 1
  s_mul_i32 s22, s52, 49152
  s_mul_i32 s75, s56, 144
  s_lshl_b32 s54, s55, 1
  s_add_u32 s75, s75, s54
  s_lshl_b32 s75, s75, 10
  ds_read_b64_tr_b16 v[224:225], v5 offset:53248
  ds_read_b64_tr_b16 v[226:227], v5 offset:53760
  s_waitcnt lgkmcnt(6)
  v_mfma_f32_32x32x16_bf16 v[144:159], v[208:211], v[72:75], v[144:159]
  s_add_u32 s75, s75, 8503296
  s_bfe_u32 s76, s2, 0x40003
  s_lshl_b32 s76, s76, 4
  s_add_u32 s76, s76, s55
  s_lshl_b32 s76, s76, 3
  s_add_u32 s76, s76, 25296896
  ds_read_b64_tr_b16 v[228:229], v5 offset:55296
  ds_read_b64_tr_b16 v[230:231], v5 offset:55808
  v_mfma_f32_32x32x16_bf16 v[144:159], v[212:215], v[76:79], v[144:159]
  s_cmp_eq_u32 s3, 0
  s_cselect_b32 s76, s76, 0x7f000000
  s_bfe_u32 s4, s2, 0x40003
  s_lshl_b32 s4, s4, 2
  s_add_u32 s4, s4, s23
  s_add_u32 s4, s4, 31
  s_and_b32 s4, s4, 31
  s_waitcnt vmcnt(2)
  s_barrier
  s_setprio 3
  ds_read_b64_tr_b16 v[208:209], v5 offset:57344
  ds_read_b64_tr_b16 v[210:211], v5 offset:57856
  s_waitcnt lgkmcnt(6)
  v_mfma_f32_32x32x16_bf16 v[144:159], v[216:219], v[80:83], v[144:159]
  s_mov_b64 exec, 1
  buffer_store_dwordx2 v[240:241], v247, s[32:35], s12 offen offset:0 sc1
  s_mov_b64 exec, -1
  s_add_u32 m0, s59, 16384
  s_sub_u32 s5, s23, 1
  s_cmp_eq_u32 s23, 0
  s_cselect_b32 s5, 11, s5
  ds_read_b64_tr_b16 v[212:213], v5 offset:59392
  ds_read_b64_tr_b16 v[214:215], v5 offset:59904
  v_mfma_f32_32x32x16_bf16 v[144:159], v[220:223], v[84:87], v[144:159]
  buffer_load_dwordx4 v3, s[36:39], s70 offen lds
  s_add_u32 m0, s59, 24576
  s_lshl_b32 s5, s5, 12
  s_add_u32 s5, s5, s22
  s_lshr_b32 s54, s55, 1
  s_mul_i32 s54, s54, 384
  s_add_u32 s54, s54, 25165824
  ds_read_b64_tr_b16 v[216:217], v5 offset:61440
  ds_read_b64_tr_b16 v[218:219], v5 offset:61952
  s_waitcnt lgkmcnt(6)
  v_mfma_f32_32x32x16_bf16 v[144:159], v[224:227], v[88:91], v[144:159]
  buffer_load_dwordx4 v4, s[40:43], s70 offen lds
  s_cmp_eq_u32 s3, 0
  s_cselect_b32 s54, s54, 0x7f000000
  v_min_u32 v236, 47, v0
  v_lshl_add_u32 v14, v236, 3, s54
  s_lshr_b32 s54, s77, 1
  ds_read_b64_tr_b16 v[220:221], v5 offset:63488
  ds_read_b64_tr_b16 v[222:223], v5 offset:64000
  v_mfma_f32_32x32x16_bf16 v[144:159], v[228:231], v[92:95], v[144:159]
  s_lshl_b32 s57, s54, 8
  s_add_u32 s57, s57, 25231360
  v_and_b32 v236, 31, v0
  v_lshrrev_b32 v237, 1, v236
  v_or_b32 v237, 23, v237
  v_and_b32 v236, v236, v237
  v_lshl_add_u32 v236, v236, 3, s57
  s_setprio 2
  ds_read_b64_tr_b16 v[224:225], v6 offset:0
  ds_read_b64_tr_b16 v[226:227], v6 offset:512
  s_waitcnt lgkmcnt(6)
  v_mfma_f32_32x32x16_bf16 v[144:159], v[208:211], v[96:99], v[144:159]
  s_lshl_b32 s54, s54, 7
  s_add_u32 s54, s54, 25296896
  ds_read_b64_tr_b16 v[228:229], v6 offset:2048
  ds_read_b64_tr_b16 v[230:231], v6 offset:2560
  v_mfma_f32_32x32x16_bf16 v[144:159], v[212:215], v[100:103], v[144:159]
  v_and_b32 v237, 15, v0
  v_lshl_add_u32 v237, v237, 3, s54
  v_bfi_b32 v1, v253, v237, v236
  ds_read_b64_tr_b16 v[208:209], v6 offset:4096
  ds_read_b64_tr_b16 v[210:211], v6 offset:4608
  s_waitcnt lgkmcnt(6)
  v_mfma_f32_32x32x16_bf16 v[144:159], v[216:219], v[104:107], v[144:159]
  s_cmp_lg_u32 s52, 0
  s_cselect_b64 vcc, -1, 0
  ds_read_b64_tr_b16 v[212:213], v6 offset:6144
  ds_read_b64_tr_b16 v[214:215], v6 offset:6656
  v_mfma_f32_32x32x16_bf16 v[144:159], v[220:223], v[108:111], v[144:159]
  s_cmp_lg_u32 s52, 0
  s_cselect_b32 s75, s75, 0x7f000000
  s_setprio 1
  ds_read_b64_tr_b16 v[216:217], v9 offset:8192
  ds_read_b64_tr_b16 v[218:219], v9 offset:8704
  s_waitcnt lgkmcnt(6)
  v_mfma_f32_32x32x16_bf16 v[144:159], v[224:227], v[112:115], v[144:159]
  s_add_u32 m0, s59, 32768
  s_nop 0
  buffer_load_dwordx4 v3, s[36:39], s71 offen lds
  ds_read_b64_tr_b16 v[220:221], v12 offset:8192
  ds_read_b64_tr_b16 v[222:223], v12 offset:8704
  v_mfma_f32_32x32x16_bf16 v[144:159], v[228:231], v[116:119], v[144:159]
  s_add_u32 m0, s59, 40960
  s_nop 0
  buffer_load_dwordx4 v4, s[40:43], s71 offen lds
  ds_read_b64_tr_b16 v[224:225], v9 offset:10240
  ds_read_b64_tr_b16 v[226:227], v9 offset:10752
  s_waitcnt lgkmcnt(6)
  v_mfma_f32_32x32x16_bf16 v[144:159], v[208:211], v[120:123], v[144:159]
  ds_read_b64_tr_b16 v[228:229], v12 offset:10240
  ds_read_b64_tr_b16 v[230:231], v12 offset:10752
  v_mfma_f32_32x32x16_bf16 v[144:159], v[212:215], v[124:127], v[144:159]
  s_setprio 0
  ds_read_b64_tr_b16 v[208:209], v9 offset:12288
  ds_read_b64_tr_b16 v[210:211], v9 offset:12800
  s_waitcnt lgkmcnt(6)
  v_mfma_f32_32x32x16_bf16 v[176:191], v[216:219], v[16:19], 0
  ds_read_b64_tr_b16 v[212:213], v12 offset:12288
  ds_read_b64_tr_b16 v[214:215], v12 offset:12800
  v_mfma_f32_32x32x16_bf16 v[192:207], v[220:223], v[16:19], 0
  v_and_b32 v235, 0x3f80, v253
  s_nop 2
  v_mul_f32 v144, v144, v248
  v_mul_f32 v145, v145, v248
  ds_read_b64_tr_b16 v[216:217], v9 offset:14336
  ds_read_b64_tr_b16 v[218:219], v9 offset:14848
  s_waitcnt lgkmcnt(6)
  v_mfma_f32_32x32x16_bf16 v[176:191], v[224:227], v[20:23], v[176:191]
  v_cvt_pk_bf16_f32 v144, v144, v145
  v_mul_f32 v146, v146, v248
  v_mul_f32 v147, v147, v248
  v_cvt_pk_bf16_f32 v145, v146, v147
  v_mul_f32 v148, v148, v248
  v_mul_f32 v149, v149, v248
  ds_read_b64_tr_b16 v[220:221], v12 offset:14336
  ds_read_b64_tr_b16 v[222:223], v12 offset:14848
  v_mfma_f32_32x32x16_bf16 v[192:207], v[228:231], v[20:23], v[192:207]
  v_cvt_pk_bf16_f32 v146, v148, v149
  v_mul_f32 v150, v150, v248
  v_mul_f32 v151, v151, v248
  v_cvt_pk_bf16_f32 v147, v150, v151
  buffer_store_dwordx4 v[144:147], v254, s[32:35], s11 offen offset:2048 sc1
  v_mul_f32 v152, v152, v248
  v_mul_f32 v153, v153, v248
  s_waitcnt vmcnt(6)
  s_barrier
  s_setprio 3
  ds_read_b64_tr_b16 v[224:225], v9 offset:24576
  ds_read_b64_tr_b16 v[226:227], v9 offset:25088
  s_waitcnt lgkmcnt(6)
  v_mfma_f32_32x32x16_bf16 v[176:191], v[208:211], v[24:27], v[176:191]
  s_add_u32 m0, s59, 65536
  s_nop 0
  buffer_load_dwordx4 v3, s[36:39], s72 offen lds
  v_cvt_pk_bf16_f32 v148, v152, v153
  v_mul_f32 v154, v154, v248
  v_mul_f32 v155, v155, v248
  v_cvt_pk_bf16_f32 v149, v154, v155
  ds_read_b64_tr_b16 v[228:229], v12 offset:24576
  ds_read_b64_tr_b16 v[230:231], v12 offset:25088
  v_mfma_f32_32x32x16_bf16 v[192:207], v[212:215], v[24:27], v[192:207]
  v_mul_f32 v156, v156, v248
  v_mul_f32 v157, v157, v248
  v_cvt_pk_bf16_f32 v150, v156, v157
  v_mul_f32 v158, v158, v248
  v_mul_f32 v159, v159, v248
  v_cvt_pk_bf16_f32 v151, v158, v159
  v_and_or_b32 v150, v150, v252, v235
  ds_read_b64_tr_b16 v[208:209], v9 offset:26624
  ds_read_b64_tr_b16 v[210:211], v9 offset:27136
  s_waitcnt lgkmcnt(6)
  v_mfma_f32_32x32x16_bf16 v[176:191], v[216:219], v[28:31], v[176:191]
  v_and_b32 v151, v151, v252
  buffer_store_dwordx4 v[148:151], v255, s[32:35], s11 offen offset:3072 sc1
  ds_read_b64_tr_b16 v[212:213], v12 offset:26624
  ds_read_b64_tr_b16 v[214:215], v12 offset:27136
  v_mfma_f32_32x32x16_bf16 v[192:207], v[220:223], v[28:31], v[192:207]
  s_setprio 2
  ds_read_b64_tr_b16 v[216:217], v9 offset:28672
  ds_read_b64_tr_b16 v[218:219], v9 offset:29184
  s_waitcnt lgkmcnt(6)
  v_mfma_f32_32x32x16_bf16 v[176:191], v[224:227], v[32:35], v[176:191]
  ds_read_b64_tr_b16 v[220:221], v12 offset:28672
  ds_read_b64_tr_b16 v[222:223], v12 offset:29184
  v_mfma_f32_32x32x16_bf16 v[192:207], v[228:231], v[32:35], v[192:207]
  ds_read_b64_tr_b16 v[224:225], v9 offset:30720
  ds_read_b64_tr_b16 v[226:227], v9 offset:31232
  s_waitcnt lgkmcnt(6)
  v_mfma_f32_32x32x16_bf16 v[176:191], v[208:211], v[36:39], v[176:191]
  ds_read_b64_tr_b16 v[228:229], v12 offset:30720
  ds_read_b64_tr_b16 v[230:231], v12 offset:31232
  v_mfma_f32_32x32x16_bf16 v[192:207], v[212:215], v[36:39], v[192:207]
  s_setprio 1
  ds_read_b64_tr_b16 v[208:209], v9 offset:40960
  ds_read_b64_tr_b16 v[210:211], v9 offset:41472
  s_waitcnt lgkmcnt(6)
  v_mfma_f32_32x32x16_bf16 v[176:191], v[216:219], v[40:43], v[176:191]
  ds_read_b64_tr_b16 v[212:213], v12 offset:40960
  ds_read_b64_tr_b16 v[214:215], v12 offset:41472
  v_mfma_f32_32x32x16_bf16 v[192:207], v[220:223], v[40:43], v[192:207]
  ds_read_b64_tr_b16 v[216:217], v9 offset:43008
  ds_read_b64_tr_b16 v[218:219], v9 offset:43520
  s_waitcnt lgkmcnt(6)
  v_mfma_f32_32x32x16_bf16 v[176:191], v[224:227], v[44:47], v[176:191]
  ds_read_b64_tr_b16 v[220:221], v12 offset:43008
  ds_read_b64_tr_b16 v[222:223], v12 offset:43520
  v_mfma_f32_32x32x16_bf16 v[192:207], v[228:231], v[44:47], v[192:207]
  s_setprio 0
  ds_read_b64_tr_b16 v[224:225], v9 offset:45056
  ds_read_b64_tr_b16 v[226:227], v9 offset:45568
  s_waitcnt lgkmcnt(6)
  v_mfma_f32_32x32x16_bf16 v[176:191], v[208:211], v[48:51], v[176:191]
  ds_read_b64_tr_b16 v[228:229], v12 offset:45056
  ds_read_b64_tr_b16 v[230:231], v12 offset:45568
  v_mfma_f32_32x32x16_bf16 v[192:207], v[212:215], v[48:51], v[192:207]
  ds_read_b64_tr_b16 v[208:209], v9 offset:47104
  ds_read_b64_tr_b16 v[210:211], v9 offset:47616
  s_waitcnt lgkmcnt(6)
  v_mfma_f32_32x32x16_bf16 v[176:191], v[216:219], v[52:55], v[176:191]
  ds_read_b64_tr_b16 v[212:213], v12 offset:47104
  ds_read_b64_tr_b16 v[214:215], v12 offset:47616
  v_mfma_f32_32x32x16_bf16 v[192:207], v[220:223], v[52:55], v[192:207]
  s_waitcnt vmcnt(0)
  s_barrier
  s_setprio 3
  ds_read_b64_tr_b16 v[216:217], v8 offset:16384
  ds_read_b64_tr_b16 v[218:219], v8 offset:16896
  s_waitcnt lgkmcnt(6)
  v_mfma_f32_32x32x16_bf16 v[176:191], v[224:227], v[56:59], v[176:191]
  s_mov_b64 exec, 1
  buffer_store_dwordx2 v[240:241], v247, s[32:35], s12 offen offset:128 sc1
  s_mov_b64 exec, -1
  ds_read_b64_tr_b16 v[220:221], v11 offset:16384
  ds_read_b64_tr_b16 v[222:223], v11 offset:16896
  v_mfma_f32_32x32x16_bf16 v[192:207], v[228:231], v[56:59], v[192:207]
  s_add_u32 m0, s59, 73728
  s_nop 0
  buffer_load_dwordx4 v4, s[40:43], s72 offen lds
  s_add_u32 m0, s59, 81920
  ds_read_b64_tr_b16 v[224:225], v8 offset:18432
  ds_read_b64_tr_b16 v[226:227], v8 offset:18944
  s_waitcnt lgkmcnt(6)
  v_mfma_f32_32x32x16_bf16 v[176:191], v[208:211], v[60:63], v[176:191]
  buffer_load_dwordx4 v3, s[36:39], s73 offen lds
  s_add_u32 m0, s59, 90112
  ds_read_b64_tr_b16 v[228:229], v11 offset:18432
  ds_read_b64_tr_b16 v[230:231], v11 offset:18944
  v_mfma_f32_32x32x16_bf16 v[192:207], v[212:215], v[60:63], v[192:207]
  buffer_load_dwordx4 v4, s[40:43], s73 offen lds
  s_add_u32 s7, s67, s6
  s_add_u32 m0, s59, 122880
  s_setprio 2
  ds_read_b64_tr_b16 v[208:209], v8 offset:20480
  ds_read_b64_tr_b16 v[210:211], v8 offset:20992
  s_waitcnt lgkmcnt(6)
  v_mfma_f32_32x32x16_bf16 v[176:191], v[216:219], v[64:67], v[176:191]
  s_mov_b64 exec, s[50:51]
  buffer_load_dwordx4 v232, s[36:39], s7 offen lds
  s_mov_b64 exec, -1
  ds_read_b64_tr_b16 v[212:213], v11 offset:20480
  ds_read_b64_tr_b16 v[214:215], v11 offset:20992
  v_mfma_f32_32x32x16_bf16 v[192:207], v[220:223], v[64:67], v[192:207]
  s_not_b64 exec, s[50:51]
  buffer_load_dwordx4 v232, s[40:43], s7 offen lds
  s_mov_b64 exec, -1
  ds_read_b64_tr_b16 v[216:217], v8 offset:22528
  ds_read_b64_tr_b16 v[218:219], v8 offset:23040
  s_waitcnt lgkmcnt(6)
  v_mfma_f32_32x32x16_bf16 v[176:191], v[224:227], v[68:71], v[176:191]
  s_add_u32 s7, s68, s6
  s_add_u32 m0, s59, 131072
  ds_read_b64_tr_b16 v[220:221], v11 offset:22528
  ds_read_b64_tr_b16 v[222:223], v11 offset:23040
  v_mfma_f32_32x32x16_bf16 v[192:207], v[228:231], v[68:71], v[192:207]
  s_mov_b64 exec, s[50:51]
  buffer_load_dwordx4 v232, s[36:39], s7 offen lds
  s_mov_b64 exec, -1
  s_setprio 1
  ds_read_b64_tr_b16 v[224:225], v8 offset:32768
  ds_read_b64_tr_b16 v[226:227], v8 offset:33280
  s_waitcnt lgkmcnt(6)
  v_mfma_f32_32x32x16_bf16 v[176:191], v[208:211], v[72:75], v[176:191]
  s_not_b64 exec, s[50:51]
  buffer_load_dwordx4 v232, s[40:43], s7 offen lds
  s_mov_b64 exec, -1
  ds_read_b64_tr_b16 v[228:229], v11 offset:32768
  ds_read_b64_tr_b16 v[230:231], v11 offset:33280
  v_mfma_f32_32x32x16_bf16 v[192:207], v[212:215], v[72:75], v[192:207]
  ds_read_b64_tr_b16 v[208:209], v8 offset:34816
  ds_read_b64_tr_b16 v[210:211], v8 offset:35328
  s_waitcnt lgkmcnt(6)
  v_mfma_f32_32x32x16_bf16 v[176:191], v[216:219], v[76:79], v[176:191]
  ds_read_b64_tr_b16 v[212:213], v11 offset:34816
  ds_read_b64_tr_b16 v[214:215], v11 offset:35328
  v_mfma_f32_32x32x16_bf16 v[192:207], v[220:223], v[76:79], v[192:207]
  s_add_u32 s7, s69, s6
  s_add_u32 m0, s59, 139264
  s_mov_b64 exec, s[50:51]
  buffer_load_dwordx4 v232, s[36:39], s7 offen lds
  s_mov_b64 exec, -1
  s_setprio 0
  ds_read_b64_tr_b16 v[216:217], v8 offset:36864
  ds_read_b64_tr_b16 v[218:219], v8 offset:37376
  s_waitcnt lgkmcnt(6)
  v_mfma_f32_32x32x16_bf16 v[176:191], v[224:227], v[80:83], v[176:191]
  s_not_b64 exec, s[50:51]
  buffer_load_dwordx4 v232, s[40:43], s7 offen lds
  s_mov_b64 exec, -1
  ds_read_b64_tr_b16 v[220:221], v11 offset:36864
  ds_read_b64_tr_b16 v[222:223], v11 offset:37376
  v_mfma_f32_32x32x16_bf16 v[192:207], v[228:231], v[80:83], v[192:207]
  ds_read_b64_tr_b16 v[224:225], v8 offset:38912
  ds_read_b64_tr_b16 v[226:227], v8 offset:39424
  s_waitcnt lgkmcnt(6)
  v_mfma_f32_32x32x16_bf16 v[176:191], v[208:211], v[84:87], v[176:191]
  ds_read_b64_tr_b16 v[228:229], v11 offset:38912
  ds_read_b64_tr_b16 v[230:231], v11 offset:39424
  v_mfma_f32_32x32x16_bf16 v[192:207], v[212:215], v[84:87], v[192:207]
  s_waitcnt vmcnt(6)
  s_barrier
  s_setprio 3
  ds_read_b64_tr_b16 v[208:209], v9 offset:0
  ds_read_b64_tr_b16 v[210:211], v9 offset:512
  s_waitcnt lgkmcnt(6)
  v_mfma_f32_32x32x16_bf16 v[176:191], v[216:219], v[88:91], v[176:191]
  s_add_u32 s7, s70, s6
  s_add_u32 m0, s59, 147456
  ds_read_b64_tr_b16 v[212:213], v12 offset:0
  ds_read_b64_tr_b16 v[214:215], v12 offset:512
  v_mfma_f32_32x32x16_bf16 v[192:207], v[220:223], v[88:91], v[192:207]
  s_mov_b64 exec, s[50:51]
  buffer_load_dwordx4 v232, s[36:39], s7 offen lds
  s_mov_b64 exec, -1
  ds_read_b64_tr_b16 v[216:217], v9 offset:2048
  ds_read_b64_tr_b16 v[218:219], v9 offset:2560
  s_waitcnt lgkmcnt(6)
  v_mfma_f32_32x32x16_bf16 v[176:191], v[224:227], v[92:95], v[176:191]
  s_not_b64 exec, s[50:51]
  buffer_load_dwordx4 v232, s[40:43], s7 offen lds
  s_mov_b64 exec, -1
  ds_read_b64_tr_b16 v[220:221], v12 offset:2048
  ds_read_b64_tr_b16 v[222:223], v12 offset:2560
  v_mfma_f32_32x32x16_bf16 v[192:207], v[228:231], v[92:95], v[192:207]
  v_mov_b32 v236, -1
  v_mov_b32 v237, -1
  v_mov_b32 v238, -1
  v_mov_b32 v239, -1
  buffer_store_dwordx4 v[236:239], v15, s[32:35], s75 offen offset:0 sc1
  s_setprio 2
  ds_read_b64_tr_b16 v[224:225], v9 offset:4096
  ds_read_b64_tr_b16 v[226:227], v9 offset:4608
  s_waitcnt lgkmcnt(6)
  v_mfma_f32_32x32x16_bf16 v[176:191], v[208:211], v[96:99], v[176:191]
  buffer_store_dwordx4 v[236:239], v15, s[32:35], s75 offen offset:1024 sc1
  ds_read_b64_tr_b16 v[228:229], v12 offset:4096
  ds_read_b64_tr_b16 v[230:231], v12 offset:4608
  v_mfma_f32_32x32x16_bf16 v[192:207], v[212:215], v[96:99], v[192:207]
  s_add_u32 s7, s71, s6
  s_add_u32 m0, s59, 155648
  s_mov_b64 exec, s[50:51]
  buffer_load_dwordx4 v232, s[36:39], s7 offen lds
  s_mov_b64 exec, -1
  ds_read_b64_tr_b16 v[208:209], v9 offset:6144
  ds_read_b64_tr_b16 v[210:211], v9 offset:6656
  s_waitcnt lgkmcnt(6)
  v_mfma_f32_32x32x16_bf16 v[176:191], v[216:219], v[100:103], v[176:191]
  s_not_b64 exec, s[50:51]
  buffer_load_dwordx4 v232, s[40:43], s7 offen lds
  s_mov_b64 exec, -1
  ds_read_b64_tr_b16 v[212:213], v12 offset:6144
  ds_read_b64_tr_b16 v[214:215], v12 offset:6656
  v_mfma_f32_32x32x16_bf16 v[192:207], v[220:223], v[100:103], v[192:207]
  buffer_load_dwordx2 v[244:245], v14, s[32:35], 0 offen sc1
  v_lshrrev_b32 v236, 3, v0
  v_and_b32 v237, 7, v0
  v_lshlrev_b32 v238, 1, v236
  v_and_b32 v238, 4, v238
  v_xor_b32 v238, v238, v237
  v_mul_u32_u24 v6, 896, v236
  s_setprio 1
  ds_read_b64_tr_b16 v[216:217], v9 offset:16384
  ds_read_b64_tr_b16 v[218:219], v9 offset:16896
  s_waitcnt lgkmcnt(6)
  v_mfma_f32_32x32x16_bf16 v[176:191], v[224:227], v[104:107], v[176:191]
  v_lshl_add_u32 v6, v238, 4, v6
  v_add_u32 v7, 6144, v6
  v_add_u32 v254, 147456, v15
  v_and_b32 v236, 3, v0
  v_lshlrev_b32 v242, 3, v236
  v_bfe_u32 v236, v0, 4, 1
  ds_read_b64_tr_b16 v[220:221], v12 offset:16384
  ds_read_b64_tr_b16 v[222:223], v12 offset:16896
  v_mfma_f32_32x32x16_bf16 v[192:207], v[228:231], v[104:107], v[192:207]
  v_lshl_add_u32 v242, v236, 5, v242
  v_bfe_u32 v237, v0, 3, 1
  v_lshl_add_u32 v242, v237, 6, v242
  v_bfe_u32 v239, v0, 2, 2
  v_lshl_add_u32 v242, v239, 7, v242
  v_lshrrev_b32 v238, 5, v0
  v_lshl_add_u32 v242, v238, 9, v242
  ds_read_b64_tr_b16 v[224:225], v9 offset:18432
  ds_read_b64_tr_b16 v[226:227], v9 offset:18944
  s_waitcnt lgkmcnt(6)
  v_mfma_f32_32x32x16_bf16 v[176:191], v[208:211], v[108:111], v[176:191]
  s_add_u32 s7, s72, s6
  s_add_u32 m0, s59, 98304
  s_mov_b64 exec, s[50:51]
  buffer_load_dwordx4 v232, s[36:39], s7 offen lds
  s_mov_b64 exec, -1
  s_lshl_b32 s55, s3, 13
  ds_read_b64_tr_b16 v[228:229], v12 offset:18432
  ds_read_b64_tr_b16 v[230:231], v12 offset:18944
  v_mfma_f32_32x32x16_bf16 v[192:207], v[212:215], v[108:111], v[192:207]
  s_not_b64 exec, s[50:51]
  buffer_load_dwordx4 v232, s[40:43], s7 offen lds
  s_mov_b64 exec, -1
  s_add_u32 s55, s55, 98304
  v_add_u32 v242, s55, v242
  v_xor_b32 v243, 64, v242
  v_add_u32 v246, s22, v15
  s_setprio 0
  ds_read_b64_tr_b16 v[208:209], v9 offset:20480
  ds_read_b64_tr_b16 v[210:211], v9 offset:20992
  s_waitcnt lgkmcnt(6)
  v_mfma_f32_32x32x16_bf16 v[176:191], v[216:219], v[112:115], v[176:191]
  v_and_b32 v237, 1, v0
  v_xor_b32 v238, v238, v237
  ds_read_b64_tr_b16 v[212:213], v12 offset:20480
  ds_read_b64_tr_b16 v[214:215], v12 offset:20992
  v_mfma_f32_32x32x16_bf16 v[192:207], v[220:223], v[112:115], v[192:207]
  v_mul_u32_u24 v2, 1152, v236
  v_lshl_add_u32 v2, v237, 9, v2
  v_lshl_add_u32 v2, v238, 6, v2
  ds_read_b64_tr_b16 v[216:217], v9 offset:22528
  ds_read_b64_tr_b16 v[218:219], v9 offset:23040
  s_waitcnt lgkmcnt(6)
  v_mfma_f32_32x32x16_bf16 v[176:191], v[224:227], v[116:119], v[176:191]
  v_lshl_add_u32 v2, v239, 4, v2
  v_bfe_u32 v237, v0, 1, 1
  ds_read_b64_tr_b16 v[220:221], v12 offset:22528
  ds_read_b64_tr_b16 v[222:223], v12 offset:23040
  v_mfma_f32_32x32x16_bf16 v[192:207], v[228:231], v[116:119], v[192:207]
  s_add_u32 s7, s73, s6
  s_add_u32 m0, s59, 106496
  s_mov_b64 exec, s[50:51]
  buffer_load_dwordx4 v232, s[36:39], s7 offen lds
  s_mov_b64 exec, -1
  s_cmp_lg_u32 s3, 0
  s_cbranch_scc1 L_pa1_ok
L_pa1_chk:
  s_waitcnt vmcnt(3)
  v_cmp_ne_u64 s[48:49], v[244:245], v[240:241]
  s_nop 0
  s_cmp_eq_u64 s[48:49], 0
  s_cbranch_scc0 L_pa1_spin
L_pa1_ok:
  s_waitcnt vmcnt(10)
  s_barrier
  s_setprio 3
  ds_read_b64_tr_b16 v[224:225], v233 offset:57344
  ds_read_b64_tr_b16 v[226:227], v233 offset:57856
  s_waitcnt lgkmcnt(6)
  v_mfma_f32_32x32x16_bf16 v[176:191], v[208:211], v[120:123], v[176:191]
  s_not_b64 exec, s[50:51]
  buffer_load_dwordx4 v232, s[40:43], s7 offen lds
  s_mov_b64 exec, -1
  v_lshl_add_u32 v2, v237, 3, v2
  v_add_u32 v2, s22, v2
  v_add_u32 v2, 2048, v2
  ds_read_b64_tr_b16 v[228:229], v233 offset:59392
  ds_read_b64_tr_b16 v[230:231], v233 offset:59904
  v_mfma_f32_32x32x16_bf16 v[192:207], v[212:215], v[120:123], v[192:207]
  buffer_load_dwordx4 v[128:131], v15, s[32:35], s74 offen offset:0 sc1
  v_xor_b32 v5, 128, v2
  ds_read_b64_tr_b16 v[208:209], v233 offset:61440
  ds_read_b64_tr_b16 v[210:211], v233 offset:61952
  s_waitcnt lgkmcnt(6)
  v_mfma_f32_32x32x16_bf16 v[176:191], v[216:219], v[124:127], v[176:191]
  buffer_load_dwordx4 v[132:135], v15, s[32:35], s74 offen offset:1024 sc1
  s_setprio 2
  ds_read_b64_tr_b16 v[212:213], v233 offset:63488
  ds_read_b64_tr_b16 v[214:215], v233 offset:64000
  v_mfma_f32_32x32x16_bf16 v[192:207], v[220:223], v[124:127], v[192:207]
  buffer_load_dwordx4 v[136:139], v15, s[32:35], s74 offen offset:2048 sc1
  ds_read_b64_tr_b16 v[216:217], v234 offset:0
  ds_read_b64_tr_b16 v[218:219], v234 offset:512
  s_waitcnt lgkmcnt(6)
  v_mfma_f32_32x32x16_bf16 v[160:175], v[224:227], v[16:19], 0
  buffer_load_dwordx4 v[140:143], v15, s[32:35], s74 offen offset:3072 sc1
  s_mul_i32 s54, s4, 6144
  s_add_u32 s57, s4, 31
  s_add_u32 s54, s54, s21
  s_and_b32 s57, s57, 31
  s_mul_i32 s57, s57, 6144
  ds_read_b64_tr_b16 v[220:221], v234 offset:2048
  ds_read_b64_tr_b16 v[222:223], v234 offset:2560
  v_mfma_f32_32x32x16_bf16 v[160:175], v[228:231], v[20:23], v[160:175]
  s_add_u32 s57, s57, s21
  s_add_u32 s4, s4, 4
  s_and_b32 s4, s4, 31
  s_setprio 1
  ds_read_b64_tr_b16 v[224:225], v234 offset:4096
  ds_read_b64_tr_b16 v[226:227], v234 offset:4608
  s_waitcnt lgkmcnt(6)
  v_mfma_f32_32x32x16_bf16 v[160:175], v[208:211], v[24:27], v[160:175]
  s_cmp_eq_u32 s23, 0
  s_cselect_b32 s54, 2130706432, s54
  s_cmp_lt_u32 s23, 2
  s_cselect_b32 s57, 2130706432, s57
  s_bitcmp1_b32 s54, 30
  s_cselect_b32 m0, 0x30000, s5
  s_nop 0
  buffer_load_dwordx4 v15, s[32:35], s54 offen offset:0 sc1 lds
  ds_read_b64_tr_b16 v[228:229], v234 offset:6144
  ds_read_b64_tr_b16 v[230:231], v234 offset:6656
  v_mfma_f32_32x32x16_bf16 v[160:175], v[212:215], v[28:31], v[160:175]
  s_bitcmp1_b32 s54, 30
  s_cselect_b32 m0, 0x30000, s5
  s_nop 0
  buffer_load_dwordx4 v15, s[32:35], s54 offen offset:1024 sc1 lds
  v_mul_f32 v236, v176, v176
  v_mul_f32 v237, v177, v177
  v_mul_f32 v238, v178, v178
  v_mul_f32 v239, v179, v179
  ds_read_b64_tr_b16 v[208:209], v234 offset:8192
  ds_read_b64_tr_b16 v[210:211], v234 offset:8704
  s_waitcnt lgkmcnt(6)
  v_mfma_f32_32x32x16_bf16 v[160:175], v[216:219], v[32:35], v[160:175]
  s_bitcmp1_b32 s57, 30
  s_cselect_b32 m0, 0x30000, s5
  s_nop 0
  buffer_load_dwordx4 v15, s[32:35], s57 offen offset:2048 sc1 lds
  v_fma_f32 v236, v236, v250, v249
  v_fma_f32 v237, v237, v250, v249
  v_fma_f32 v238, v238, v250, v249
  s_setprio 0
  ds_read_b64_tr_b16 v[212:213], v234 offset:10240
  ds_read_b64_tr_b16 v[214:215], v234 offset:10752
  v_mfma_f32_32x32x16_bf16 v[160:175], v[220:223], v[36:39], v[160:175]
  s_bitcmp1_b32 s57, 30
  s_cselect_b32 m0, 0x30000, s5
  s_nop 0
  buffer_load_dwordx4 v15, s[32:35], s57 offen offset:3072 sc1 lds
  s_add_u32 s5, s5, 16384
  s_sub_u32 s54, s5, 49152
  s_cmp_ge_i32 s54, s22
  s_cselect_b32 s5, s54, s5
  ds_read_b64_tr_b16 v[216:217], v234 offset:12288
  ds_read_b64_tr_b16 v[218:219], v234 offset:12800
  s_waitcnt lgkmcnt(6)
  v_mfma_f32_32x32x16_bf16 v[160:175], v[224:227], v[40:43], v[160:175]
  v_fma_f32 v239, v239, v250, v249
  v_mul_f32 v236, v236, v176
  v_mul_f32 v237, v237, v177
  v_mul_f32 v238, v238, v178
  v_mul_f32 v239, v239, v179
  v_exp_f32 v236, v236
  ds_read_b64_tr_b16 v[220:221], v234 offset:14336
  ds_read_b64_tr_b16 v[222:223], v234 offset:14848
  v_mfma_f32_32x32x16_bf16 v[160:175], v[228:231], v[44:47], v[160:175]
  v_exp_f32 v237, v237
  v_exp_f32 v238, v238
  v_exp_f32 v239, v239
  v_mul_f32 v176, v176, v184
  v_mul_f32 v177, v177, v185
  v_mul_f32 v178, v178, v186
  v_mul_f32 v179, v179, v187
  s_waitcnt vmcnt(8)
  s_barrier
  s_setprio 3
  ds_read_b64_tr_b16 v[224:225], v234 offset:16384
  ds_read_b64_tr_b16 v[226:227], v234 offset:16896
  s_waitcnt lgkmcnt(6)
  v_mfma_f32_32x32x16_bf16 v[160:175], v[208:211], v[48:51], v[160:175]
  v_fma_f32 v236, v236, v251, v251
  v_fma_f32 v237, v237, v251, v251
  v_fma_f32 v238, v238, v251, v251
  v_fma_f32 v239, v239, v251, v251
  v_rcp_f32 v236, v236
  v_rcp_f32 v237, v237
  ds_read_b64_tr_b16 v[228:229], v234 offset:18432
  ds_read_b64_tr_b16 v[230:231], v234 offset:18944
  v_mfma_f32_32x32x16_bf16 v[160:175], v[212:215], v[52:55], v[160:175]
  v_rcp_f32 v238, v238
  v_rcp_f32 v239, v239
  v_mul_f32 v176, v176, v236
  v_mul_f32 v177, v177, v237
  v_mul_f32 v178, v178, v238
  v_mul_f32 v179, v179, v239
  v_mul_f32 v236, v180, v180
  ds_read_b64_tr_b16 v[208:209], v234 offset:20480
  ds_read_b64_tr_b16 v[210:211], v234 offset:20992
  s_waitcnt lgkmcnt(6)
  v_mfma_f32_32x32x16_bf16 v[160:175], v[216:219], v[56:59], v[160:175]
  v_mul_f32 v237, v181, v181
  v_mul_f32 v238, v182, v182
  v_mul_f32 v239, v183, v183
  v_fma_f32 v236, v236, v250, v249
  v_fma_f32 v237, v237, v250, v249
  v_fma_f32 v238, v238, v250, v249
  ds_read_b64_tr_b16 v[212:213], v234 offset:22528
  ds_read_b64_tr_b16 v[214:215], v234 offset:23040
  v_mfma_f32_32x32x16_bf16 v[160:175], v[220:223], v[60:63], v[160:175]
  v_fma_f32 v239, v239, v250, v249
  v_mul_f32 v236, v236, v180
  v_mul_f32 v237, v237, v181
  v_mul_f32 v238, v238, v182
  v_mul_f32 v239, v239, v183
  v_exp_f32 v236, v236
  v_exp_f32 v237, v237
  ds_read_b64_tr_b16 v[216:217], v234 offset:24576
  ds_read_b64_tr_b16 v[218:219], v234 offset:25088
  s_waitcnt lgkmcnt(6)
  v_mfma_f32_32x32x16_bf16 v[160:175], v[224:227], v[64:67], v[160:175]
  v_exp_f32 v238, v238
  v_exp_f32 v239, v239
  v_mul_f32 v180, v180, v188
  v_mul_f32 v181, v181, v189
  v_mul_f32 v182, v182, v190
  v_mul_f32 v183, v183, v191
  s_setprio 2
  ds_read_b64_tr_b16 v[220:221], v234 offset:26624
  ds_read_b64_tr_b16 v[222:223], v234 offset:27136
  v_mfma_f32_32x32x16_bf16 v[160:175], v[228:231], v[68:71], v[160:175]
  v_fma_f32 v236, v236, v251, v251
  v_fma_f32 v237, v237, v251, v251
  v_fma_f32 v238, v238, v251, v251
  v_fma_f32 v239, v239, v251, v251
  v_rcp_f32 v236, v236
  v_rcp_f32 v237, v237
  v_rcp_f32 v238, v238
  ds_read_b64_tr_b16 v[224:225], v234 offset:28672
  ds_read_b64_tr_b16 v[226:227], v234 offset:29184
  s_waitcnt lgkmcnt(6)
  v_mfma_f32_32x32x16_bf16 v[160:175], v[208:211], v[72:75], v[160:175]
  v_rcp_f32 v239, v239
  v_mul_f32 v180, v180, v236
  v_mul_f32 v181, v181, v237
  v_mul_f32 v182, v182, v238
  v_mul_f32 v183, v183, v239
  v_cvt_pk_bf16_f32 v184, v176, v177
  ds_read_b64_tr_b16 v[228:229], v234 offset:30720
  ds_read_b64_tr_b16 v[230:231], v234 offset:31232
  v_mfma_f32_32x32x16_bf16 v[160:175], v[212:215], v[76:79], v[160:175]
  v_cvt_pk_bf16_f32 v185, v178, v179
  v_cvt_pk_bf16_f32 v186, v180, v181
  v_cvt_pk_bf16_f32 v187, v182, v183
  buffer_store_dwordx4 v[184:187], v15, s[32:35], s13 offen offset:0 sc1
  ds_read_b64_tr_b16 v[208:209], v233 offset:32768
  ds_read_b64_tr_b16 v[210:211], v233 offset:33280
  s_waitcnt lgkmcnt(6)
  v_mfma_f32_32x32x16_bf16 v[160:175], v[216:219], v[80:83], v[160:175]
  s_mul_i32 s54, s4, 6144
  s_add_u32 s57, s4, 31
  ds_read_b64_tr_b16 v[212:213], v233 offset:34816
  ds_read_b64_tr_b16 v[214:215], v233 offset:35328
  v_mfma_f32_32x32x16_bf16 v[160:175], v[220:223], v[84:87], v[160:175]
  s_add_u32 s54, s54, s21
  s_and_b32 s57, s57, 31
  s_mul_i32 s57, s57, 6144
  s_add_u32 s57, s57, s21
  s_add_u32 s4, s4, 4
  s_and_b32 s4, s4, 31
  s_mov_b32 m0, s5
  s_nop 0
  buffer_load_dwordx4 v15, s[32:35], s54 offen offset:0 sc1 lds
  s_setprio 1
  ds_read_b64_tr_b16 v[216:217], v233 offset:36864
  ds_read_b64_tr_b16 v[218:219], v233 offset:37376
  s_waitcnt lgkmcnt(6)
  v_mfma_f32_32x32x16_bf16 v[160:175], v[224:227], v[88:91], v[160:175]
  s_mov_b32 m0, s5
  s_nop 0
  buffer_load_dwordx4 v15, s[32:35], s54 offen offset:1024 sc1 lds
  ds_read_b64_tr_b16 v[220:221], v233 offset:38912
  ds_read_b64_tr_b16 v[222:223], v233 offset:39424
  v_mfma_f32_32x32x16_bf16 v[160:175], v[228:231], v[92:95], v[160:175]
  s_mov_b32 m0, s5
  s_nop 0
  buffer_load_dwordx4 v15, s[32:35], s57 offen offset:2048 sc1 lds
  ds_read_b64_tr_b16 v[224:225], v233 offset:40960
  ds_read_b64_tr_b16 v[226:227], v233 offset:41472
  s_waitcnt lgkmcnt(6)
  v_mfma_f32_32x32x16_bf16 v[160:175], v[208:211], v[96:99], v[160:175]
  s_mov_b32 m0, s5
  s_nop 0
  buffer_load_dwordx4 v15, s[32:35], s57 offen offset:3072 sc1 lds
  s_add_u32 s5, s5, 16384
  s_sub_u32 s54, s5, 49152
  s_cmp_ge_i32 s54, s22
  s_cselect_b32 s5, s54, s5
  ds_read_b64_tr_b16 v[228:229], v233 offset:43008
  ds_read_b64_tr_b16 v[230:231], v233 offset:43520
  v_mfma_f32_32x32x16_bf16 v[160:175], v[212:215], v[100:103], v[160:175]
  s_mul_i32 s54, s4, 6144
  s_add_u32 s57, s4, 31
  s_add_u32 s54, s54, s21
  s_and_b32 s57, s57, 31
  s_mul_i32 s57, s57, 6144
  s_add_u32 s57, s57, s21
  s_add_u32 s4, s4, 4
  ds_read_b64_tr_b16 v[208:209], v233 offset:45056
  ds_read_b64_tr_b16 v[210:211], v233 offset:45568
  s_waitcnt lgkmcnt(6)
  v_mfma_f32_32x32x16_bf16 v[160:175], v[216:219], v[104:107], v[160:175]
  s_and_b32 s4, s4, 31
  s_mov_b32 m0, s5
  s_nop 0
  buffer_load_dwordx4 v15, s[32:35], s54 offen offset:0 sc1 lds
  s_setprio 0
  ds_read_b64_tr_b16 v[212:213], v233 offset:47104
  ds_read_b64_tr_b16 v[214:215], v233 offset:47616
  v_mfma_f32_32x32x16_bf16 v[160:175], v[220:223], v[108:111], v[160:175]
  s_mov_b32 m0, s5
  s_nop 0
  buffer_load_dwordx4 v15, s[32:35], s54 offen offset:1024 sc1 lds
  s_waitcnt lgkmcnt(4)
  v_mfma_f32_32x32x16_bf16 v[160:175], v[224:227], v[112:115], v[160:175]
  s_mov_b32 m0, s5
  s_nop 0
  buffer_load_dwordx4 v15, s[32:35], s57 offen offset:2048 sc1 lds
  v_mfma_f32_32x32x16_bf16 v[160:175], v[228:231], v[116:119], v[160:175]
  s_mov_b32 m0, s5
  s_nop 0
  buffer_load_dwordx4 v15, s[32:35], s57 offen offset:3072 sc1 lds
  s_add_u32 s5, s5, 16384
  s_waitcnt lgkmcnt(0)
  v_mfma_f32_32x32x16_bf16 v[160:175], v[208:211], v[120:123], v[160:175]
  s_sub_u32 s54, s5, 49152
  s_cmp_ge_i32 s54, s22
  s_cselect_b32 s5, s54, s5
  v_mfma_f32_32x32x16_bf16 v[160:175], v[212:215], v[124:127], v[160:175]
  v_mul_f32 v236, v192, v192
  v_mul_f32 v237, v193, v193
  v_mul_f32 v238, v194, v194
  v_mul_f32 v239, v195, v195
  v_fma_f32 v236, v236, v250, v249
  v_fma_f32 v237, v237, v250, v249
  v_fma_f32 v238, v238, v250, v249
  v_fma_f32 v239, v239, v250, v249
  v_mul_f32 v236, v236, v192
  v_mul_f32 v237, v237, v193
  v_mul_f32 v238, v238, v194
  v_mul_f32 v239, v239, v195
  v_exp_f32 v236, v236
  v_exp_f32 v237, v237
  v_exp_f32 v238, v238
  v_exp_f32 v239, v239
  v_mul_f32 v192, v192, v200
  v_mul_f32 v193, v193, v201
  v_mul_f32 v194, v194, v202
  v_mul_f32 v195, v195, v203
  v_fma_f32 v236, v236, v251, v251
  v_fma_f32 v237, v237, v251, v251
  v_fma_f32 v238, v238, v251, v251
  v_fma_f32 v239, v239, v251, v251
  v_rcp_f32 v236, v236
  v_rcp_f32 v237, v237
  v_rcp_f32 v238, v238
  v_rcp_f32 v239, v239
  v_mul_f32 v192, v192, v236
  v_mul_f32 v193, v193, v237
  v_mul_f32 v194, v194, v238
  v_mul_f32 v195, v195, v239
  v_mul_f32 v236, v196, v196
  v_mul_f32 v237, v197, v197
  v_mul_f32 v238, v198, v198
  v_mul_f32 v239, v199, v199
  v_fma_f32 v236, v236, v250, v249
  v_fma_f32 v237, v237, v250, v249
  v_fma_f32 v238, v238, v250, v249
  v_fma_f32 v239, v239, v250, v249
  v_mul_f32 v236, v236, v196
  v_mul_f32 v237, v237, v197
  v_mul_f32 v238, v238, v198
  v_mul_f32 v239, v239, v199
  v_exp_f32 v236, v236
  v_exp_f32 v237, v237
  v_exp_f32 v238, v238
  v_exp_f32 v239, v239
  v_mul_f32 v196, v196, v204
  v_mul_f32 v197, v197, v205
  v_mul_f32 v198, v198, v206
  v_mul_f32 v199, v199, v207
  v_fma_f32 v236, v236, v251, v251
  v_fma_f32 v237, v237, v251, v251
  v_fma_f32 v238, v238, v251, v251
  v_fma_f32 v239, v239, v251, v251
  v_rcp_f32 v236, v236
  v_rcp_f32 v237, v237
  v_rcp_f32 v238, v238
  v_rcp_f32 v239, v239
  v_mul_f32 v196, v196, v236
  v_mul_f32 v197, v197, v237
  v_mul_f32 v198, v198, v238
  s_mov_b32 s28, s16
  v_mul_f32 v199, v199, v239
  v_cvt_pk_bf16_f32 v200, v192, v193
  s_mov_b32 s29, s17
  v_cvt_pk_bf16_f32 v201, v194, v195
  v_cvt_pk_bf16_f32 v202, v196, v197
  s_mov_b32 s30, 1605632
  v_cvt_pk_bf16_f32 v203, v198, v199
  buffer_store_dwordx4 v[200:203], v15, s[32:35], s13 offen offset:1024 sc1
  s_mov_b32 s31, 0x00020000
  v_mul_f32 v236, v160, v160
  v_mul_f32 v237, v161, v161
  s_mov_b32 s36, s18
  v_mul_f32 v238, v162, v162
  v_mul_f32 v239, v163, v163
  s_mov_b32 s37, s19
  v_fma_f32 v236, v236, v250, v249
  v_fma_f32 v237, v237, v250, v249
  v_fma_f32 v238, v238, v250, v249
  s_mov_b32 s38, 1835008
  v_fma_f32 v239, v239, v250, v249
  v_mul_f32 v236, v236, v160
  s_mov_b32 s39, 0x00020000
  v_mul_f32 v237, v237, v161
  v_mul_f32 v238, v238, v162
  s_cmp_lt_u32 s2, 224
  v_mul_f32 v239, v239, v163
  v_exp_f32 v236, v236
  s_cselect_b32 s65, 1, 0
  v_exp_f32 v237, v237
  v_exp_f32 v238, v238
  s_bfe_u32 s55, s2, 0x20003
  v_exp_f32 v239, v239
  v_mul_f32 v160, v160, v168
  s_lshr_b32 s56, s2, 5
  v_mul_f32 v161, v161, v169
  v_mul_f32 v162, v162, v170
  v_mul_f32 v163, v163, v171
  s_lshl_b32 s66, s55, 1
  v_fma_f32 v236, v236, v251, v251
  v_fma_f32 v237, v237, v251, v251
  s_add_u32 s66, s66, s56
  v_fma_f32 v238, v238, v251, v251
  v_fma_f32 v239, v239, v251, v251
  s_add_u32 s62, s55, s56
  v_rcp_f32 v236, v236
  v_rcp_f32 v237, v237
  s_and_b32 s62, s62, 3
  v_rcp_f32 v238, v238
  v_rcp_f32 v239, v239
  s_sub_u32 s56, s66, 10
  v_mul_f32 v160, v160, v236
  v_mul_f32 v161, v161, v237
  s_cmp_ge_u32 s66, 10
  v_mul_f32 v162, v162, v238
  v_mul_f32 v163, v163, v239
  v_mul_f32 v236, v164, v164
  s_cselect_b32 s66, s56, s66
  v_mul_f32 v237, v165, v165
  v_mul_f32 v238, v166, v166
  s_sub_u32 s56, s66, 10
  v_mul_f32 v239, v167, v167
  v_fma_f32 v236, v236, v250, v249
  s_cmp_ge_u32 s66, 10
  v_fma_f32 v237, v237, v250, v249
  v_fma_f32 v238, v238, v250, v249
  s_cselect_b32 s66, s56, s66
  v_fma_f32 v239, v239, v250, v249
  v_mul_f32 v236, v236, v164
  s_add_u32 s66, s66, 4
  v_mul_f32 v237, v237, v165
  v_mul_f32 v238, v238, v166
  s_lshl_b32 s63, s62, 3
  v_mul_f32 v239, v239, v167
  v_exp_f32 v236, v236
  v_exp_f32 v237, v237
  s_add_u32 s63, s63, s3
  v_exp_f32 v238, v238
  v_exp_f32 v239, v239
  s_mul_i32 s63, s63, 14336
  v_mul_f32 v164, v164, v172
  v_mul_f32 v165, v165, v173
  s_add_u32 s63, s63, s78
  v_mul_f32 v166, v166, v174
  v_mul_f32 v167, v167, v175
  s_lshl_b32 s62, s62, 13
  v_fma_f32 v236, v236, v251, v251
  v_fma_f32 v237, v237, v251, v251
  s_mul_i32 s61, s77, 294912
  v_fma_f32 v238, v238, v251, v251
  v_fma_f32 v239, v239, v251, v251
  s_add_u32 s61, s61, 8388608
  v_rcp_f32 v236, v236
  v_rcp_f32 v237, v237
  v_rcp_f32 v238, v238
  s_lshl_b32 s55, s3, 10
  v_rcp_f32 v239, v239
  v_mul_f32 v164, v164, v236
  s_add_u32 s61, s61, s55
  v_mul_f32 v165, v165, v237
  v_mul_f32 v166, v166, v238
  s_add_u32 s62, s62, s61
  v_mul_f32 v167, v167, v239
  v_cvt_pk_bf16_f32 v168, v160, v161
  s_lshl_b32 s64, s3, 13
  v_cvt_pk_bf16_f32 v169, v162, v163
  v_cvt_pk_bf16_f32 v170, v164, v165
  s_add_u32 s64, s64, 98304
  v_cvt_pk_bf16_f32 v171, v166, v167
  buffer_store_dwordx4 v[168:171], v15, s[32:35], s14 offen offset:0 sc1
  s_mov_b32 s60, 0
L_fin:
  s_waitcnt vmcnt(16)
  v_mfma_f32_32x32x16_bf16 v[80:95], v[136:139], v[128:131], 0
  s_waitcnt vmcnt(15)
  v_mfma_f32_32x32x16_bf16 v[80:95], v[140:143], v[132:135], v[80:95]
  s_nop 11
  v_max3_f32 v10, v80, v81, v82
  v_max_f32 v10, v10, v95
  v_max3_f32 v10, v10, v83, v84
  v_max3_f32 v10, v10, v85, v86
  v_max3_f32 v10, v10, v87, v88
  v_max3_f32 v10, v10, v89, v90
  v_max3_f32 v10, v10, v91, v92
  v_max3_f32 v10, v10, v93, v94
  v_mov_b32 v3, v10
  s_nop 1
  v_permlane32_swap_b32 v3, v10
  v_max_f32 v10, v10, v3
  v_sub_f32 v3, 0, v10
  v_and_b32 v4, 0xffff0000, v3
  v_sub_f32 v3, v3, v4
  v_and_b32 v8, 0xffff0000, v3
  v_sub_f32 v3, v3, v8
  v_lshrrev_b32 v4, 16, v4
  v_or_b32 v4, v4, v8
  v_lshrrev_b32 v3, 16, v3
  v_and_b32 v4, v4, v253
  v_and_b32 v3, v3, v253
  v_and_or_b32 v134, v134, v252, v4
  v_and_or_b32 v135, v135, v252, v3
  s_cmp_eq_u32 s65, 0
  s_cbranch_scc1 L_plain0
  s_waitcnt vmcnt(11)
  s_waitcnt lgkmcnt(0)
  s_barrier
  ds_read_b128 v[136:139], v246 offset:0
  ds_read_b128 v[140:143], v246 offset:1024
  s_setprio 1
  s_waitcnt lgkmcnt(1)
  v_mfma_f32_32x32x16_bf16 v[80:95], v[136:139], v[128:131], 0
  s_add_u32 m0, s64, 0
  s_nop 0
  buffer_load_dwordx4 v6, s[28:31], s63 offen lds
  s_waitcnt lgkmcnt(0)
  v_mfma_f32_32x32x16_bf16 v[80:95], v[140:143], v[132:135], v[80:95]
  ds_read_b128 v[136:139], v246 offset:4096
  ds_read_b128 v[140:143], v246 offset:5120
  s_add_u32 m0, s64, 0
  s_nop 0
  buffer_load_dwordx4 v7, s[28:31], s63 offen offset:1024 lds
  s_add_u32 s63, s63, 114688
  ds_read_b64_tr_b16 v[112:113], v2 offset:4096
  ds_read_b64_tr_b16 v[114:115], v5 offset:4096
  s_sub_u32 s56, s63, 458752
  s_cmp_ge_u32 s63, 458752
  s_cselect_b32 s63, s56, s63
  ds_read_b64_tr_b16 v[116:117], v2 offset:4352
  ds_read_b64_tr_b16 v[118:119], v5 offset:4352
  v_exp_f32 v80, v80
  v_exp_f32 v81, v81
  v_exp_f32 v82, v82
  v_exp_f32 v83, v83
  v_exp_f32 v84, v84
  v_exp_f32 v85, v85
  v_exp_f32 v86, v86
  v_exp_f32 v87, v87
  v_exp_f32 v88, v88
  v_exp_f32 v89, v89
  v_exp_f32 v90, v90
  v_exp_f32 v91, v91
  v_exp_f32 v92, v92
  v_exp_f32 v93, v93
  v_exp_f32 v94, v94
  v_exp_f32 v95, v95
  v_cvt_pk_bf16_f32 v120, v80, v81
  v_cvt_pk_bf16_f32 v121, v82, v83
  v_cvt_pk_bf16_f32 v122, v84, v85
  v_cvt_pk_bf16_f32 v123, v86, v87
  v_cvt_pk_bf16_f32 v124, v88, v89
  v_cvt_pk_bf16_f32 v125, v90, v91
  v_cvt_pk_bf16_f32 v126, v92, v93
  v_cvt_pk_bf16_f32 v127, v94, v95
  s_setprio 0
  s_waitcnt lgkmcnt(5)
  v_mfma_f32_32x32x16_bf16 v[80:95], v[136:139], v[128:131], 0
  s_add_u32 m0, s64, 2048
  s_nop 0
  buffer_load_dwordx4 v6, s[28:31], s63 offen lds
  s_waitcnt lgkmcnt(4)
  v_mfma_f32_32x32x16_bf16 v[80:95], v[140:143], v[132:135], v[80:95]
  ds_read_b128 v[136:139], v246 offset:8192
  ds_read_b128 v[140:143], v246 offset:9216
  s_add_u32 m0, s64, 2048
  s_nop 0
  buffer_load_dwordx4 v7, s[28:31], s63 offen offset:1024 lds
  s_add_u32 s63, s63, 114688
  s_waitcnt lgkmcnt(4)
  v_mfma_f32_32x32x16_bf16 v[96:111], v[112:115], v[120:123], 0
  ds_read_b64_tr_b16 v[112:113], v2 offset:8192
  ds_read_b64_tr_b16 v[114:115], v5 offset:8192
  s_sub_u32 s56, s63, 458752
  s_cmp_ge_u32 s63, 458752
  s_cselect_b32 s63, s56, s63
  s_waitcnt lgkmcnt(4)
  v_mfma_f32_32x32x16_bf16 v[96:111], v[116:119], v[124:127], v[96:111]
  ds_read_b64_tr_b16 v[116:117], v2 offset:8448
  ds_read_b64_tr_b16 v[118:119], v5 offset:8448
  v_exp_f32 v80, v80
  v_exp_f32 v81, v81
  v_exp_f32 v82, v82
  v_exp_f32 v83, v83
  v_exp_f32 v84, v84
  v_exp_f32 v85, v85
  v_exp_f32 v86, v86
  v_exp_f32 v87, v87
  v_exp_f32 v88, v88
  v_exp_f32 v89, v89
  v_exp_f32 v90, v90
  v_exp_f32 v91, v91
  v_exp_f32 v92, v92
  v_exp_f32 v93, v93
  v_exp_f32 v94, v94
  v_exp_f32 v95, v95
  v_cvt_pk_bf16_f32 v120, v80, v81
  v_cvt_pk_bf16_f32 v121, v82, v83
  v_cvt_pk_bf16_f32 v122, v84, v85
  v_cvt_pk_bf16_f32 v123, v86, v87
  v_cvt_pk_bf16_f32 v124, v88, v89
  v_cvt_pk_bf16_f32 v125, v90, v91
  v_cvt_pk_bf16_f32 v126, v92, v93
  v_cvt_pk_bf16_f32 v127, v94, v95
  s_cbranch_vccz L_sk1
  s_waitcnt vmcnt(4)
  s_waitcnt lgkmcnt(0)
  s_barrier
L_sk1:
  s_setprio 3
  s_waitcnt lgkmcnt(5)
  v_mfma_f32_32x32x16_bf16 v[80:95], v[136:139], v[128:131], 0
  s_mov_b64 exec, 255
  buffer_load_dwordx2 v[244:245], v1, s[32:35], 0 offen sc1
  s_mov_b64 exec, -1
  s_mul_i32 s54, s4, 6144
  s_add_u32 s57, s4, 31
  s_waitcnt lgkmcnt(4)
  v_mfma_f32_32x32x16_bf16 v[80:95], v[140:143], v[132:135], v[80:95]
  ds_read_b128 v[136:139], v246 offset:12288
  ds_read_b128 v[140:143], v246 offset:13312
  s_add_u32 m0, s64, 4096
  s_nop 0
  buffer_load_dwordx4 v6, s[28:31], s63 offen lds
  s_add_u32 s54, s54, s21
  s_waitcnt lgkmcnt(4)
  v_mfma_f32_32x32x16_bf16 v[96:111], v[112:115], v[120:123], v[96:111]
  ds_read_b64_tr_b16 v[112:113], v2 offset:12288
  ds_read_b64_tr_b16 v[114:115], v5 offset:12288
  s_add_u32 m0, s64, 4096
  s_nop 0
  buffer_load_dwordx4 v7, s[28:31], s63 offen offset:1024 lds
  s_and_b32 s57, s57, 31
  s_waitcnt lgkmcnt(4)
  v_mfma_f32_32x32x16_bf16 v[96:111], v[116:119], v[124:127], v[96:111]
  ds_read_b64_tr_b16 v[116:117], v2 offset:12544
  ds_read_b64_tr_b16 v[118:119], v5 offset:12544
  s_mul_i32 s57, s57, 6144
  s_add_u32 s57, s57, s21
  s_add_u32 s4, s4, 4
  s_and_b32 s4, s4, 31
  s_add_u32 s63, s63, 114688
  s_sub_u32 s56, s63, 458752
  s_cmp_ge_u32 s63, 458752
  s_cselect_b32 s63, s56, s63
  s_cbranch_vccnz L_sk2
  s_waitcnt vmcnt(7)
  s_waitcnt lgkmcnt(0)
  s_barrier
L_sk2:
  v_exp_f32 v80, v80
  v_exp_f32 v81, v81
  v_exp_f32 v82, v82
  v_exp_f32 v83, v83
  v_exp_f32 v84, v84
  v_exp_f32 v85, v85
  v_exp_f32 v86, v86
  v_exp_f32 v87, v87
  v_exp_f32 v88, v88
  v_exp_f32 v89, v89
  v_exp_f32 v90, v90
  v_exp_f32 v91, v91
  v_exp_f32 v92, v92
  v_exp_f32 v93, v93
  v_exp_f32 v94, v94
  v_exp_f32 v95, v95
  v_cvt_pk_bf16_f32 v120, v80, v81
  v_cvt_pk_bf16_f32 v121, v82, v83
  v_cvt_pk_bf16_f32 v122, v84, v85
  v_cvt_pk_bf16_f32 v123, v86, v87
  v_cvt_pk_bf16_f32 v124, v88, v89
  v_cvt_pk_bf16_f32 v125, v90, v91
  v_cvt_pk_bf16_f32 v126, v92, v93
  v_cvt_pk_bf16_f32 v127, v94, v95
  s_setprio 2
  s_waitcnt lgkmcnt(5)
  v_mfma_f32_32x32x16_bf16 v[80:95], v[136:139], v[128:131], 0
  s_mov_b64 exec, 1
  buffer_store_dwordx2 v[240:241], v247, s[32:35], s20 offen offset:0 sc1
  s_mov_b64 exec, -1
  s_waitcnt lgkmcnt(4)
  v_mfma_f32_32x32x16_bf16 v[80:95], v[140:143], v[132:135], v[80:95]
  ds_read_b128 v[136:139], v246 offset:16384
  ds_read_b128 v[140:143], v246 offset:17408
  s_mov_b64 exec, 1
  buffer_store_dwordx2 v[240:241], v247, s[32:35], s76 offen offset:0 sc1
  s_mov_b64 exec, -1
  s_waitcnt lgkmcnt(4)
  v_mfma_f32_32x32x16_bf16 v[96:111], v[112:115], v[120:123], v[96:111]
  ds_read_b64_tr_b16 v[112:113], v2 offset:16384
  ds_read_b64_tr_b16 v[114:115], v5 offset:16384
  s_mov_b32 m0, s5
  s_nop 0
  buffer_load_dwordx4 v15, s[32:35], s54 offen offset:0 sc1 lds
  s_waitcnt lgkmcnt(4)
  v_mfma_f32_32x32x16_bf16 v[96:111], v[116:119], v[124:127], v[96:111]
  ds_read_b64_tr_b16 v[116:117], v2 offset:16640
  ds_read_b64_tr_b16 v[118:119], v5 offset:16640
  v_exp_f32 v80, v80
  v_exp_f32 v81, v81
  v_exp_f32 v82, v82
  v_exp_f32 v83, v83
  v_exp_f32 v84, v84
  v_exp_f32 v85, v85
  v_exp_f32 v86, v86
  v_exp_f32 v87, v87
  v_exp_f32 v88, v88
  v_exp_f32 v89, v89
  v_exp_f32 v90, v90
  v_exp_f32 v91, v91
  v_exp_f32 v92, v92
  v_exp_f32 v93, v93
  v_exp_f32 v94, v94
  v_exp_f32 v95, v95
  v_cvt_pk_bf16_f32 v120, v80, v81
  v_cvt_pk_bf16_f32 v121, v82, v83
  v_cvt_pk_bf16_f32 v122, v84, v85
  v_cvt_pk_bf16_f32 v123, v86, v87
  v_cvt_pk_bf16_f32 v124, v88, v89
  v_cvt_pk_bf16_f32 v125, v90, v91
  v_cvt_pk_bf16_f32 v126, v92, v93
  v_cvt_pk_bf16_f32 v127, v94, v95
  s_setprio 1
  s_waitcnt lgkmcnt(5)
  v_mfma_f32_32x32x16_bf16 v[80:95], v[136:139], v[128:131], 0
  s_mov_b32 m0, s5
  s_nop 0
  buffer_load_dwordx4 v15, s[32:35], s54 offen offset:1024 sc1 lds
  s_waitcnt lgkmcnt(4)
  v_mfma_f32_32x32x16_bf16 v[80:95], v[140:143], v[132:135], v[80:95]
  ds_read_b128 v[136:139], v246 offset:20480
  ds_read_b128 v[140:143], v246 offset:21504
  s_mov_b32 m0, s5
  s_nop 0
  buffer_load_dwordx4 v15, s[32:35], s57 offen offset:2048 sc1 lds
  s_waitcnt lgkmcnt(4)
  v_mfma_f32_32x32x16_bf16 v[96:111], v[112:115], v[120:123], v[96:111]
  ds_read_b64_tr_b16 v[112:113], v2 offset:20480
  ds_read_b64_tr_b16 v[114:115], v5 offset:20480
  s_mov_b32 m0, s5
  s_nop 0
  buffer_load_dwordx4 v15, s[32:35], s57 offen offset:3072 sc1 lds
  s_add_u32 s5, s5, 16384
  s_waitcnt lgkmcnt(4)
  v_mfma_f32_32x32x16_bf16 v[96:111], v[116:119], v[124:127], v[96:111]
  ds_read_b64_tr_b16 v[116:117], v2 offset:20736
  ds_read_b64_tr_b16 v[118:119], v5 offset:20736
  s_sub_u32 s54, s5, 49152
  s_cmp_ge_i32 s54, s22
  s_cselect_b32 s5, s54, s5
L_pb_chk:
  s_waitcnt vmcnt(8)
  v_cmp_ne_u64 s[48:49], v[244:245], v[240:241]
  s_nop 0
  s_and_b32 s48, s48, 255
  s_cmp_eq_u32 s48, 0
  s_cbranch_scc0 L_pb_spin
L_pb_ok:
  v_exp_f32 v80, v80
  v_exp_f32 v81, v81
  v_exp_f32 v82, v82
  v_exp_f32 v83, v83
  v_exp_f32 v84, v84
  v_exp_f32 v85, v85
  v_exp_f32 v86, v86
  v_exp_f32 v87, v87
  v_exp_f32 v88, v88
  v_exp_f32 v89, v89
  v_exp_f32 v90, v90
  v_exp_f32 v91, v91
  v_exp_f32 v92, v92
  v_exp_f32 v93, v93
  v_exp_f32 v94, v94
  v_exp_f32 v95, v95
  v_cvt_pk_bf16_f32 v120, v80, v81
  v_cvt_pk_bf16_f32 v121, v82, v83
  v_cvt_pk_bf16_f32 v122, v84, v85
  v_cvt_pk_bf16_f32 v123, v86, v87
  v_cvt_pk_bf16_f32 v124, v88, v89
  v_cvt_pk_bf16_f32 v125, v90, v91
  v_cvt_pk_bf16_f32 v126, v92, v93
  v_cvt_pk_bf16_f32 v127, v94, v95
  s_setprio 0
  s_waitcnt lgkmcnt(5)
  v_mfma_f32_32x32x16_bf16 v[80:95], v[136:139], v[128:131], 0
  buffer_load_dwordx4 v[144:147], v15, s[32:35], s62 offen sc1
  s_waitcnt lgkmcnt(4)
  v_mfma_f32_32x32x16_bf16 v[80:95], v[140:143], v[132:135], v[80:95]
  ds_read_b128 v[136:139], v246 offset:24576
  ds_read_b128 v[140:143], v246 offset:25600
  buffer_load_dwordx4 v[148:151], v254, s[32:35], s62 offen sc1
  s_add_u32 s62, s62, 8192
  s_sub_u32 s55, s62, s61
  s_waitcnt lgkmcnt(4)
  v_mfma_f32_32x32x16_bf16 v[96:111], v[112:115], v[120:123], v[96:111]
  ds_read_b64_tr_b16 v[112:113], v2 offset:24576
  ds_read_b64_tr_b16 v[114:115], v5 offset:24576
  s_add_u32 m0, s64, 6144
  s_nop 0
  buffer_load_dwordx4 v6, s[28:31], s63 offen lds
  s_sub_u32 s73, s62, 32768
  s_waitcnt lgkmcnt(4)
  v_mfma_f32_32x32x16_bf16 v[96:111], v[116:119], v[124:127], v[96:111]
  ds_read_b64_tr_b16 v[116:117], v2 offset:24832
  ds_read_b64_tr_b16 v[118:119], v5 offset:24832
  s_cmp_eq_u32 s55, 32768
  s_cselect_b32 s62, s73, s62
  v_exp_f32 v80, v80
  v_exp_f32 v81, v81
  v_exp_f32 v82, v82
  v_exp_f32 v83, v83
  v_exp_f32 v84, v84
  v_exp_f32 v85, v85
  v_exp_f32 v86, v86
  v_exp_f32 v87, v87
  v_exp_f32 v88, v88
  v_exp_f32 v89, v89
  v_exp_f32 v90, v90
  v_exp_f32 v91, v91
  v_exp_f32 v92, v92
  v_exp_f32 v93, v93
  v_exp_f32 v94, v94
  v_exp_f32 v95, v95
  v_cvt_pk_bf16_f32 v120, v80, v81
  v_cvt_pk_bf16_f32 v121, v82, v83
  v_cvt_pk_bf16_f32 v122, v84, v85
  v_cvt_pk_bf16_f32 v123, v86, v87
  v_cvt_pk_bf16_f32 v124, v88, v89
  v_cvt_pk_bf16_f32 v125, v90, v91
  v_cvt_pk_bf16_f32 v126, v92, v93
  v_cvt_pk_bf16_f32 v127, v94, v95
  s_cbranch_vccz L_sk3
  s_waitcnt lgkmcnt(0)
  s_barrier
L_sk3:
  s_setprio 3
  s_waitcnt lgkmcnt(5)
  v_mfma_f32_32x32x16_bf16 v[80:95], v[136:139], v[128:131], 0
  buffer_load_dwordx4 v[152:155], v15, s[32:35], s62 offen sc1
  s_mul_i32 s54, s4, 6144
  s_add_u32 s57, s4, 31
  s_add_u32 s54, s54, s21
  s_and_b32 s57, s57, 31
  s_waitcnt lgkmcnt(4)
  v_mfma_f32_32x32x16_bf16 v[80:95], v[140:143], v[132:135], v[80:95]
  ds_read_b128 v[136:139], v246 offset:28672
  ds_read_b128 v[140:143], v246 offset:29696
  buffer_load_dwordx4 v[156:159], v254, s[32:35], s62 offen sc1
  s_add_u32 s62, s62, 8192
  s_sub_u32 s55, s62, s61
  s_waitcnt lgkmcnt(4)
  v_mfma_f32_32x32x16_bf16 v[96:111], v[112:115], v[120:123], v[96:111]
  ds_read_b64_tr_b16 v[112:113], v2 offset:28672
  ds_read_b64_tr_b16 v[114:115], v5 offset:28672
  s_add_u32 m0, s64, 6144
  s_nop 0
  buffer_load_dwordx4 v7, s[28:31], s63 offen offset:1024 lds
  s_sub_u32 s73, s62, 32768
  s_waitcnt lgkmcnt(4)
  v_mfma_f32_32x32x16_bf16 v[96:111], v[116:119], v[124:127], v[96:111]
  ds_read_b64_tr_b16 v[116:117], v2 offset:28928
  ds_read_b64_tr_b16 v[118:119], v5 offset:28928
  s_cmp_eq_u32 s55, 32768
  s_cselect_b32 s62, s73, s62
  s_mul_i32 s57, s57, 6144
  s_add_u32 s57, s57, s21
  s_add_u32 s4, s4, 4
  s_and_b32 s4, s4, 31
  s_lshl_b32 s63, s66, 3
  s_add_u32 s63, s63, s3
  s_cbranch_vccnz L_sk4
  s_waitcnt lgkmcnt(0)
  s_barrier
L_sk4:
  v_exp_f32 v80, v80
  v_exp_f32 v81, v81
  v_exp_f32 v82, v82
  v_exp_f32 v83, v83
  v_exp_f32 v84, v84
  v_exp_f32 v85, v85
  v_exp_f32 v86, v86
  v_exp_f32 v87, v87
  v_exp_f32 v88, v88
  v_exp_f32 v89, v89
  v_exp_f32 v90, v90
  v_exp_f32 v91, v91
  v_exp_f32 v92, v92
  v_exp_f32 v93, v93
  v_exp_f32 v94, v94
  v_exp_f32 v95, v95
  v_cvt_pk_bf16_f32 v120, v80, v81
  v_cvt_pk_bf16_f32 v121, v82, v83
  v_cvt_pk_bf16_f32 v122, v84, v85
  v_cvt_pk_bf16_f32 v123, v86, v87
  v_cvt_pk_bf16_f32 v124, v88, v89
  v_cvt_pk_bf16_f32 v125, v90, v91
  v_cvt_pk_bf16_f32 v126, v92, v93
  v_cvt_pk_bf16_f32 v127, v94, v95
  s_setprio 2
  s_waitcnt lgkmcnt(5)
  v_mfma_f32_32x32x16_bf16 v[80:95], v[136:139], v[128:131], 0
  s_mov_b32 m0, s5
  s_nop 0
  buffer_load_dwordx4 v15, s[32:35], s54 offen offset:0 sc1 lds
  s_mul_i32 s63, s63, 14336
  s_add_u32 s63, s63, s78
  s_waitcnt lgkmcnt(4)
  v_mfma_f32_32x32x16_bf16 v[80:95], v[140:143], v[132:135], v[80:95]
  ds_read_b128 v[136:139], v246 offset:32768
  ds_read_b128 v[140:143], v246 offset:33792
  s_mov_b32 m0, s5
  s_nop 0
  buffer_load_dwordx4 v15, s[32:35], s54 offen offset:1024 sc1 lds
  s_waitcnt lgkmcnt(4)
  v_mfma_f32_32x32x16_bf16 v[96:111], v[112:115], v[120:123], v[96:111]
  ds_read_b64_tr_b16 v[112:113], v2 offset:32768
  ds_read_b64_tr_b16 v[114:115], v5 offset:32768
  s_mov_b32 m0, s5
  s_nop 0
  buffer_load_dwordx4 v15, s[32:35], s57 offen offset:2048 sc1 lds
  s_waitcnt lgkmcnt(4)
  v_mfma_f32_32x32x16_bf16 v[96:111], v[116:119], v[124:127], v[96:111]
  ds_read_b64_tr_b16 v[116:117], v2 offset:33024
  ds_read_b64_tr_b16 v[118:119], v5 offset:33024
  ds_read_b64_tr_b16 v[200:201], v242 offset:0
  ds_read_b64_tr_b16 v[202:203], v242 offset:1024
  ds_read_b64_tr_b16 v[204:205], v243 offset:0
  ds_read_b64_tr_b16 v[206:207], v243 offset:1024
  v_exp_f32 v80, v80
  v_exp_f32 v81, v81
  v_exp_f32 v82, v82
  v_exp_f32 v83, v83
  v_exp_f32 v84, v84
  v_exp_f32 v85, v85
  v_exp_f32 v86, v86
  v_exp_f32 v87, v87
  v_exp_f32 v88, v88
  v_exp_f32 v89, v89
  v_exp_f32 v90, v90
  v_exp_f32 v91, v91
  v_exp_f32 v92, v92
  v_exp_f32 v93, v93
  v_exp_f32 v94, v94
  v_exp_f32 v95, v95
  v_cvt_pk_bf16_f32 v120, v80, v81
  v_cvt_pk_bf16_f32 v121, v82, v83
  v_cvt_pk_bf16_f32 v122, v84, v85
  v_cvt_pk_bf16_f32 v123, v86, v87
  v_cvt_pk_bf16_f32 v124, v88, v89
  v_cvt_pk_bf16_f32 v125, v90, v91
  v_cvt_pk_bf16_f32 v126, v92, v93
  v_cvt_pk_bf16_f32 v127, v94, v95
  s_setprio 1
  s_waitcnt lgkmcnt(9)
  v_mfma_f32_32x32x16_bf16 v[80:95], v[136:139], v[128:131], 0
  s_mov_b32 m0, s5
  s_nop 0
  buffer_load_dwordx4 v15, s[32:35], s57 offen offset:3072 sc1 lds
  s_add_u32 s5, s5, 16384
  s_sub_u32 s54, s5, 49152
  s_cmp_ge_i32 s54, s22
  s_cselect_b32 s5, s54, s5
  s_waitcnt lgkmcnt(8)
  v_mfma_f32_32x32x16_bf16 v[80:95], v[140:143], v[132:135], v[80:95]
  ds_read_b128 v[136:139], v246 offset:36864
  ds_read_b128 v[140:143], v246 offset:37888
  s_lshl_b32 s68, s10, 14
  s_cmp_eq_u32 s10, 1
  s_cselect_b32 s68, 81920, s68
  s_waitcnt lgkmcnt(8)
  v_mfma_f32_32x32x16_bf16 v[96:111], v[112:115], v[120:123], v[96:111]
  ds_read_b64_tr_b16 v[112:113], v2 offset:36864
  ds_read_b64_tr_b16 v[114:115], v5 offset:36864
  buffer_load_dwordx4 v[160:163], v15, s[32:35], s62 offen sc1
  s_add_u32 s70, s10, 1
  s_and_b32 s70, s70, 2
  s_waitcnt lgkmcnt(8)
  v_mfma_f32_32x32x16_bf16 v[96:111], v[116:119], v[124:127], v[96:111]
  ds_read_b64_tr_b16 v[116:117], v2 offset:37120
  ds_read_b64_tr_b16 v[118:119], v5 offset:37120
  s_mul_i32 s69, s10, 100352
  s_add_u32 s69, s69, s78
  s_mov_b32 s44, s8
  s_waitcnt vmcnt(10) lgkmcnt(8)
  v_mfma_f32_32x32x16_bf16 v[16:31], v[200:203], v[144:147], 0
  buffer_load_dwordx4 v[164:167], v254, s[32:35], s62 offen sc1
  s_add_u32 s62, s62, 8192
  s_sub_u32 s55, s62, s61
  s_sub_u32 s73, s62, 32768
  s_cmp_eq_u32 s55, 32768
  s_cselect_b32 s62, s73, s62
  s_waitcnt vmcnt(10)
  v_mfma_f32_32x32x16_bf16 v[32:47], v[200:203], v[148:151], 0
  v_exp_f32 v80, v80
  v_exp_f32 v81, v81
  v_exp_f32 v82, v82
  v_exp_f32 v83, v83
  v_exp_f32 v84, v84
  v_exp_f32 v85, v85
  v_exp_f32 v86, v86
  v_exp_f32 v87, v87
  v_exp_f32 v88, v88
  v_exp_f32 v89, v89
  v_exp_f32 v90, v90
  v_exp_f32 v91, v91
  v_exp_f32 v92, v92
  v_exp_f32 v93, v93
  v_exp_f32 v94, v94
  v_exp_f32 v95, v95
  v_cvt_pk_bf16_f32 v120, v80, v81
  v_cvt_pk_bf16_f32 v121, v82, v83
  v_cvt_pk_bf16_f32 v122, v84, v85
  v_cvt_pk_bf16_f32 v123, v86, v87
  v_cvt_pk_bf16_f32 v124, v88, v89
  v_cvt_pk_bf16_f32 v125, v90, v91
  v_cvt_pk_bf16_f32 v126, v92, v93
  v_cvt_pk_bf16_f32 v127, v94, v95
  s_setprio 0
  s_waitcnt lgkmcnt(5)
  v_mfma_f32_32x32x16_bf16 v[80:95], v[136:139], v[128:131], 0
  buffer_load_dwordx2 v[244:245], v1, s[32:35], 0 offen sc1
  s_mov_b32 s45, s9
  s_mov_b32 s46, 401408
  s_mul_i32 s67, s52, 3
  s_lshr_b32 s71, s67, 1
  s_waitcnt lgkmcnt(4)
  v_mfma_f32_32x32x16_bf16 v[80:95], v[140:143], v[132:135], v[80:95]
  ds_read_b128 v[136:139], v246 offset:40960
  ds_read_b128 v[140:143], v246 offset:41984
  s_mul_i32 s71, s71, -3584
  s_mul_i32 s72, s67, 14336
  s_add_u32 s71, s71, s72
  s_waitcnt lgkmcnt(4)
  v_mfma_f32_32x32x16_bf16 v[96:111], v[112:115], v[120:123], v[96:111]
  ds_read_b64_tr_b16 v[112:113], v2 offset:40960
  ds_read_b64_tr_b16 v[114:115], v5 offset:40960
  buffer_load_dwordx4 v[168:171], v15, s[32:35], s62 offen sc1
  s_add_u32 s71, s71, s69
  s_add_u32 s72, s67, s70
  s_waitcnt lgkmcnt(4)
  v_mfma_f32_32x32x16_bf16 v[96:111], v[116:119], v[124:127], v[96:111]
  ds_read_b64_tr_b16 v[116:117], v2 offset:41216
  ds_read_b64_tr_b16 v[118:119], v5 offset:41216
  s_and_b32 s72, s72, 7
  s_lshl_b32 s72, s72, 11
  s_add_u32 s72, s72, s68
  v_mfma_f32_32x32x16_bf16 v[48:63], v[204:207], v[144:147], 0
  buffer_load_dwordx4 v[172:175], v254, s[32:35], s62 offen sc1
  s_lshl_b32 s62, s66, 13
  s_add_u32 s62, s62, s61
  s_bitcmp1_b32 s67, 0
  s_cselect_b32 s67, 10752, s60
  s_cselect_b32 s67, s67, 14336
  v_mfma_f32_32x32x16_bf16 v[64:79], v[204:207], v[148:151], 0
  ds_read_b64_tr_b16 v[192:193], v242 offset:2048
  ds_read_b64_tr_b16 v[194:195], v242 offset:3072
  ds_read_b64_tr_b16 v[196:197], v243 offset:2048
  ds_read_b64_tr_b16 v[198:199], v243 offset:3072
  v_exp_f32 v80, v80
  v_exp_f32 v81, v81
  v_exp_f32 v82, v82
  v_exp_f32 v83, v83
  v_exp_f32 v84, v84
  v_exp_f32 v85, v85
  v_exp_f32 v86, v86
  v_exp_f32 v87, v87
  v_exp_f32 v88, v88
  v_exp_f32 v89, v89
  v_exp_f32 v90, v90
  v_exp_f32 v91, v91
  v_exp_f32 v92, v92
  v_exp_f32 v93, v93
  v_exp_f32 v94, v94
  v_exp_f32 v95, v95
  v_cvt_pk_bf16_f32 v120, v80, v81
  v_cvt_pk_bf16_f32 v121, v82, v83
  v_cvt_pk_bf16_f32 v122, v84, v85
  v_cvt_pk_bf16_f32 v123, v86, v87
  v_cvt_pk_bf16_f32 v124, v88, v89
  v_cvt_pk_bf16_f32 v125, v90, v91
  v_cvt_pk_bf16_f32 v126, v92, v93
  v_cvt_pk_bf16_f32 v127, v94, v95
  s_cbranch_vccz L_sk5
  s_waitcnt lgkmcnt(0)
  s_barrier
L_sk5:
  s_setprio 3
  s_waitcnt lgkmcnt(9)
  v_mfma_f32_32x32x16_bf16 v[80:95], v[136:139], v[128:131], 0
  s_add_u32 m0, s64, 0
  s_nop 0
  buffer_load_dwordx4 v6, s[28:31], s63 offen lds
  s_mul_i32 s54, s4, 6144
  s_add_u32 s57, s4, 31
  s_add_u32 s54, s54, s21
  s_waitcnt lgkmcnt(8)
  v_mfma_f32_32x32x16_bf16 v[80:95], v[140:143], v[132:135], v[80:95]
  ds_read_b128 v[136:139], v246 offset:45056
  ds_read_b128 v[140:143], v246 offset:46080
  s_and_b32 s57, s57, 31
  s_mul_i32 s57, s57, 6144
  s_add_u32 s57, s57, s21
  s_waitcnt lgkmcnt(8)
  v_mfma_f32_32x32x16_bf16 v[96:111], v[112:115], v[120:123], v[96:111]
  ds_read_b64_tr_b16 v[112:113], v2 offset:45056
  ds_read_b64_tr_b16 v[114:115], v5 offset:45056
  s_add_u32 m0, s64, 0
  s_nop 0
  buffer_load_dwordx4 v7, s[28:31], s63 offen offset:1024 lds
  s_add_u32 s63, s63, 114688
  s_waitcnt lgkmcnt(8)
  v_mfma_f32_32x32x16_bf16 v[96:111], v[116:119], v[124:127], v[96:111]
  ds_read_b64_tr_b16 v[116:117], v2 offset:45312
  ds_read_b64_tr_b16 v[118:119], v5 offset:45312
  s_sub_u32 s56, s63, 1146880
  s_cmp_ge_u32 s63, 1605632
  s_cselect_b32 s63, s56, s63
  s_waitcnt vmcnt(13) lgkmcnt(8)
  v_mfma_f32_32x32x16_bf16 v[16:31], v[192:195], v[152:155], v[16:31]
  s_add_u32 m0, s64, 2048
  s_nop 0
  buffer_load_dwordx4 v6, s[28:31], s63 offen lds
  s_add_u32 s4, s4, 4
  s_and_b32 s4, s4, 31
  s_waitcnt vmcnt(13)
  v_mfma_f32_32x32x16_bf16 v[32:47], v[192:195], v[156:159], v[32:47]
  s_cbranch_vccnz L_sk6
  s_waitcnt lgkmcnt(0)
  s_barrier
L_sk6:
  v_exp_f32 v80, v80
  v_exp_f32 v81, v81
  v_exp_f32 v82, v82
  v_exp_f32 v83, v83
  v_exp_f32 v84, v84
  v_exp_f32 v85, v85
  v_exp_f32 v86, v86
  v_exp_f32 v87, v87
  v_exp_f32 v88, v88
  v_exp_f32 v89, v89
  v_exp_f32 v90, v90
  v_exp_f32 v91, v91
  v_exp_f32 v92, v92
  v_exp_f32 v93, v93
  v_exp_f32 v94, v94
  v_exp_f32 v95, v95
  v_cvt_pk_bf16_f32 v120, v80, v81
  v_cvt_pk_bf16_f32 v121, v82, v83
  v_cvt_pk_bf16_f32 v122, v84, v85
  v_cvt_pk_bf16_f32 v123, v86, v87
  v_cvt_pk_bf16_f32 v124, v88, v89
  v_cvt_pk_bf16_f32 v125, v90, v91
  v_cvt_pk_bf16_f32 v126, v92, v93
  v_cvt_pk_bf16_f32 v127, v94, v95
  s_setprio 2
  s_waitcnt lgkmcnt(5)
  v_mfma_f32_32x32x16_bf16 v[80:95], v[136:139], v[128:131], 0
  s_mov_b32 m0, s5
  s_nop 0
  buffer_load_dwordx4 v15, s[32:35], s54 offen offset:0 sc1 lds
  s_waitcnt lgkmcnt(4)
  v_mfma_f32_32x32x16_bf16 v[80:95], v[140:143], v[132:135], v[80:95]
  ds_read_b128 v[136:139], v246 offset:0
  ds_read_b128 v[140:143], v246 offset:1024
  s_waitcnt lgkmcnt(4)
  v_mfma_f32_32x32x16_bf16 v[96:111], v[112:115], v[120:123], v[96:111]
  ds_read_b64_tr_b16 v[112:113], v2 offset:0
  ds_read_b64_tr_b16 v[114:115], v5 offset:0
  s_mov_b32 m0, s5
  s_nop 0
  buffer_load_dwordx4 v15, s[32:35], s54 offen offset:1024 sc1 lds
  s_waitcnt lgkmcnt(4)
  v_mfma_f32_32x32x16_bf16 v[96:111], v[116:119], v[124:127], v[96:111]
  ds_read_b64_tr_b16 v[116:117], v2 offset:256
  ds_read_b64_tr_b16 v[118:119], v5 offset:256
  v_mfma_f32_32x32x16_bf16 v[48:63], v[196:199], v[152:155], v[48:63]
  s_mov_b32 m0, s5
  s_nop 0
  buffer_load_dwordx4 v15, s[32:35], s57 offen offset:2048 sc1 lds
  v_mfma_f32_32x32x16_bf16 v[64:79], v[196:199], v[156:159], v[64:79]
  ds_read_b64_tr_b16 v[184:185], v242 offset:4096
  ds_read_b64_tr_b16 v[186:187], v242 offset:5120
  ds_read_b64_tr_b16 v[188:189], v243 offset:4096
  ds_read_b64_tr_b16 v[190:191], v243 offset:5120
L_pc_chk:
  s_waitcnt vmcnt(8)
  v_cmp_ne_u64 s[48:49], v[244:245], v[240:241]
  s_nop 0
  s_cmp_eq_u64 s[48:49], 0
  s_cbranch_scc0 L_pc_spin
L_pc_ok:
  v_exp_f32 v80, v80
  v_exp_f32 v81, v81
  v_exp_f32 v82, v82
  v_exp_f32 v83, v83
  v_exp_f32 v84, v84
  v_exp_f32 v85, v85
  v_exp_f32 v86, v86
  v_exp_f32 v87, v87
  v_exp_f32 v88, v88
  v_exp_f32 v89, v89
  v_exp_f32 v90, v90
  v_exp_f32 v91, v91
  v_exp_f32 v92, v92
  v_exp_f32 v93, v93
  v_exp_f32 v94, v94
  v_exp_f32 v95, v95
  v_cvt_pk_bf16_f32 v120, v80, v81
  v_cvt_pk_bf16_f32 v121, v82, v83
  v_cvt_pk_bf16_f32 v122, v84, v85
  v_cvt_pk_bf16_f32 v123, v86, v87
  v_cvt_pk_bf16_f32 v124, v88, v89
  v_cvt_pk_bf16_f32 v125, v90, v91
  v_cvt_pk_bf16_f32 v126, v92, v93
  v_cvt_pk_bf16_f32 v127, v94, v95
  s_setprio 1
  s_waitcnt lgkmcnt(9)
  v_mfma_f32_32x32x16_bf16 v[80:95], v[136:139], v[128:131], 0
  s_mov_b32 m0, s5
  s_nop 0
  buffer_load_dwordx4 v15, s[32:35], s57 offen offset:3072 sc1 lds
  s_add_u32 s5, s5, 16384
  s_sub_u32 s54, s5, 49152
  s_cmp_ge_i32 s54, s22
  s_cselect_b32 s5, s54, s5
  s_waitcnt lgkmcnt(8)
  v_mfma_f32_32x32x16_bf16 v[80:95], v[140:143], v[132:135], v[80:95]
  ds_read_b128 v[136:139], v246 offset:4096
  ds_read_b128 v[140:143], v246 offset:5120
  s_waitcnt lgkmcnt(8)
  v_mfma_f32_32x32x16_bf16 v[96:111], v[112:115], v[120:123], v[96:111]
  ds_read_b64_tr_b16 v[112:113], v2 offset:4096
  ds_read_b64_tr_b16 v[114:115], v5 offset:4096
  buffer_load_dwordx4 v[144:147], v15, s[32:35], s62 offen sc1
  s_waitcnt lgkmcnt(8)
  v_mfma_f32_32x32x16_bf16 v[96:111], v[116:119], v[124:127], v[96:111]
  ds_read_b64_tr_b16 v[116:117], v2 offset:4352
  ds_read_b64_tr_b16 v[118:119], v5 offset:4352
  s_waitcnt lgkmcnt(8)
  v_mfma_f32_32x32x16_bf16 v[16:31], v[184:187], v[160:163], v[16:31]
  buffer_load_dwordx4 v[148:151], v254, s[32:35], s62 offen sc1
  s_add_u32 s62, s62, 8192
  s_sub_u32 s55, s62, s61
  s_sub_u32 s73, s62, 81920
  s_cmp_eq_u32 s55, 114688
  s_cselect_b32 s62, s73, s62
  v_mfma_f32_32x32x16_bf16 v[32:47], v[184:187], v[164:167], v[32:47]
  v_exp_f32 v80, v80
  v_exp_f32 v81, v81
  v_exp_f32 v82, v82
  v_exp_f32 v83, v83
  v_exp_f32 v84, v84
  v_exp_f32 v85, v85
  v_exp_f32 v86, v86
  v_exp_f32 v87, v87
  v_exp_f32 v88, v88
  v_exp_f32 v89, v89
  v_exp_f32 v90, v90
  v_exp_f32 v91, v91
  v_exp_f32 v92, v92
  v_exp_f32 v93, v93
  v_exp_f32 v94, v94
  v_exp_f32 v95, v95
  v_cvt_pk_bf16_f32 v120, v80, v81
  v_cvt_pk_bf16_f32 v121, v82, v83
  v_cvt_pk_bf16_f32 v122, v84, v85
  v_cvt_pk_bf16_f32 v123, v86, v87
  v_cvt_pk_bf16_f32 v124, v88, v89
  v_cvt_pk_bf16_f32 v125, v90, v91
  v_cvt_pk_bf16_f32 v126, v92, v93
  v_cvt_pk_bf16_f32 v127, v94, v95
  s_setprio 0
  s_waitcnt lgkmcnt(5)
  v_mfma_f32_32x32x16_bf16 v[80:95], v[136:139], v[128:131], 0
  s_add_u32 m0, s64, 2048
  s_nop 0
  buffer_load_dwordx4 v7, s[28:31], s63 offen offset:1024 lds
  s_add_u32 s63, s63, 114688
  s_sub_u32 s56, s63, 1146880
  s_cmp_ge_u32 s63, 1605632
  s_cselect_b32 s63, s56, s63
  s_waitcnt lgkmcnt(4)
  v_mfma_f32_32x32x16_bf16 v[80:95], v[140:143], v[132:135], v[80:95]
  ds_read_b128 v[136:139], v246 offset:8192
  ds_read_b128 v[140:143], v246 offset:9216
  s_waitcnt lgkmcnt(4)
  v_mfma_f32_32x32x16_bf16 v[96:111], v[112:115], v[120:123], v[96:111]
  ds_read_b64_tr_b16 v[112:113], v2 offset:8192
  ds_read_b64_tr_b16 v[114:115], v5 offset:8192
  buffer_load_dwordx4 v[152:155], v15, s[32:35], s62 offen sc1
  s_waitcnt lgkmcnt(4)
  v_mfma_f32_32x32x16_bf16 v[96:111], v[116:119], v[124:127], v[96:111]
  ds_read_b64_tr_b16 v[116:117], v2 offset:8448
  ds_read_b64_tr_b16 v[118:119], v5 offset:8448
  v_mfma_f32_32x32x16_bf16 v[48:63], v[188:191], v[160:163], v[48:63]
  buffer_load_dwordx4 v[156:159], v254, s[32:35], s62 offen sc1
  s_add_u32 s62, s62, 8192
  s_sub_u32 s55, s62, s61
  s_sub_u32 s73, s62, 81920
  s_cmp_eq_u32 s55, 114688
  s_cselect_b32 s62, s73, s62
  v_mfma_f32_32x32x16_bf16 v[64:79], v[188:191], v[164:167], v[64:79]
  ds_read_b64_tr_b16 v[176:177], v242 offset:6144
  ds_read_b64_tr_b16 v[178:179], v242 offset:7168
  ds_read_b64_tr_b16 v[180:181], v243 offset:6144
  ds_read_b64_tr_b16 v[182:183], v243 offset:7168
  v_exp_f32 v80, v80
  v_exp_f32 v81, v81
  v_exp_f32 v82, v82
  v_exp_f32 v83, v83
  v_exp_f32 v84, v84
  v_exp_f32 v85, v85
  v_exp_f32 v86, v86
  v_exp_f32 v87, v87
  v_exp_f32 v88, v88
  v_exp_f32 v89, v89
  v_exp_f32 v90, v90
  v_exp_f32 v91, v91
  v_exp_f32 v92, v92
  v_exp_f32 v93, v93
  v_exp_f32 v94, v94
  v_exp_f32 v95, v95
  v_cvt_pk_bf16_f32 v120, v80, v81
  v_cvt_pk_bf16_f32 v121, v82, v83
  v_cvt_pk_bf16_f32 v122, v84, v85
  v_cvt_pk_bf16_f32 v123, v86, v87
  v_cvt_pk_bf16_f32 v124, v88, v89
  v_cvt_pk_bf16_f32 v125, v90, v91
  v_cvt_pk_bf16_f32 v126, v92, v93
  v_cvt_pk_bf16_f32 v127, v94, v95
  s_cbranch_vccz L_sk7
  s_waitcnt lgkmcnt(0)
  s_barrier
L_sk7:
  s_setprio 3
  s_waitcnt lgkmcnt(9)
  v_mfma_f32_32x32x16_bf16 v[80:95], v[136:139], v[128:131], 0
  s_add_u32 m0, s64, 4096
  s_nop 0
  buffer_load_dwordx4 v6, s[28:31], s63 offen lds
  s_mul_i32 s54, s4, 6144
  s_add_u32 s57, s4, 31
  s_add_u32 s54, s54, s21
  s_waitcnt lgkmcnt(8)
  v_mfma_f32_32x32x16_bf16 v[80:95], v[140:143], v[132:135], v[80:95]
  ds_read_b128 v[136:139], v246 offset:12288
  ds_read_b128 v[140:143], v246 offset:13312
  s_and_b32 s57, s57, 31
  s_mul_i32 s57, s57, 6144
  s_add_u32 s57, s57, s21
  s_waitcnt lgkmcnt(8)
  v_mfma_f32_32x32x16_bf16 v[96:111], v[112:115], v[120:123], v[96:111]
  ds_read_b64_tr_b16 v[112:113], v2 offset:12288
  ds_read_b64_tr_b16 v[114:115], v5 offset:12288
  s_add_u32 m0, s64, 4096
  s_nop 0
  buffer_load_dwordx4 v7, s[28:31], s63 offen offset:1024 lds
  s_add_u32 s63, s63, 114688
  s_waitcnt lgkmcnt(8)
  v_mfma_f32_32x32x16_bf16 v[96:111], v[116:119], v[124:127], v[96:111]
  ds_read_b64_tr_b16 v[116:117], v2 offset:12544
  ds_read_b64_tr_b16 v[118:119], v5 offset:12544
  s_sub_u32 s56, s63, 1146880
  s_cmp_ge_u32 s63, 1605632
  s_cselect_b32 s63, s56, s63
  s_waitcnt vmcnt(15) lgkmcnt(8)
  v_mfma_f32_32x32x16_bf16 v[16:31], v[176:179], v[168:171], v[16:31]
  buffer_load_dwordx4 v[160:163], v15, s[32:35], s62 offen sc1
  s_add_u32 s4, s4, 4
  s_and_b32 s4, s4, 31
  s_waitcnt vmcnt(15)
  v_mfma_f32_32x32x16_bf16 v[32:47], v[176:179], v[172:175], v[32:47]
  s_cbranch_vccnz L_sk8
  s_waitcnt lgkmcnt(0)
  s_barrier
L_sk8:
  v_exp_f32 v80, v80
  v_exp_f32 v81, v81
  v_exp_f32 v82, v82
  v_exp_f32 v83, v83
  v_exp_f32 v84, v84
  v_exp_f32 v85, v85
  v_exp_f32 v86, v86
  v_exp_f32 v87, v87
  v_exp_f32 v88, v88
  v_exp_f32 v89, v89
  v_exp_f32 v90, v90
  v_exp_f32 v91, v91
  v_exp_f32 v92, v92
  v_exp_f32 v93, v93
  v_exp_f32 v94, v94
  v_exp_f32 v95, v95
  v_cvt_pk_bf16_f32 v120, v80, v81
  v_cvt_pk_bf16_f32 v121, v82, v83
  v_cvt_pk_bf16_f32 v122, v84, v85
  v_cvt_pk_bf16_f32 v123, v86, v87
  v_cvt_pk_bf16_f32 v124, v88, v89
  v_cvt_pk_bf16_f32 v125, v90, v91
  v_cvt_pk_bf16_f32 v126, v92, v93
  v_cvt_pk_bf16_f32 v127, v94, v95
  s_setprio 2
  s_waitcnt lgkmcnt(5)
  v_mfma_f32_32x32x16_bf16 v[80:95], v[136:139], v[128:131], 0
  s_mov_b32 m0, s5
  s_nop 0
  buffer_load_dwordx4 v15, s[32:35], s54 offen offset:0 sc1 lds
  s_waitcnt lgkmcnt(4)
  v_mfma_f32_32x32x16_bf16 v[80:95], v[140:143], v[132:135], v[80:95]
  ds_read_b128 v[136:139], v246 offset:16384
  ds_read_b128 v[140:143], v246 offset:17408
  s_waitcnt lgkmcnt(4)
  v_mfma_f32_32x32x16_bf16 v[96:111], v[112:115], v[120:123], v[96:111]
  ds_read_b64_tr_b16 v[112:113], v2 offset:16384
  ds_read_b64_tr_b16 v[114:115], v5 offset:16384
  s_mov_b32 m0, s5
  s_nop 0
  buffer_load_dwordx4 v15, s[32:35], s54 offen offset:1024 sc1 lds
  s_waitcnt lgkmcnt(4)
  v_mfma_f32_32x32x16_bf16 v[96:111], v[116:119], v[124:127], v[96:111]
  ds_read_b64_tr_b16 v[116:117], v2 offset:16640
  ds_read_b64_tr_b16 v[118:119], v5 offset:16640
  v_mfma_f32_32x32x16_bf16 v[48:63], v[180:183], v[168:171], v[48:63]
  s_mov_b32 m0, s5
  s_nop 0
  buffer_load_dwordx4 v15, s[32:35], s57 offen offset:2048 sc1 lds
  v_mfma_f32_32x32x16_bf16 v[64:79], v[180:183], v[172:175], v[64:79]
  s_waitcnt vmcnt(16)
  ds_read_b64_tr_b16 v[208:209], v242 offset:0
  ds_read_b64_tr_b16 v[210:211], v242 offset:1024
  ds_read_b64_tr_b16 v[212:213], v243 offset:0
  ds_read_b64_tr_b16 v[214:215], v243 offset:1024
  v_exp_f32 v80, v80
  v_exp_f32 v81, v81
  v_exp_f32 v82, v82
  v_exp_f32 v83, v83
  v_exp_f32 v84, v84
  v_exp_f32 v85, v85
  v_exp_f32 v86, v86
  v_exp_f32 v87, v87
  v_exp_f32 v88, v88
  v_exp_f32 v89, v89
  v_exp_f32 v90, v90
  v_exp_f32 v91, v91
  v_exp_f32 v92, v92
  v_exp_f32 v93, v93
  v_exp_f32 v94, v94
  v_exp_f32 v95, v95
  v_cvt_pk_bf16_f32 v120, v80, v81
  v_cvt_pk_bf16_f32 v121, v82, v83
  v_cvt_pk_bf16_f32 v122, v84, v85
  v_cvt_pk_bf16_f32 v123, v86, v87
  v_cvt_pk_bf16_f32 v124, v88, v89
  v_cvt_pk_bf16_f32 v125, v90, v91
  v_cvt_pk_bf16_f32 v126, v92, v93
  v_cvt_pk_bf16_f32 v127, v94, v95
  s_setprio 1
  s_waitcnt lgkmcnt(9)
  v_mfma_f32_32x32x16_bf16 v[80:95], v[136:139], v[128:131], 0
  s_mov_b32 m0, s5
  s_nop 0
  buffer_load_dwordx4 v15, s[32:35], s57 offen offset:3072 sc1 lds
  s_add_u32 s5, s5, 16384
  s_sub_u32 s54, s5, 49152
  s_cmp_ge_i32 s54, s22
  s_cselect_b32 s5, s54, s5
  s_waitcnt lgkmcnt(8)
  v_mfma_f32_32x32x16_bf16 v[80:95], v[140:143], v[132:135], v[80:95]
  ds_read_b128 v[136:139], v246 offset:20480
  ds_read_b128 v[140:143], v246 offset:21504
  s_waitcnt lgkmcnt(8)
  v_mfma_f32_32x32x16_bf16 v[96:111], v[112:115], v[120:123], v[96:111]
  ds_read_b64_tr_b16 v[112:113], v2 offset:20480
  ds_read_b64_tr_b16 v[114:115], v5 offset:20480
  buffer_load_dwordx4 v[164:167], v254, s[32:35], s62 offen sc1
  s_add_u32 s62, s62, 8192
  s_sub_u32 s55, s62, s61
  s_waitcnt lgkmcnt(8)
  v_mfma_f32_32x32x16_bf16 v[96:111], v[116:119], v[124:127], v[96:111]
  ds_read_b64_tr_b16 v[116:117], v2 offset:20736
  ds_read_b64_tr_b16 v[118:119], v5 offset:20736
  s_sub_u32 s73, s62, 81920
  s_cmp_eq_u32 s55, 114688
  s_cselect_b32 s62, s73, s62
  s_waitcnt vmcnt(12) lgkmcnt(8)
  v_mfma_f32_32x32x16_bf16 v[16:31], v[208:211], v[144:147], v[16:31]
  s_add_u32 m0, s64, 6144
  s_nop 0
  buffer_load_dwordx4 v6, s[28:31], s63 offen lds
  s_waitcnt vmcnt(12)
  v_mfma_f32_32x32x16_bf16 v[32:47], v[208:211], v[148:151], v[32:47]
  v_exp_f32 v80, v80
  v_exp_f32 v81, v81
  v_exp_f32 v82, v82
  v_exp_f32 v83, v83
  v_exp_f32 v84, v84
  v_exp_f32 v85, v85
  v_exp_f32 v86, v86
  v_exp_f32 v87, v87
  v_exp_f32 v88, v88
  v_exp_f32 v89, v89
  v_exp_f32 v90, v90
  v_exp_f32 v91, v91
  v_exp_f32 v92, v92
  v_exp_f32 v93, v93
  v_exp_f32 v94, v94
  v_exp_f32 v95, v95
  v_cvt_pk_bf16_f32 v120, v80, v81
  v_cvt_pk_bf16_f32 v121, v82, v83
  v_cvt_pk_bf16_f32 v122, v84, v85
  v_cvt_pk_bf16_f32 v123, v86, v87
  v_cvt_pk_bf16_f32 v124, v88, v89
  v_cvt_pk_bf16_f32 v125, v90, v91
  v_cvt_pk_bf16_f32 v126, v92, v93
  v_cvt_pk_bf16_f32 v127, v94, v95
  s_setprio 0
  s_waitcnt lgkmcnt(5)
  v_mfma_f32_32x32x16_bf16 v[80:95], v[136:139], v[128:131], 0
  s_add_u32 m0, s64, 6144
  s_nop 0
  buffer_load_dwordx4 v7, s[28:31], s63 offen offset:1024 lds
  s_add_u32 s63, s63, 114688
  s_sub_u32 s56, s63, 1146880
  s_cmp_ge_u32 s63, 1605632
  s_cselect_b32 s63, s56, s63
  s_waitcnt lgkmcnt(4)
  v_mfma_f32_32x32x16_bf16 v[80:95], v[140:143], v[132:135], v[80:95]
  ds_read_b128 v[136:139], v246 offset:24576
  ds_read_b128 v[140:143], v246 offset:25600
  s_waitcnt lgkmcnt(4)
  v_mfma_f32_32x32x16_bf16 v[96:111], v[112:115], v[120:123], v[96:111]
  ds_read_b64_tr_b16 v[112:113], v2 offset:24576
  ds_read_b64_tr_b16 v[114:115], v5 offset:24576
  buffer_load_dwordx4 v[168:171], v15, s[32:35], s62 offen sc1
  s_waitcnt lgkmcnt(4)
  v_mfma_f32_32x32x16_bf16 v[96:111], v[116:119], v[124:127], v[96:111]
  ds_read_b64_tr_b16 v[116:117], v2 offset:24832
  ds_read_b64_tr_b16 v[118:119], v5 offset:24832
  v_mfma_f32_32x32x16_bf16 v[48:63], v[212:215], v[144:147], v[48:63]
  buffer_load_dwordx4 v[172:175], v254, s[32:35], s62 offen sc1
  s_add_u32 s62, s62, 8192
  s_sub_u32 s55, s62, s61
  s_sub_u32 s73, s62, 81920
  s_cmp_eq_u32 s55, 114688
  s_cselect_b32 s62, s73, s62
  v_mfma_f32_32x32x16_bf16 v[64:79], v[212:215], v[148:151], v[64:79]
  s_waitcnt vmcnt(14)
  ds_read_b64_tr_b16 v[216:217], v242 offset:2048
  ds_read_b64_tr_b16 v[218:219], v242 offset:3072
  ds_read_b64_tr_b16 v[220:221], v243 offset:2048
  ds_read_b64_tr_b16 v[222:223], v243 offset:3072
  v_exp_f32 v80, v80
  v_exp_f32 v81, v81
  v_exp_f32 v82, v82
  v_exp_f32 v83, v83
  v_exp_f32 v84, v84
  v_exp_f32 v85, v85
  v_exp_f32 v86, v86
  v_exp_f32 v87, v87
  v_exp_f32 v88, v88
  v_exp_f32 v89, v89
  v_exp_f32 v90, v90
  v_exp_f32 v91, v91
  v_exp_f32 v92, v92
  v_exp_f32 v93, v93
  v_exp_f32 v94, v94
  v_exp_f32 v95, v95
  v_cvt_pk_bf16_f32 v120, v80, v81
  v_cvt_pk_bf16_f32 v121, v82, v83
  v_cvt_pk_bf16_f32 v122, v84, v85
  v_cvt_pk_bf16_f32 v123, v86, v87
  v_cvt_pk_bf16_f32 v124, v88, v89
  v_cvt_pk_bf16_f32 v125, v90, v91
  v_cvt_pk_bf16_f32 v126, v92, v93
  v_cvt_pk_bf16_f32 v127, v94, v95
  s_cbranch_vccz L_sk9
  s_waitcnt lgkmcnt(0)
  s_barrier
L_sk9:
  s_setprio 3
  s_waitcnt lgkmcnt(9)
  v_mfma_f32_32x32x16_bf16 v[80:95], v[136:139], v[128:131], 0
  s_add_u32 m0, s64, 0
  s_nop 0
  buffer_load_dwordx4 v6, s[28:31], s63 offen lds
  s_mul_i32 s54, s4, 6144
  s_add_u32 s57, s4, 31
  s_add_u32 s54, s54, s21
  s_waitcnt lgkmcnt(8)
  v_mfma_f32_32x32x16_bf16 v[80:95], v[140:143], v[132:135], v[80:95]
  ds_read_b128 v[136:139], v246 offset:28672
  ds_read_b128 v[140:143], v246 offset:29696
  s_and_b32 s57, s57, 31
  s_mul_i32 s57, s57, 6144
  s_add_u32 s57, s57, s21
  s_waitcnt lgkmcnt(8)
  v_mfma_f32_32x32x16_bf16 v[96:111], v[112:115], v[120:123], v[96:111]
  ds_read_b64_tr_b16 v[112:113], v2 offset:28672
  ds_read_b64_tr_b16 v[114:115], v5 offset:28672
  s_add_u32 m0, s64, 0
  s_nop 0
  buffer_load_dwordx4 v7, s[28:31], s63 offen offset:1024 lds
  s_add_u32 s63, s63, 114688
  s_waitcnt lgkmcnt(8)
  v_mfma_f32_32x32x16_bf16 v[96:111], v[116:119], v[124:127], v[96:111]
  ds_read_b64_tr_b16 v[116:117], v2 offset:28928
  ds_read_b64_tr_b16 v[118:119], v5 offset:28928
  s_sub_u32 s56, s63, 1146880
  s_cmp_ge_u32 s63, 1605632
  s_cselect_b32 s63, s56, s63
  s_waitcnt vmcnt(15) lgkmcnt(8)
  v_mfma_f32_32x32x16_bf16 v[16:31], v[216:219], v[152:155], v[16:31]
  buffer_load_dwordx4 v[144:147], v15, s[32:35], s62 offen sc1
  s_add_u32 s4, s4, 4
  s_and_b32 s4, s4, 31
  s_waitcnt vmcnt(15)
  v_mfma_f32_32x32x16_bf16 v[32:47], v[216:219], v[156:159], v[32:47]
  s_cbranch_vccnz L_sk10
  s_waitcnt lgkmcnt(0)
  s_barrier
L_sk10:
  v_exp_f32 v80, v80
  v_exp_f32 v81, v81
  v_exp_f32 v82, v82
  v_exp_f32 v83, v83
  v_exp_f32 v84, v84
  v_exp_f32 v85, v85
  v_exp_f32 v86, v86
  v_exp_f32 v87, v87
  v_exp_f32 v88, v88
  v_exp_f32 v89, v89
  v_exp_f32 v90, v90
  v_exp_f32 v91, v91
  v_exp_f32 v92, v92
  v_exp_f32 v93, v93
  v_exp_f32 v94, v94
  v_exp_f32 v95, v95
  v_cvt_pk_bf16_f32 v120, v80, v81
  v_cvt_pk_bf16_f32 v121, v82, v83
  v_cvt_pk_bf16_f32 v122, v84, v85
  v_cvt_pk_bf16_f32 v123, v86, v87
  v_cvt_pk_bf16_f32 v124, v88, v89
  v_cvt_pk_bf16_f32 v125, v90, v91
  v_cvt_pk_bf16_f32 v126, v92, v93
  v_cvt_pk_bf16_f32 v127, v94, v95
  s_setprio 2
  s_waitcnt lgkmcnt(5)
  v_mfma_f32_32x32x16_bf16 v[80:95], v[136:139], v[128:131], 0
  s_mov_b32 m0, s5
  s_nop 0
  buffer_load_dwordx4 v15, s[32:35], s54 offen offset:0 sc1 lds
  s_waitcnt lgkmcnt(4)
  v_mfma_f32_32x32x16_bf16 v[80:95], v[140:143], v[132:135], v[80:95]
  ds_read_b128 v[136:139], v246 offset:32768
  ds_read_b128 v[140:143], v246 offset:33792
  s_waitcnt lgkmcnt(4)
  v_mfma_f32_32x32x16_bf16 v[96:111], v[112:115], v[120:123], v[96:111]
  ds_read_b64_tr_b16 v[112:113], v2 offset:32768
  ds_read_b64_tr_b16 v[114:115], v5 offset:32768
  s_mov_b32 m0, s5
  s_nop 0
  buffer_load_dwordx4 v15, s[32:35], s54 offen offset:1024 sc1 lds
  s_waitcnt lgkmcnt(4)
  v_mfma_f32_32x32x16_bf16 v[96:111], v[116:119], v[124:127], v[96:111]
  ds_read_b64_tr_b16 v[116:117], v2 offset:33024
  ds_read_b64_tr_b16 v[118:119], v5 offset:33024
  v_mfma_f32_32x32x16_bf16 v[48:63], v[220:223], v[152:155], v[48:63]
  s_mov_b32 m0, s5
  s_nop 0
  buffer_load_dwordx4 v15, s[32:35], s57 offen offset:2048 sc1 lds
  v_mfma_f32_32x32x16_bf16 v[64:79], v[220:223], v[156:159], v[64:79]
  s_waitcnt vmcnt(16)
  ds_read_b64_tr_b16 v[224:225], v242 offset:4096
  ds_read_b64_tr_b16 v[226:227], v242 offset:5120
  ds_read_b64_tr_b16 v[228:229], v243 offset:4096
  ds_read_b64_tr_b16 v[230:231], v243 offset:5120
  v_exp_f32 v80, v80
  v_exp_f32 v81, v81
  v_exp_f32 v82, v82
  v_exp_f32 v83, v83
  v_exp_f32 v84, v84
  v_exp_f32 v85, v85
  v_exp_f32 v86, v86
  v_exp_f32 v87, v87
  v_exp_f32 v88, v88
  v_exp_f32 v89, v89
  v_exp_f32 v90, v90
  v_exp_f32 v91, v91
  v_exp_f32 v92, v92
  v_exp_f32 v93, v93
  v_exp_f32 v94, v94
  v_exp_f32 v95, v95
  v_cvt_pk_bf16_f32 v120, v80, v81
  v_cvt_pk_bf16_f32 v121, v82, v83
  v_cvt_pk_bf16_f32 v122, v84, v85
  v_cvt_pk_bf16_f32 v123, v86, v87
  v_cvt_pk_bf16_f32 v124, v88, v89
  v_cvt_pk_bf16_f32 v125, v90, v91
  v_cvt_pk_bf16_f32 v126, v92, v93
  v_cvt_pk_bf16_f32 v127, v94, v95
  s_setprio 1
  s_waitcnt lgkmcnt(9)
  v_mfma_f32_32x32x16_bf16 v[80:95], v[136:139], v[128:131], 0
  s_mov_b32 m0, s5
  s_nop 0
  buffer_load_dwordx4 v15, s[32:35], s57 offen offset:3072 sc1 lds
  s_add_u32 s5, s5, 16384
  s_sub_u32 s54, s5, 49152
  s_cmp_ge_i32 s54, s22
  s_cselect_b32 s5, s54, s5
  s_waitcnt lgkmcnt(8)
  v_mfma_f32_32x32x16_bf16 v[80:95], v[140:143], v[132:135], v[80:95]
  ds_read_b128 v[136:139], v246 offset:36864
  ds_read_b128 v[140:143], v246 offset:37888
  s_waitcnt lgkmcnt(8)
  v_mfma_f32_32x32x16_bf16 v[96:111], v[112:115], v[120:123], v[96:111]
  ds_read_b64_tr_b16 v[112:113], v2 offset:36864
  ds_read_b64_tr_b16 v[114:115], v5 offset:36864
  buffer_load_dwordx4 v[148:151], v254, s[32:35], s62 offen sc1
  s_add_u32 s62, s62, 8192
  s_sub_u32 s55, s62, s61
  s_waitcnt lgkmcnt(8)
  v_mfma_f32_32x32x16_bf16 v[96:111], v[116:119], v[124:127], v[96:111]
  ds_read_b64_tr_b16 v[116:117], v2 offset:37120
  ds_read_b64_tr_b16 v[118:119], v5 offset:37120
  s_sub_u32 s73, s62, 81920
  s_cmp_eq_u32 s55, 114688
  s_cselect_b32 s62, s73, s62
  s_waitcnt vmcnt(17) lgkmcnt(8)
  v_mfma_f32_32x32x16_bf16 v[16:31], v[224:227], v[160:163], v[16:31]
  s_add_u32 m0, s64, 2048
  s_nop 0
  buffer_load_dwordx4 v6, s[28:31], s63 offen lds
  s_waitcnt vmcnt(13)
  v_mfma_f32_32x32x16_bf16 v[32:47], v[224:227], v[164:167], v[32:47]
  v_exp_f32 v80, v80
  v_exp_f32 v81, v81
  v_exp_f32 v82, v82
  v_exp_f32 v83, v83
  v_exp_f32 v84, v84
  v_exp_f32 v85, v85
  v_exp_f32 v86, v86
  v_exp_f32 v87, v87
  v_exp_f32 v88, v88
  v_exp_f32 v89, v89
  v_exp_f32 v90, v90
  v_exp_f32 v91, v91
  v_exp_f32 v92, v92
  v_exp_f32 v93, v93
  v_exp_f32 v94, v94
  v_exp_f32 v95, v95
  v_cvt_pk_bf16_f32 v120, v80, v81
  v_cvt_pk_bf16_f32 v121, v82, v83
  v_cvt_pk_bf16_f32 v122, v84, v85
  v_cvt_pk_bf16_f32 v123, v86, v87
  v_cvt_pk_bf16_f32 v124, v88, v89
  v_cvt_pk_bf16_f32 v125, v90, v91
  v_cvt_pk_bf16_f32 v126, v92, v93
  v_cvt_pk_bf16_f32 v127, v94, v95
  s_setprio 0
  s_waitcnt lgkmcnt(5)
  v_mfma_f32_32x32x16_bf16 v[80:95], v[136:139], v[128:131], 0
  s_add_u32 m0, s64, 2048
  s_nop 0
  buffer_load_dwordx4 v7, s[28:31], s63 offen offset:1024 lds
  s_add_u32 s63, s63, 114688
  s_sub_u32 s56, s63, 1146880
  s_cmp_ge_u32 s63, 1605632
  s_cselect_b32 s63, s56, s63
  s_waitcnt lgkmcnt(4)
  v_mfma_f32_32x32x16_bf16 v[80:95], v[140:143], v[132:135], v[80:95]
  ds_read_b128 v[136:139], v246 offset:40960
  ds_read_b128 v[140:143], v246 offset:41984
  s_waitcnt lgkmcnt(4)
  v_mfma_f32_32x32x16_bf16 v[96:111], v[112:115], v[120:123], v[96:111]
  ds_read_b64_tr_b16 v[112:113], v2 offset:40960
  ds_read_b64_tr_b16 v[114:115], v5 offset:40960
  buffer_load_dwordx4 v[152:155], v15, s[32:35], s62 offen sc1
  s_waitcnt lgkmcnt(4)
  v_mfma_f32_32x32x16_bf16 v[96:111], v[116:119], v[124:127], v[96:111]
  ds_read_b64_tr_b16 v[116:117], v2 offset:41216
  ds_read_b64_tr_b16 v[118:119], v5 offset:41216
  v_mfma_f32_32x32x16_bf16 v[48:63], v[228:231], v[160:163], v[48:63]
  buffer_load_dwordx4 v[156:159], v254, s[32:35], s62 offen sc1
  s_add_u32 s62, s62, 8192
  s_sub_u32 s55, s62, s61
  s_sub_u32 s73, s62, 81920
  s_cmp_eq_u32 s55, 114688
  s_cselect_b32 s62, s73, s62
  v_mfma_f32_32x32x16_bf16 v[64:79], v[228:231], v[164:167], v[64:79]
  s_waitcnt vmcnt(14)
  ds_read_b64_tr_b16 v[200:201], v242 offset:6144
  ds_read_b64_tr_b16 v[202:203], v242 offset:7168
  ds_read_b64_tr_b16 v[204:205], v243 offset:6144
  ds_read_b64_tr_b16 v[206:207], v243 offset:7168
  v_exp_f32 v80, v80
  v_exp_f32 v81, v81
  v_exp_f32 v82, v82
  v_exp_f32 v83, v83
  v_exp_f32 v84, v84
  v_exp_f32 v85, v85
  v_exp_f32 v86, v86
  v_exp_f32 v87, v87
  v_exp_f32 v88, v88
  v_exp_f32 v89, v89
  v_exp_f32 v90, v90
  v_exp_f32 v91, v91
  v_exp_f32 v92, v92
  v_exp_f32 v93, v93
  v_exp_f32 v94, v94
  v_exp_f32 v95, v95
  v_cvt_pk_bf16_f32 v120, v80, v81
  v_cvt_pk_bf16_f32 v121, v82, v83
  v_cvt_pk_bf16_f32 v122, v84, v85
  v_cvt_pk_bf16_f32 v123, v86, v87
  v_cvt_pk_bf16_f32 v124, v88, v89
  v_cvt_pk_bf16_f32 v125, v90, v91
  v_cvt_pk_bf16_f32 v126, v92, v93
  v_cvt_pk_bf16_f32 v127, v94, v95
  s_cbranch_vccz L_sk11
  s_waitcnt lgkmcnt(0)
  s_barrier
L_sk11:
  s_setprio 3
  s_waitcnt lgkmcnt(9)
  v_mfma_f32_32x32x16_bf16 v[80:95], v[136:139], v[128:131], 0
  s_add_u32 m0, s64, 4096
  s_nop 0
  buffer_load_dwordx4 v6, s[28:31], s63 offen lds
  s_mul_i32 s54, s4, 6144
  s_add_u32 s57, s4, 31
  s_add_u32 s54, s54, s21
  s_waitcnt lgkmcnt(8)
  v_mfma_f32_32x32x16_bf16 v[80:95], v[140:143], v[132:135], v[80:95]
  ds_read_b128 v[136:139], v246 offset:45056
  ds_read_b128 v[140:143], v246 offset:46080
  s_and_b32 s57, s57, 31
  s_mul_i32 s57, s57, 6144
  s_add_u32 s57, s57, s21
  s_waitcnt lgkmcnt(8)
  v_mfma_f32_32x32x16_bf16 v[96:111], v[112:115], v[120:123], v[96:111]
  ds_read_b64_tr_b16 v[112:113], v2 offset:45056
  ds_read_b64_tr_b16 v[114:115], v5 offset:45056
  s_add_u32 m0, s64, 4096
  s_nop 0
  buffer_load_dwordx4 v7, s[28:31], s63 offen offset:1024 lds
  s_add_u32 s63, s63, 114688
  s_waitcnt lgkmcnt(8)
  v_mfma_f32_32x32x16_bf16 v[96:111], v[116:119], v[124:127], v[96:111]
  ds_read_b64_tr_b16 v[116:117], v2 offset:45312
  ds_read_b64_tr_b16 v[118:119], v5 offset:45312
  s_sub_u32 s56, s63, 1146880
  s_cmp_ge_u32 s63, 1605632
  s_cselect_b32 s63, s56, s63
  s_waitcnt vmcnt(15) lgkmcnt(8)
  v_mfma_f32_32x32x16_bf16 v[16:31], v[200:203], v[168:171], v[16:31]
  s_add_u32 m0, s64, 6144
  s_nop 0
  buffer_load_dwordx4 v6, s[28:31], s63 offen lds
  s_add_u32 s4, s4, 4
  s_and_b32 s4, s4, 31
  s_cmp_lg_u32 s23, 0
  s_cselect_b32 s54, 2130706432, s54
  s_waitcnt vmcnt(15)
  v_mfma_f32_32x32x16_bf16 v[32:47], v[200:203], v[172:175], v[32:47]
  s_cbranch_vccnz L_sk12
  s_waitcnt lgkmcnt(0)
  s_barrier
L_sk12:
  v_exp_f32 v80, v80
  v_exp_f32 v81, v81
  v_exp_f32 v82, v82
  v_exp_f32 v83, v83
  v_exp_f32 v84, v84
  v_exp_f32 v85, v85
  v_exp_f32 v86, v86
  v_exp_f32 v87, v87
  v_exp_f32 v88, v88
  v_exp_f32 v89, v89
  v_exp_f32 v90, v90
  v_exp_f32 v91, v91
  v_exp_f32 v92, v92
  v_exp_f32 v93, v93
  v_exp_f32 v94, v94
  v_exp_f32 v95, v95
  v_cvt_pk_bf16_f32 v120, v80, v81
  v_cvt_pk_bf16_f32 v121, v82, v83
  v_cvt_pk_bf16_f32 v122, v84, v85
  v_cvt_pk_bf16_f32 v123, v86, v87
  v_cvt_pk_bf16_f32 v124, v88, v89
  v_cvt_pk_bf16_f32 v125, v90, v91
  v_cvt_pk_bf16_f32 v126, v92, v93
  v_cvt_pk_bf16_f32 v127, v94, v95
  s_setprio 2
  s_waitcnt lgkmcnt(5)
  v_mfma_f32_32x32x16_bf16 v[80:95], v[136:139], v[128:131], 0
  s_add_u32 m0, s64, 6144
  s_nop 0
  buffer_load_dwordx4 v7, s[28:31], s63 offen offset:1024 lds
  s_cmp_ge_u32 s23, 2
  s_cselect_b32 s57, 2130706432, s57
  s_add_u32 s63, s63, 114688
  s_waitcnt lgkmcnt(4)
  v_mfma_f32_32x32x16_bf16 v[80:95], v[140:143], v[132:135], v[80:95]
  ds_read_b128 v[136:139], v246 offset:0
  ds_read_b128 v[140:143], v246 offset:1024
  s_sub_u32 s56, s63, 1146880
  s_cmp_ge_u32 s63, 1605632
  s_cselect_b32 s63, s56, s63
  s_waitcnt lgkmcnt(4)
  v_mfma_f32_32x32x16_bf16 v[96:111], v[112:115], v[120:123], v[96:111]
  ds_read_b64_tr_b16 v[112:113], v2 offset:0
  ds_read_b64_tr_b16 v[114:115], v5 offset:0
  s_bitcmp1_b32 s54, 30
  s_cselect_b32 m0, 0x30000, s5
  s_nop 0
  buffer_load_dwordx4 v15, s[32:35], s54 offen offset:0 sc1 lds
  s_waitcnt lgkmcnt(4)
  v_mfma_f32_32x32x16_bf16 v[96:111], v[116:119], v[124:127], v[96:111]
  ds_read_b64_tr_b16 v[116:117], v2 offset:256
  ds_read_b64_tr_b16 v[118:119], v5 offset:256
  v_mfma_f32_32x32x16_bf16 v[48:63], v[204:207], v[168:171], v[48:63]
  s_bitcmp1_b32 s54, 30
  s_cselect_b32 m0, 0x30000, s5
  s_nop 0
  buffer_load_dwordx4 v15, s[32:35], s54 offen offset:1024 sc1 lds
  v_mfma_f32_32x32x16_bf16 v[64:79], v[204:207], v[172:175], v[64:79]
  s_waitcnt vmcnt(16)
  ds_read_b64_tr_b16 v[192:193], v242 offset:0
  ds_read_b64_tr_b16 v[194:195], v242 offset:1024
  ds_read_b64_tr_b16 v[196:197], v243 offset:0
  ds_read_b64_tr_b16 v[198:199], v243 offset:1024
  v_exp_f32 v80, v80
  v_exp_f32 v81, v81
  v_exp_f32 v82, v82
  v_exp_f32 v83, v83
  v_exp_f32 v84, v84
  v_exp_f32 v85, v85
  v_exp_f32 v86, v86
  v_exp_f32 v87, v87
  v_exp_f32 v88, v88
  v_exp_f32 v89, v89
  v_exp_f32 v90, v90
  v_exp_f32 v91, v91
  v_exp_f32 v92, v92
  v_exp_f32 v93, v93
  v_exp_f32 v94, v94
  v_exp_f32 v95, v95
  v_cvt_pk_bf16_f32 v120, v80, v81
  v_cvt_pk_bf16_f32 v121, v82, v83
  v_cvt_pk_bf16_f32 v122, v84, v85
  v_cvt_pk_bf16_f32 v123, v86, v87
  v_cvt_pk_bf16_f32 v124, v88, v89
  v_cvt_pk_bf16_f32 v125, v90, v91
  v_cvt_pk_bf16_f32 v126, v92, v93
  v_cvt_pk_bf16_f32 v127, v94, v95
  s_setprio 1
  s_waitcnt lgkmcnt(9)
  v_mfma_f32_32x32x16_bf16 v[80:95], v[136:139], v[128:131], 0
  s_bitcmp1_b32 s57, 30
  s_cselect_b32 m0, 0x30000, s5
  s_nop 0
  buffer_load_dwordx4 v15, s[32:35], s57 offen offset:2048 sc1 lds
  s_waitcnt lgkmcnt(8)
  v_mfma_f32_32x32x16_bf16 v[80:95], v[140:143], v[132:135], v[80:95]
  ds_read_b128 v[136:139], v246 offset:4096
  ds_read_b128 v[140:143], v246 offset:5120
  s_waitcnt lgkmcnt(8)
  v_mfma_f32_32x32x16_bf16 v[96:111], v[112:115], v[120:123], v[96:111]
  ds_read_b64_tr_b16 v[112:113], v2 offset:4096
  ds_read_b64_tr_b16 v[114:115], v5 offset:4096
  s_bitcmp1_b32 s57, 30
  s_cselect_b32 m0, 0x30000, s5
  s_nop 0
  buffer_load_dwordx4 v15, s[32:35], s57 offen offset:3072 sc1 lds
  s_waitcnt lgkmcnt(8)
  v_mfma_f32_32x32x16_bf16 v[96:111], v[116:119], v[124:127], v[96:111]
  ds_read_b64_tr_b16 v[116:117], v2 offset:4352
  ds_read_b64_tr_b16 v[118:119], v5 offset:4352
  s_add_u32 s5, s5, 16384
  s_sub_u32 s54, s5, 49152
  s_cmp_ge_i32 s54, s22
  s_cselect_b32 s5, s54, s5
  s_waitcnt vmcnt(17) lgkmcnt(8)
  v_mfma_f32_32x32x16_bf16 v[16:31], v[192:195], v[144:147], v[16:31]
  s_add_u32 m0, s64, 0
  s_nop 0
  buffer_load_dwordx4 v6, s[28:31], s63 offen lds
  s_waitcnt vmcnt(13)
  v_mfma_f32_32x32x16_bf16 v[32:47], v[192:195], v[148:151], v[32:47]
  v_exp_f32 v80, v80
  v_exp_f32 v81, v81
  v_exp_f32 v82, v82
  v_exp_f32 v83, v83
  v_exp_f32 v84, v84
  v_exp_f32 v85, v85
  v_exp_f32 v86, v86
  v_exp_f32 v87, v87
  v_exp_f32 v88, v88
  v_exp_f32 v89, v89
  v_exp_f32 v90, v90
  v_exp_f32 v91, v91
  v_exp_f32 v92, v92
  v_exp_f32 v93, v93
  v_exp_f32 v94, v94
  v_exp_f32 v95, v95
  v_cvt_pk_bf16_f32 v120, v80, v81
  v_cvt_pk_bf16_f32 v121, v82, v83
  v_cvt_pk_bf16_f32 v122, v84, v85
  v_cvt_pk_bf16_f32 v123, v86, v87
  v_cvt_pk_bf16_f32 v124, v88, v89
  v_cvt_pk_bf16_f32 v125, v90, v91
  v_cvt_pk_bf16_f32 v126, v92, v93
  v_cvt_pk_bf16_f32 v127, v94, v95
  s_setprio 0
  s_waitcnt lgkmcnt(5)
  v_mfma_f32_32x32x16_bf16 v[80:95], v[136:139], v[128:131], 0
  s_add_u32 m0, s64, 0
  s_nop 0
  buffer_load_dwordx4 v7, s[28:31], s63 offen offset:1024 lds
  s_add_u32 s63, s63, 114688
  s_sub_u32 s56, s63, 1146880
  s_cmp_ge_u32 s63, 1605632
  s_cselect_b32 s63, s56, s63
  s_waitcnt lgkmcnt(4)
  v_mfma_f32_32x32x16_bf16 v[80:95], v[140:143], v[132:135], v[80:95]
  ds_read_b128 v[136:139], v246 offset:8192
  ds_read_b128 v[140:143], v246 offset:9216
  s_waitcnt lgkmcnt(4)
  v_mfma_f32_32x32x16_bf16 v[96:111], v[112:115], v[120:123], v[96:111]
  ds_read_b64_tr_b16 v[112:113], v2 offset:8192
  ds_read_b64_tr_b16 v[114:115], v5 offset:8192
  buffer_load_dwordx4 v[160:163], v15, s[32:35], s62 offen sc1
  s_waitcnt lgkmcnt(4)
  v_mfma_f32_32x32x16_bf16 v[96:111], v[116:119], v[124:127], v[96:111]
  ds_read_b64_tr_b16 v[116:117], v2 offset:8448
  ds_read_b64_tr_b16 v[118:119], v5 offset:8448
  v_mfma_f32_32x32x16_bf16 v[48:63], v[196:199], v[144:147], v[48:63]
  buffer_load_dwordx4 v[164:167], v254, s[32:35], s62 offen sc1
  s_add_u32 s62, s62, 8192
  s_sub_u32 s55, s62, s61
  s_sub_u32 s73, s62, 81920
  s_cmp_eq_u32 s55, 114688
  s_cselect_b32 s62, s73, s62
  v_mfma_f32_32x32x16_bf16 v[64:79], v[196:199], v[148:151], v[64:79]
  s_waitcnt vmcnt(14)
  ds_read_b64_tr_b16 v[184:185], v242 offset:2048
  ds_read_b64_tr_b16 v[186:187], v242 offset:3072
  ds_read_b64_tr_b16 v[188:189], v243 offset:2048
  ds_read_b64_tr_b16 v[190:191], v243 offset:3072
  v_exp_f32 v80, v80
  v_exp_f32 v81, v81
  v_exp_f32 v82, v82
  v_exp_f32 v83, v83
  v_exp_f32 v84, v84
  v_exp_f32 v85, v85
  v_exp_f32 v86, v86
  v_exp_f32 v87, v87
  v_exp_f32 v88, v88
  v_exp_f32 v89, v89
  v_exp_f32 v90, v90
  v_exp_f32 v91, v91
  v_exp_f32 v92, v92
  v_exp_f32 v93, v93
  v_exp_f32 v94, v94
  v_exp_f32 v95, v95
  v_cvt_pk_bf16_f32 v120, v80, v81
  v_cvt_pk_bf16_f32 v121, v82, v83
  v_cvt_pk_bf16_f32 v122, v84, v85
  v_cvt_pk_bf16_f32 v123, v86, v87
  v_cvt_pk_bf16_f32 v124, v88, v89
  v_cvt_pk_bf16_f32 v125, v90, v91
  v_cvt_pk_bf16_f32 v126, v92, v93
  v_cvt_pk_bf16_f32 v127, v94, v95
  s_cbranch_vccz L_sk13
  s_waitcnt lgkmcnt(0)
  s_barrier
L_sk13:
  s_setprio 3
  s_waitcnt lgkmcnt(9)
  v_mfma_f32_32x32x16_bf16 v[80:95], v[136:139], v[128:131], 0
  s_add_u32 m0, s64, 2048
  s_nop 0
  buffer_load_dwordx4 v6, s[28:31], s63 offen lds
  s_waitcnt lgkmcnt(8)
  v_mfma_f32_32x32x16_bf16 v[80:95], v[140:143], v[132:135], v[80:95]
  ds_read_b128 v[136:139], v246 offset:12288
  ds_read_b128 v[140:143], v246 offset:13312
  s_waitcnt lgkmcnt(8)
  v_mfma_f32_32x32x16_bf16 v[96:111], v[112:115], v[120:123], v[96:111]
  ds_read_b64_tr_b16 v[112:113], v2 offset:12288
  ds_read_b64_tr_b16 v[114:115], v5 offset:12288
  s_add_u32 m0, s64, 2048
  s_nop 0
  buffer_load_dwordx4 v7, s[28:31], s63 offen offset:1024 lds
  s_waitcnt lgkmcnt(8)
  v_mfma_f32_32x32x16_bf16 v[96:111], v[116:119], v[124:127], v[96:111]
  ds_read_b64_tr_b16 v[116:117], v2 offset:12544
  ds_read_b64_tr_b16 v[118:119], v5 offset:12544
  s_waitcnt vmcnt(15) lgkmcnt(8)
  v_mfma_f32_32x32x16_bf16 v[16:31], v[184:187], v[152:155], v[16:31]
  buffer_load_dwordx4 v[168:171], v15, s[32:35], s62 offen sc1
  s_waitcnt vmcnt(15)
  v_mfma_f32_32x32x16_bf16 v[32:47], v[184:187], v[156:159], v[32:47]
  s_cbranch_vccnz L_sk14
  s_waitcnt lgkmcnt(0)
  s_barrier
L_sk14:
  v_exp_f32 v80, v80
  v_exp_f32 v81, v81
  v_exp_f32 v82, v82
  v_exp_f32 v83, v83
  v_exp_f32 v84, v84
  v_exp_f32 v85, v85
  v_exp_f32 v86, v86
  v_exp_f32 v87, v87
  v_exp_f32 v88, v88
  v_exp_f32 v89, v89
  v_exp_f32 v90, v90
  v_exp_f32 v91, v91
  v_exp_f32 v92, v92
  v_exp_f32 v93, v93
  v_exp_f32 v94, v94
  v_exp_f32 v95, v95
  v_cvt_pk_bf16_f32 v120, v80, v81
  v_cvt_pk_bf16_f32 v121, v82, v83
  v_cvt_pk_bf16_f32 v122, v84, v85
  v_cvt_pk_bf16_f32 v123, v86, v87
  v_cvt_pk_bf16_f32 v124, v88, v89
  v_cvt_pk_bf16_f32 v125, v90, v91
  v_cvt_pk_bf16_f32 v126, v92, v93
  v_cvt_pk_bf16_f32 v127, v94, v95
  s_setprio 2
  s_waitcnt lgkmcnt(5)
  v_mfma_f32_32x32x16_bf16 v[80:95], v[136:139], v[128:131], 0
  s_mov_b32 m0, s72
  s_nop 0
  buffer_load_dwordx4 v6, s[44:47], s71 offen offset:0 lds
  s_waitcnt lgkmcnt(4)
  v_mfma_f32_32x32x16_bf16 v[80:95], v[140:143], v[132:135], v[80:95]
  ds_read_b128 v[136:139], v246 offset:16384
  ds_read_b128 v[140:143], v246 offset:17408
  s_waitcnt lgkmcnt(4)
  v_mfma_f32_32x32x16_bf16 v[96:111], v[112:115], v[120:123], v[96:111]
  ds_read_b64_tr_b16 v[112:113], v2 offset:16384
  ds_read_b64_tr_b16 v[114:115], v5 offset:16384
  s_mov_b32 m0, s72
  s_nop 0
  buffer_load_dwordx4 v7, s[44:47], s71 offen offset:1024 lds
  s_add_u32 s71, s71, s67
  s_waitcnt lgkmcnt(4)
  v_mfma_f32_32x32x16_bf16 v[96:111], v[116:119], v[124:127], v[96:111]
  ds_read_b64_tr_b16 v[116:117], v2 offset:16640
  ds_read_b64_tr_b16 v[118:119], v5 offset:16640
  s_add_u32 s72, s72, 2048
  v_mfma_f32_32x32x16_bf16 v[48:63], v[188:191], v[152:155], v[48:63]
  s_mov_b32 m0, s72
  s_nop 0
  buffer_load_dwordx4 v6, s[44:47], s71 offen offset:0 lds
  v_mfma_f32_32x32x16_bf16 v[64:79], v[188:191], v[156:159], v[64:79]
  s_waitcnt vmcnt(16)
  ds_read_b64_tr_b16 v[176:177], v242 offset:4096
  ds_read_b64_tr_b16 v[178:179], v242 offset:5120
  ds_read_b64_tr_b16 v[180:181], v243 offset:4096
  ds_read_b64_tr_b16 v[182:183], v243 offset:5120
  v_exp_f32 v80, v80
  v_exp_f32 v81, v81
  v_exp_f32 v82, v82
  v_exp_f32 v83, v83
  v_exp_f32 v84, v84
  v_exp_f32 v85, v85
  v_exp_f32 v86, v86
  v_exp_f32 v87, v87
  v_exp_f32 v88, v88
  v_exp_f32 v89, v89
  v_exp_f32 v90, v90
  v_exp_f32 v91, v91
  v_exp_f32 v92, v92
  v_exp_f32 v93, v93
  v_exp_f32 v94, v94
  v_exp_f32 v95, v95
  v_cvt_pk_bf16_f32 v120, v80, v81
  v_cvt_pk_bf16_f32 v121, v82, v83
  v_cvt_pk_bf16_f32 v122, v84, v85
  v_cvt_pk_bf16_f32 v123, v86, v87
  v_cvt_pk_bf16_f32 v124, v88, v89
  v_cvt_pk_bf16_f32 v125, v90, v91
  v_cvt_pk_bf16_f32 v126, v92, v93
  v_cvt_pk_bf16_f32 v127, v94, v95
  s_setprio 1
  s_waitcnt lgkmcnt(9)
  v_mfma_f32_32x32x16_bf16 v[80:95], v[136:139], v[128:131], 0
  s_mov_b32 m0, s72
  s_nop 0
  buffer_load_dwordx4 v7, s[44:47], s71 offen offset:1024 lds
  s_sub_u32 s71, s71, s67
  s_add_u32 s71, s71, 25088
  s_add_u32 s72, s72, 2048
  s_waitcnt lgkmcnt(8)
  v_mfma_f32_32x32x16_bf16 v[80:95], v[140:143], v[132:135], v[80:95]
  ds_read_b128 v[136:139], v246 offset:20480
  ds_read_b128 v[140:143], v246 offset:21504
  s_waitcnt lgkmcnt(8)
  v_mfma_f32_32x32x16_bf16 v[96:111], v[112:115], v[120:123], v[96:111]
  ds_read_b64_tr_b16 v[112:113], v2 offset:20480
  ds_read_b64_tr_b16 v[114:115], v5 offset:20480
  s_mov_b32 m0, s72
  s_nop 0
  buffer_load_dwordx4 v6, s[44:47], s71 offen offset:0 lds
  s_waitcnt lgkmcnt(8)
  v_mfma_f32_32x32x16_bf16 v[96:111], v[116:119], v[124:127], v[96:111]
  ds_read_b64_tr_b16 v[116:117], v2 offset:20736
  ds_read_b64_tr_b16 v[118:119], v5 offset:20736
  s_waitcnt vmcnt(9) lgkmcnt(8)
  v_mfma_f32_32x32x16_bf16 v[16:31], v[176:179], v[160:163], v[16:31]
  s_mov_b32 m0, s72
  s_nop 0
  buffer_load_dwordx4 v7, s[44:47], s71 offen offset:1024 lds
  s_waitcnt vmcnt(9)
  v_mfma_f32_32x32x16_bf16 v[32:47], v[176:179], v[164:167], v[32:47]
  v_exp_f32 v80, v80
  v_exp_f32 v81, v81
  v_exp_f32 v82, v82
  v_exp_f32 v83, v83
  v_exp_f32 v84, v84
  v_exp_f32 v85, v85
  v_exp_f32 v86, v86
  v_exp_f32 v87, v87
  v_exp_f32 v88, v88
  v_exp_f32 v89, v89
  v_exp_f32 v90, v90
  v_exp_f32 v91, v91
  v_exp_f32 v92, v92
  v_exp_f32 v93, v93
  v_exp_f32 v94, v94
  v_exp_f32 v95, v95
  v_cvt_pk_bf16_f32 v120, v80, v81
  v_cvt_pk_bf16_f32 v121, v82, v83
  v_cvt_pk_bf16_f32 v122, v84, v85
  v_cvt_pk_bf16_f32 v123, v86, v87
  v_cvt_pk_bf16_f32 v124, v88, v89
  v_cvt_pk_bf16_f32 v125, v90, v91
  v_cvt_pk_bf16_f32 v126, v92, v93
  v_cvt_pk_bf16_f32 v127, v94, v95
  s_setprio 0
  s_waitcnt lgkmcnt(5)
  v_mfma_f32_32x32x16_bf16 v[80:95], v[136:139], v[128:131], 0
  buffer_load_dwordx4 v[172:175], v254, s[32:35], s62 offen sc1
  s_add_u32 s62, s62, 8192
  s_sub_u32 s55, s62, s61
  s_sub_u32 s73, s62, 81920
  s_cmp_eq_u32 s55, 114688
  s_cselect_b32 s62, s73, s62
  s_waitcnt lgkmcnt(4)
  v_mfma_f32_32x32x16_bf16 v[80:95], v[140:143], v[132:135], v[80:95]
  ds_read_b128 v[136:139], v246 offset:24576
  ds_read_b128 v[140:143], v246 offset:25600
  s_waitcnt lgkmcnt(4)
  v_mfma_f32_32x32x16_bf16 v[96:111], v[112:115], v[120:123], v[96:111]
  ds_read_b64_tr_b16 v[112:113], v2 offset:24576
  ds_read_b64_tr_b16 v[114:115], v5 offset:24576
  buffer_load_dwordx4 v[144:147], v15, s[32:35], s62 offen sc1
  s_waitcnt lgkmcnt(4)
  v_mfma_f32_32x32x16_bf16 v[96:111], v[116:119], v[124:127], v[96:111]
  ds_read_b64_tr_b16 v[116:117], v2 offset:24832
  ds_read_b64_tr_b16 v[118:119], v5 offset:24832
  v_mfma_f32_32x32x16_bf16 v[48:63], v[180:183], v[160:163], v[48:63]
  buffer_load_dwordx4 v[148:151], v254, s[32:35], s62 offen sc1
  s_add_u32 s62, s62, 8192
  s_sub_u32 s55, s62, s61
  s_sub_u32 s73, s62, 81920
  s_cmp_eq_u32 s55, 114688
  s_cselect_b32 s62, s73, s62
  v_mfma_f32_32x32x16_bf16 v[64:79], v[180:183], v[164:167], v[64:79]
  ds_read_b64_tr_b16 v[208:209], v242 offset:6144
  ds_read_b64_tr_b16 v[210:211], v242 offset:7168
  ds_read_b64_tr_b16 v[212:213], v243 offset:6144
  ds_read_b64_tr_b16 v[214:215], v243 offset:7168
  v_exp_f32 v80, v80
  v_exp_f32 v81, v81
  v_exp_f32 v82, v82
  v_exp_f32 v83, v83
  v_exp_f32 v84, v84
  v_exp_f32 v85, v85
  v_exp_f32 v86, v86
  v_exp_f32 v87, v87
  v_exp_f32 v88, v88
  v_exp_f32 v89, v89
  v_exp_f32 v90, v90
  v_exp_f32 v91, v91
  v_exp_f32 v92, v92
  v_exp_f32 v93, v93
  v_exp_f32 v94, v94
  v_exp_f32 v95, v95
  v_cvt_pk_bf16_f32 v120, v80, v81
  v_cvt_pk_bf16_f32 v121, v82, v83
  v_cvt_pk_bf16_f32 v122, v84, v85
  v_cvt_pk_bf16_f32 v123, v86, v87
  v_cvt_pk_bf16_f32 v124, v88, v89
  v_cvt_pk_bf16_f32 v125, v90, v91
  v_cvt_pk_bf16_f32 v126, v92, v93
  v_cvt_pk_bf16_f32 v127, v94, v95
  s_cbranch_vccz L_sk15
  s_waitcnt lgkmcnt(0)
  s_barrier
L_sk15:
  s_setprio 3
  s_waitcnt lgkmcnt(9)
  v_mfma_f32_32x32x16_bf16 v[80:95], v[136:139], v[128:131], 0
  buffer_load_dwordx4 v[152:155], v15, s[32:35], s62 offen sc1
  s_waitcnt lgkmcnt(8)
  v_mfma_f32_32x32x16_bf16 v[80:95], v[140:143], v[132:135], v[80:95]
  ds_read_b128 v[136:139], v246 offset:28672
  ds_read_b128 v[140:143], v246 offset:29696
  buffer_load_dwordx4 v[156:159], v254, s[32:35], s62 offen sc1
  s_waitcnt lgkmcnt(8)
  v_mfma_f32_32x32x16_bf16 v[96:111], v[112:115], v[120:123], v[96:111]
  ds_read_b64_tr_b16 v[112:113], v2 offset:28672
  ds_read_b64_tr_b16 v[114:115], v5 offset:28672
  s_waitcnt lgkmcnt(8)
  v_mfma_f32_32x32x16_bf16 v[96:111], v[116:119], v[124:127], v[96:111]
  ds_read_b64_tr_b16 v[116:117], v2 offset:28928
  ds_read_b64_tr_b16 v[118:119], v5 offset:28928
  s_cbranch_vccnz L_sk16
  s_waitcnt lgkmcnt(0)
  s_barrier
L_sk16:
  v_exp_f32 v80, v80
  v_exp_f32 v81, v81
  v_exp_f32 v82, v82
  v_exp_f32 v83, v83
  v_exp_f32 v84, v84
  v_exp_f32 v85, v85
  v_exp_f32 v86, v86
  v_exp_f32 v87, v87
  v_exp_f32 v88, v88
  v_exp_f32 v89, v89
  v_exp_f32 v90, v90
  v_exp_f32 v91, v91
  v_exp_f32 v92, v92
  v_exp_f32 v93, v93
  v_exp_f32 v94, v94
  v_exp_f32 v95, v95
  v_cvt_pk_bf16_f32 v120, v80, v81
  v_cvt_pk_bf16_f32 v121, v82, v83
  v_cvt_pk_bf16_f32 v122, v84, v85
  v_cvt_pk_bf16_f32 v123, v86, v87
  v_cvt_pk_bf16_f32 v124, v88, v89
  v_cvt_pk_bf16_f32 v125, v90, v91
  v_cvt_pk_bf16_f32 v126, v92, v93
  v_cvt_pk_bf16_f32 v127, v94, v95
  s_setprio 2
  s_waitcnt lgkmcnt(5)
  v_mfma_f32_32x32x16_bf16 v[80:95], v[136:139], v[128:131], 0
  s_waitcnt lgkmcnt(4)
  v_mfma_f32_32x32x16_bf16 v[80:95], v[140:143], v[132:135], v[80:95]
  s_waitcnt lgkmcnt(2)
  v_mfma_f32_32x32x16_bf16 v[96:111], v[112:115], v[120:123], v[96:111]
  ds_read_b64_tr_b16 v[112:113], v2 offset:32768
  ds_read_b64_tr_b16 v[114:115], v5 offset:32768
  s_waitcnt lgkmcnt(2)
  v_mfma_f32_32x32x16_bf16 v[96:111], v[116:119], v[124:127], v[96:111]
  ds_read_b64_tr_b16 v[116:117], v2 offset:33024
  ds_read_b64_tr_b16 v[118:119], v5 offset:33024
  ds_read_b64_tr_b16 v[216:217], v242 offset:0
  ds_read_b64_tr_b16 v[218:219], v242 offset:1024
  ds_read_b64_tr_b16 v[220:221], v243 offset:0
  ds_read_b64_tr_b16 v[222:223], v243 offset:1024
  s_waitcnt vmcnt(12)
  ds_read_b64_tr_b16 v[224:225], v242 offset:2048
  ds_read_b64_tr_b16 v[226:227], v242 offset:3072
  ds_read_b64_tr_b16 v[228:229], v243 offset:2048
  ds_read_b64_tr_b16 v[230:231], v243 offset:3072
  v_exp_f32 v80, v80
  v_exp_f32 v81, v81
  v_exp_f32 v82, v82
  v_exp_f32 v83, v83
  v_exp_f32 v84, v84
  v_exp_f32 v85, v85
  v_exp_f32 v86, v86
  v_exp_f32 v87, v87
  v_exp_f32 v88, v88
  v_exp_f32 v89, v89
  v_exp_f32 v90, v90
  v_exp_f32 v91, v91
  v_exp_f32 v92, v92
  v_exp_f32 v93, v93
  v_exp_f32 v94, v94
  v_exp_f32 v95, v95
  v_cvt_pk_bf16_f32 v120, v80, v81
  v_cvt_pk_bf16_f32 v121, v82, v83
  v_cvt_pk_bf16_f32 v122, v84, v85
  v_cvt_pk_bf16_f32 v123, v86, v87
  v_cvt_pk_bf16_f32 v124, v88, v89
  v_cvt_pk_bf16_f32 v125, v90, v91
  v_cvt_pk_bf16_f32 v126, v92, v93
  v_cvt_pk_bf16_f32 v127, v94, v95
  s_waitcnt lgkmcnt(10)
  v_mfma_f32_32x32x16_bf16 v[96:111], v[112:115], v[120:123], v[96:111]
  s_waitcnt lgkmcnt(8)
  v_mfma_f32_32x32x16_bf16 v[96:111], v[116:119], v[124:127], v[96:111]
  s_branch L_attn_done
L_plain0:
L_plain:
  s_waitcnt vmcnt(11)
  s_waitcnt lgkmcnt(0)
  s_barrier
  ds_read_b128 v[136:139], v246 offset:0
  ds_read_b128 v[140:143], v246 offset:1024
  s_setprio 1
  s_waitcnt lgkmcnt(1)
  v_mfma_f32_32x32x16_bf16 v[80:95], v[136:139], v[128:131], 0
  s_waitcnt lgkmcnt(0)
  v_mfma_f32_32x32x16_bf16 v[80:95], v[140:143], v[132:135], v[80:95]
  ds_read_b128 v[136:139], v246 offset:4096
  ds_read_b128 v[140:143], v246 offset:5120
  ds_read_b64_tr_b16 v[112:113], v2 offset:4096
  ds_read_b64_tr_b16 v[114:115], v5 offset:4096
  ds_read_b64_tr_b16 v[116:117], v2 offset:4352
  ds_read_b64_tr_b16 v[118:119], v5 offset:4352
  s_nop 5
  v_exp_f32 v80, v80
  v_exp_f32 v81, v81
  v_exp_f32 v82, v82
  v_exp_f32 v83, v83
  v_exp_f32 v84, v84
  v_exp_f32 v85, v85
  v_exp_f32 v86, v86
  v_exp_f32 v87, v87
  v_exp_f32 v88, v88
  v_exp_f32 v89, v89
  v_exp_f32 v90, v90
  v_exp_f32 v91, v91
  v_exp_f32 v92, v92
  v_exp_f32 v93, v93
  v_exp_f32 v94, v94
  v_exp_f32 v95, v95
  v_cvt_pk_bf16_f32 v120, v80, v81
  v_cvt_pk_bf16_f32 v121, v82, v83
  v_cvt_pk_bf16_f32 v122, v84, v85
  v_cvt_pk_bf16_f32 v123, v86, v87
  v_cvt_pk_bf16_f32 v124, v88, v89
  v_cvt_pk_bf16_f32 v125, v90, v91
  v_cvt_pk_bf16_f32 v126, v92, v93
  v_cvt_pk_bf16_f32 v127, v94, v95
  s_setprio 0
  s_waitcnt lgkmcnt(5)
  v_mfma_f32_32x32x16_bf16 v[80:95], v[136:139], v[128:131], 0
  s_waitcnt lgkmcnt(4)
  v_mfma_f32_32x32x16_bf16 v[80:95], v[140:143], v[132:135], v[80:95]
  ds_read_b128 v[136:139], v246 offset:8192
  ds_read_b128 v[140:143], v246 offset:9216
  s_waitcnt lgkmcnt(4)
  v_mfma_f32_32x32x16_bf16 v[96:111], v[112:115], v[120:123], 0
  ds_read_b64_tr_b16 v[112:113], v2 offset:8192
  ds_read_b64_tr_b16 v[114:115], v5 offset:8192
  s_waitcnt lgkmcnt(4)
  v_mfma_f32_32x32x16_bf16 v[96:111], v[116:119], v[124:127], v[96:111]
  ds_read_b64_tr_b16 v[116:117], v2 offset:8448
  ds_read_b64_tr_b16 v[118:119], v5 offset:8448
  s_nop 1
  v_exp_f32 v80, v80
  v_exp_f32 v81, v81
  v_exp_f32 v82, v82
  v_exp_f32 v83, v83
  v_exp_f32 v84, v84
  v_exp_f32 v85, v85
  v_exp_f32 v86, v86
  v_exp_f32 v87, v87
  v_exp_f32 v88, v88
  v_exp_f32 v89, v89
  v_exp_f32 v90, v90
  v_exp_f32 v91, v91
  v_exp_f32 v92, v92
  v_exp_f32 v93, v93
  v_exp_f32 v94, v94
  v_exp_f32 v95, v95
  v_cvt_pk_bf16_f32 v120, v80, v81
  v_cvt_pk_bf16_f32 v121, v82, v83
  v_cvt_pk_bf16_f32 v122, v84, v85
  v_cvt_pk_bf16_f32 v123, v86, v87
  v_cvt_pk_bf16_f32 v124, v88, v89
  v_cvt_pk_bf16_f32 v125, v90, v91
  v_cvt_pk_bf16_f32 v126, v92, v93
  v_cvt_pk_bf16_f32 v127, v94, v95
  s_cbranch_vccz L_sk17
  s_waitcnt vmcnt(0)
  s_waitcnt lgkmcnt(0)
  s_barrier
L_sk17:
  s_setprio 3
  s_waitcnt lgkmcnt(5)
  v_mfma_f32_32x32x16_bf16 v[80:95], v[136:139], v[128:131], 0
  s_mul_i32 s54, s4, 6144
  s_add_u32 s57, s4, 31
  s_add_u32 s54, s54, s21
  s_and_b32 s57, s57, 31
  s_mul_i32 s57, s57, 6144
  s_waitcnt lgkmcnt(4)
  v_mfma_f32_32x32x16_bf16 v[80:95], v[140:143], v[132:135], v[80:95]
  ds_read_b128 v[136:139], v246 offset:12288
  ds_read_b128 v[140:143], v246 offset:13312
  s_add_u32 s57, s57, s21
  s_add_u32 s4, s4, 4
  s_and_b32 s4, s4, 31
  s_waitcnt lgkmcnt(4)
  v_mfma_f32_32x32x16_bf16 v[96:111], v[112:115], v[120:123], v[96:111]
  ds_read_b64_tr_b16 v[112:113], v2 offset:12288
  ds_read_b64_tr_b16 v[114:115], v5 offset:12288
  s_waitcnt lgkmcnt(4)
  v_mfma_f32_32x32x16_bf16 v[96:111], v[116:119], v[124:127], v[96:111]
  ds_read_b64_tr_b16 v[116:117], v2 offset:12544
  ds_read_b64_tr_b16 v[118:119], v5 offset:12544
  s_cbranch_vccnz L_sk18
  s_waitcnt vmcnt(0)
  s_waitcnt lgkmcnt(0)
  s_barrier
L_sk18:
  v_exp_f32 v80, v80
  v_exp_f32 v81, v81
  v_exp_f32 v82, v82
  v_exp_f32 v83, v83
  v_exp_f32 v84, v84
  v_exp_f32 v85, v85
  v_exp_f32 v86, v86
  v_exp_f32 v87, v87
  v_exp_f32 v88, v88
  v_exp_f32 v89, v89
  v_exp_f32 v90, v90
  v_exp_f32 v91, v91
  v_exp_f32 v92, v92
  v_exp_f32 v93, v93
  v_exp_f32 v94, v94
  v_exp_f32 v95, v95
  v_cvt_pk_bf16_f32 v120, v80, v81
  v_cvt_pk_bf16_f32 v121, v82, v83
  v_cvt_pk_bf16_f32 v122, v84, v85
  v_cvt_pk_bf16_f32 v123, v86, v87
  v_cvt_pk_bf16_f32 v124, v88, v89
  v_cvt_pk_bf16_f32 v125, v90, v91
  v_cvt_pk_bf16_f32 v126, v92, v93
  v_cvt_pk_bf16_f32 v127, v94, v95
  s_setprio 2
  s_waitcnt lgkmcnt(5)
  v_mfma_f32_32x32x16_bf16 v[80:95], v[136:139], v[128:131], 0
  s_mov_b64 exec, 1
  buffer_store_dwordx2 v[240:241], v247, s[32:35], s20 offen offset:0 sc1
  s_mov_b64 exec, -1
  s_waitcnt lgkmcnt(4)
  v_mfma_f32_32x32x16_bf16 v[80:95], v[140:143], v[132:135], v[80:95]
  ds_read_b128 v[136:139], v246 offset:16384
  ds_read_b128 v[140:143], v246 offset:17408
  s_mov_b64 exec, 1
  buffer_store_dwordx2 v[240:241], v247, s[32:35], s76 offen offset:0 sc1
  s_mov_b64 exec, -1
  s_waitcnt lgkmcnt(4)
  v_mfma_f32_32x32x16_bf16 v[96:111], v[112:115], v[120:123], v[96:111]
  ds_read_b64_tr_b16 v[112:113], v2 offset:16384
  ds_read_b64_tr_b16 v[114:115], v5 offset:16384
  s_mov_b32 m0, s5
  s_nop 0
  buffer_load_dwordx4 v15, s[32:35], s54 offen offset:0 sc1 lds
  s_waitcnt lgkmcnt(4)
  v_mfma_f32_32x32x16_bf16 v[96:111], v[116:119], v[124:127], v[96:111]
  ds_read_b64_tr_b16 v[116:117], v2 offset:16640
  ds_read_b64_tr_b16 v[118:119], v5 offset:16640
  v_exp_f32 v80, v80
  v_exp_f32 v81, v81
  v_exp_f32 v82, v82
  v_exp_f32 v83, v83
  v_exp_f32 v84, v84
  v_exp_f32 v85, v85
  v_exp_f32 v86, v86
  v_exp_f32 v87, v87
  v_exp_f32 v88, v88
  v_exp_f32 v89, v89
  v_exp_f32 v90, v90
  v_exp_f32 v91, v91
  v_exp_f32 v92, v92
  v_exp_f32 v93, v93
  v_exp_f32 v94, v94
  v_exp_f32 v95, v95
  v_cvt_pk_bf16_f32 v120, v80, v81
  v_cvt_pk_bf16_f32 v121, v82, v83
  v_cvt_pk_bf16_f32 v122, v84, v85
  v_cvt_pk_bf16_f32 v123, v86, v87
  v_cvt_pk_bf16_f32 v124, v88, v89
  v_cvt_pk_bf16_f32 v125, v90, v91
  v_cvt_pk_bf16_f32 v126, v92, v93
  v_cvt_pk_bf16_f32 v127, v94, v95
  s_setprio 1
  s_waitcnt lgkmcnt(5)
  v_mfma_f32_32x32x16_bf16 v[80:95], v[136:139], v[128:131], 0
  s_mov_b32 m0, s5
  s_nop 0
  buffer_load_dwordx4 v15, s[32:35], s54 offen offset:1024 sc1 lds
  s_waitcnt lgkmcnt(4)
  v_mfma_f32_32x32x16_bf16 v[80:95], v[140:143], v[132:135], v[80:95]
  ds_read_b128 v[136:139], v246 offset:20480
  ds_read_b128 v[140:143], v246 offset:21504
  s_mov_b32 m0, s5
  s_nop 0
  buffer_load_dwordx4 v15, s[32:35], s57 offen offset:2048 sc1 lds
  s_waitcnt lgkmcnt(4)
  v_mfma_f32_32x32x16_bf16 v[96:111], v[112:115], v[120:123], v[96:111]
  ds_read_b64_tr_b16 v[112:113], v2 offset:20480
  ds_read_b64_tr_b16 v[114:115], v5 offset:20480
  s_mov_b32 m0, s5
  s_nop 0
  buffer_load_dwordx4 v15, s[32:35], s57 offen offset:3072 sc1 lds
  s_add_u32 s5, s5, 16384
  s_waitcnt lgkmcnt(4)
  v_mfma_f32_32x32x16_bf16 v[96:111], v[116:119], v[124:127], v[96:111]
  ds_read_b64_tr_b16 v[116:117], v2 offset:20736
  ds_read_b64_tr_b16 v[118:119], v5 offset:20736
  s_sub_u32 s54, s5, 49152
  s_cmp_ge_i32 s54, s22
  s_cselect_b32 s5, s54, s5
  v_exp_f32 v80, v80
  v_exp_f32 v81, v81
  v_exp_f32 v82, v82
  v_exp_f32 v83, v83
  v_exp_f32 v84, v84
  v_exp_f32 v85, v85
  v_exp_f32 v86, v86
  v_exp_f32 v87, v87
  v_exp_f32 v88, v88
  v_exp_f32 v89, v89
  v_exp_f32 v90, v90
  v_exp_f32 v91, v91
  v_exp_f32 v92, v92
  v_exp_f32 v93, v93
  v_exp_f32 v94, v94
  v_exp_f32 v95, v95
  v_cvt_pk_bf16_f32 v120, v80, v81
  v_cvt_pk_bf16_f32 v121, v82, v83
  v_cvt_pk_bf16_f32 v122, v84, v85
  v_cvt_pk_bf16_f32 v123, v86, v87
  v_cvt_pk_bf16_f32 v124, v88, v89
  v_cvt_pk_bf16_f32 v125, v90, v91
  v_cvt_pk_bf16_f32 v126, v92, v93
  v_cvt_pk_bf16_f32 v127, v94, v95
  s_setprio 0
  s_waitcnt lgkmcnt(5)
  v_mfma_f32_32x32x16_bf16 v[80:95], v[136:139], v[128:131], 0
  s_waitcnt lgkmcnt(4)
  v_mfma_f32_32x32x16_bf16 v[80:95], v[140:143], v[132:135], v[80:95]
  ds_read_b128 v[136:139], v246 offset:24576
  ds_read_b128 v[140:143], v246 offset:25600
  s_waitcnt lgkmcnt(4)
  v_mfma_f32_32x32x16_bf16 v[96:111], v[112:115], v[120:123], v[96:111]
  ds_read_b64_tr_b16 v[112:113], v2 offset:24576
  ds_read_b64_tr_b16 v[114:115], v5 offset:24576
  s_waitcnt lgkmcnt(4)
  v_mfma_f32_32x32x16_bf16 v[96:111], v[116:119], v[124:127], v[96:111]
  ds_read_b64_tr_b16 v[116:117], v2 offset:24832
  ds_read_b64_tr_b16 v[118:119], v5 offset:24832
  s_nop 1
  v_exp_f32 v80, v80
  v_exp_f32 v81, v81
  v_exp_f32 v82, v82
  v_exp_f32 v83, v83
  v_exp_f32 v84, v84
  v_exp_f32 v85, v85
  v_exp_f32 v86, v86
  v_exp_f32 v87, v87
  v_exp_f32 v88, v88
  v_exp_f32 v89, v89
  v_exp_f32 v90, v90
  v_exp_f32 v91, v91
  v_exp_f32 v92, v92
  v_exp_f32 v93, v93
  v_exp_f32 v94, v94
  v_exp_f32 v95, v95
  v_cvt_pk_bf16_f32 v120, v80, v81
  v_cvt_pk_bf16_f32 v121, v82, v83
  v_cvt_pk_bf16_f32 v122, v84, v85
  v_cvt_pk_bf16_f32 v123, v86, v87
  v_cvt_pk_bf16_f32 v124, v88, v89
  v_cvt_pk_bf16_f32 v125, v90, v91
  v_cvt_pk_bf16_f32 v126, v92, v93
  v_cvt_pk_bf16_f32 v127, v94, v95
  s_cbranch_vccz L_sk19
  s_waitcnt lgkmcnt(0)
  s_barrier
L_sk19:
  s_setprio 3
  s_waitcnt lgkmcnt(5)
  v_mfma_f32_32x32x16_bf16 v[80:95], v[136:139], v[128:131], 0
  s_mul_i32 s54, s4, 6144
  s_add_u32 s57, s4, 31
  s_add_u32 s54, s54, s21
  s_and_b32 s57, s57, 31
  s_mul_i32 s57, s57, 6144
  s_waitcnt lgkmcnt(4)
  v_mfma_f32_32x32x16_bf16 v[80:95], v[140:143], v[132:135], v[80:95]
  ds_read_b128 v[136:139], v246 offset:28672
  ds_read_b128 v[140:143], v246 offset:29696
  s_add_u32 s57, s57, s21
  s_add_u32 s4, s4, 4
  s_and_b32 s4, s4, 31
  s_waitcnt lgkmcnt(4)
  v_mfma_f32_32x32x16_bf16 v[96:111], v[112:115], v[120:123], v[96:111]
  ds_read_b64_tr_b16 v[112:113], v2 offset:28672
  ds_read_b64_tr_b16 v[114:115], v5 offset:28672
  s_waitcnt lgkmcnt(4)
  v_mfma_f32_32x32x16_bf16 v[96:111], v[116:119], v[124:127], v[96:111]
  ds_read_b64_tr_b16 v[116:117], v2 offset:28928
  ds_read_b64_tr_b16 v[118:119], v5 offset:28928
  s_cbranch_vccnz L_sk20
  s_waitcnt lgkmcnt(0)
  s_barrier
L_sk20:
  v_exp_f32 v80, v80
  v_exp_f32 v81, v81
  v_exp_f32 v82, v82
  v_exp_f32 v83, v83
  v_exp_f32 v84, v84
  v_exp_f32 v85, v85
  v_exp_f32 v86, v86
  v_exp_f32 v87, v87
  v_exp_f32 v88, v88
  v_exp_f32 v89, v89
  v_exp_f32 v90, v90
  v_exp_f32 v91, v91
  v_exp_f32 v92, v92
  v_exp_f32 v93, v93
  v_exp_f32 v94, v94
  v_exp_f32 v95, v95
  v_cvt_pk_bf16_f32 v120, v80, v81
  v_cvt_pk_bf16_f32 v121, v82, v83
  v_cvt_pk_bf16_f32 v122, v84, v85
  v_cvt_pk_bf16_f32 v123, v86, v87
  v_cvt_pk_bf16_f32 v124, v88, v89
  v_cvt_pk_bf16_f32 v125, v90, v91
  v_cvt_pk_bf16_f32 v126, v92, v93
  v_cvt_pk_bf16_f32 v127, v94, v95
  s_setprio 2
  s_waitcnt lgkmcnt(5)
  v_mfma_f32_32x32x16_bf16 v[80:95], v[136:139], v[128:131], 0
  s_mov_b32 m0, s5
  s_nop 0
  buffer_load_dwordx4 v15, s[32:35], s54 offen offset:0 sc1 lds
  s_waitcnt lgkmcnt(4)
  v_mfma_f32_32x32x16_bf16 v[80:95], v[140:143], v[132:135], v[80:95]
  ds_read_b128 v[136:139], v246 offset:32768
  ds_read_b128 v[140:143], v246 offset:33792
  s_mov_b32 m0, s5
  s_nop 0
  buffer_load_dwordx4 v15, s[32:35], s54 offen offset:1024 sc1 lds
  s_waitcnt lgkmcnt(4)
  v_mfma_f32_32x32x16_bf16 v[96:111], v[112:115], v[120:123], v[96:111]
  ds_read_b64_tr_b16 v[112:113], v2 offset:32768
  ds_read_b64_tr_b16 v[114:115], v5 offset:32768
  s_mov_b32 m0, s5
  s_nop 0
  buffer_load_dwordx4 v15, s[32:35], s57 offen offset:2048 sc1 lds
  s_waitcnt lgkmcnt(4)
  v_mfma_f32_32x32x16_bf16 v[96:111], v[116:119], v[124:127], v[96:111]
  ds_read_b64_tr_b16 v[116:117], v2 offset:33024
  ds_read_b64_tr_b16 v[118:119], v5 offset:33024
  v_exp_f32 v80, v80
  v_exp_f32 v81, v81
  v_exp_f32 v82, v82
  v_exp_f32 v83, v83
  v_exp_f32 v84, v84
  v_exp_f32 v85, v85
  v_exp_f32 v86, v86
  v_exp_f32 v87, v87
  v_exp_f32 v88, v88
  v_exp_f32 v89, v89
  v_exp_f32 v90, v90
  v_exp_f32 v91, v91
  v_exp_f32 v92, v92
  v_exp_f32 v93, v93
  v_exp_f32 v94, v94
  v_exp_f32 v95, v95
  v_cvt_pk_bf16_f32 v120, v80, v81
  v_cvt_pk_bf16_f32 v121, v82, v83
  v_cvt_pk_bf16_f32 v122, v84, v85
  v_cvt_pk_bf16_f32 v123, v86, v87
  v_cvt_pk_bf16_f32 v124, v88, v89
  v_cvt_pk_bf16_f32 v125, v90, v91
  v_cvt_pk_bf16_f32 v126, v92, v93
  v_cvt_pk_bf16_f32 v127, v94, v95
  s_setprio 1
  s_waitcnt lgkmcnt(5)
  v_mfma_f32_32x32x16_bf16 v[80:95], v[136:139], v[128:131], 0
  s_mov_b32 m0, s5
  s_nop 0
  buffer_load_dwordx4 v15, s[32:35], s57 offen offset:3072 sc1 lds
  s_add_u32 s5, s5, 16384
  s_sub_u32 s54, s5, 49152
  s_cmp_ge_i32 s54, s22
  s_cselect_b32 s5, s54, s5
  s_waitcnt lgkmcnt(4)
  v_mfma_f32_32x32x16_bf16 v[80:95], v[140:143], v[132:135], v[80:95]
  ds_read_b128 v[136:139], v246 offset:36864
  ds_read_b128 v[140:143], v246 offset:37888
  s_waitcnt lgkmcnt(4)
  v_mfma_f32_32x32x16_bf16 v[96:111], v[112:115], v[120:123], v[96:111]
  ds_read_b64_tr_b16 v[112:113], v2 offset:36864
  ds_read_b64_tr_b16 v[114:115], v5 offset:36864
  s_waitcnt lgkmcnt(4)
  v_mfma_f32_32x32x16_bf16 v[96:111], v[116:119], v[124:127], v[96:111]
  ds_read_b64_tr_b16 v[116:117], v2 offset:37120
  ds_read_b64_tr_b16 v[118:119], v5 offset:37120
  s_nop 1
  v_exp_f32 v80, v80
  v_exp_f32 v81, v81
  v_exp_f32 v82, v82
  v_exp_f32 v83, v83
  v_exp_f32 v84, v84
  v_exp_f32 v85, v85
  v_exp_f32 v86, v86
  v_exp_f32 v87, v87
  v_exp_f32 v88, v88
  v_exp_f32 v89, v89
  v_exp_f32 v90, v90
  v_exp_f32 v91, v91
  v_exp_f32 v92, v92
  v_exp_f32 v93, v93
  v_exp_f32 v94, v94
  v_exp_f32 v95, v95
  v_cvt_pk_bf16_f32 v120, v80, v81
  v_cvt_pk_bf16_f32 v121, v82, v83
  v_cvt_pk_bf16_f32 v122, v84, v85
  v_cvt_pk_bf16_f32 v123, v86, v87
  v_cvt_pk_bf16_f32 v124, v88, v89
  v_cvt_pk_bf16_f32 v125, v90, v91
  v_cvt_pk_bf16_f32 v126, v92, v93
  v_cvt_pk_bf16_f32 v127, v94, v95
  s_setprio 0
  s_waitcnt lgkmcnt(5)
  v_mfma_f32_32x32x16_bf16 v[80:95], v[136:139], v[128:131], 0
  s_waitcnt lgkmcnt(4)
  v_mfma_f32_32x32x16_bf16 v[80:95], v[140:143], v[132:135], v[80:95]
  ds_read_b128 v[136:139], v246 offset:40960
  ds_read_b128 v[140:143], v246 offset:41984
  s_waitcnt lgkmcnt(4)
  v_mfma_f32_32x32x16_bf16 v[96:111], v[112:115], v[120:123], v[96:111]
  ds_read_b64_tr_b16 v[112:113], v2 offset:40960
  ds_read_b64_tr_b16 v[114:115], v5 offset:40960
  s_waitcnt lgkmcnt(4)
  v_mfma_f32_32x32x16_bf16 v[96:111], v[116:119], v[124:127], v[96:111]
  ds_read_b64_tr_b16 v[116:117], v2 offset:41216
  ds_read_b64_tr_b16 v[118:119], v5 offset:41216
  s_nop 1
  v_exp_f32 v80, v80
  v_exp_f32 v81, v81
  v_exp_f32 v82, v82
  v_exp_f32 v83, v83
  v_exp_f32 v84, v84
  v_exp_f32 v85, v85
  v_exp_f32 v86, v86
  v_exp_f32 v87, v87
  v_exp_f32 v88, v88
  v_exp_f32 v89, v89
  v_exp_f32 v90, v90
  v_exp_f32 v91, v91
  v_exp_f32 v92, v92
  v_exp_f32 v93, v93
  v_exp_f32 v94, v94
  v_exp_f32 v95, v95
  v_cvt_pk_bf16_f32 v120, v80, v81
  v_cvt_pk_bf16_f32 v121, v82, v83
  v_cvt_pk_bf16_f32 v122, v84, v85
  v_cvt_pk_bf16_f32 v123, v86, v87
  v_cvt_pk_bf16_f32 v124, v88, v89
  v_cvt_pk_bf16_f32 v125, v90, v91
  v_cvt_pk_bf16_f32 v126, v92, v93
  v_cvt_pk_bf16_f32 v127, v94, v95
  s_cbranch_vccz L_sk21
  s_waitcnt vmcnt(4)
  s_waitcnt lgkmcnt(0)
  s_barrier
L_sk21:
  s_setprio 3
  s_waitcnt lgkmcnt(5)
  v_mfma_f32_32x32x16_bf16 v[80:95], v[136:139], v[128:131], 0
  s_mul_i32 s54, s4, 6144
  s_add_u32 s57, s4, 31
  s_add_u32 s54, s54, s21
  s_and_b32 s57, s57, 31
  s_mul_i32 s57, s57, 6144
  s_waitcnt lgkmcnt(4)
  v_mfma_f32_32x32x16_bf16 v[80:95], v[140:143], v[132:135], v[80:95]
  ds_read_b128 v[136:139], v246 offset:45056
  ds_read_b128 v[140:143], v246 offset:46080
  s_add_u32 s57, s57, s21
  s_add_u32 s4, s4, 4
  s_and_b32 s4, s4, 31
  s_waitcnt lgkmcnt(4)
  v_mfma_f32_32x32x16_bf16 v[96:111], v[112:115], v[120:123], v[96:111]
  ds_read_b64_tr_b16 v[112:113], v2 offset:45056
  ds_read_b64_tr_b16 v[114:115], v5 offset:45056
  s_waitcnt lgkmcnt(4)
  v_mfma_f32_32x32x16_bf16 v[96:111], v[116:119], v[124:127], v[96:111]
  ds_read_b64_tr_b16 v[116:117], v2 offset:45312
  ds_read_b64_tr_b16 v[118:119], v5 offset:45312
  s_cbranch_vccnz L_sk22
  s_waitcnt vmcnt(4)
  s_waitcnt lgkmcnt(0)
  s_barrier
L_sk22:
  v_exp_f32 v80, v80
  v_exp_f32 v81, v81
  v_exp_f32 v82, v82
  v_exp_f32 v83, v83
  v_exp_f32 v84, v84
  v_exp_f32 v85, v85
  v_exp_f32 v86, v86
  v_exp_f32 v87, v87
  v_exp_f32 v88, v88
  v_exp_f32 v89, v89
  v_exp_f32 v90, v90
  v_exp_f32 v91, v91
  v_exp_f32 v92, v92
  v_exp_f32 v93, v93
  v_exp_f32 v94, v94
  v_exp_f32 v95, v95
  v_cvt_pk_bf16_f32 v120, v80, v81
  v_cvt_pk_bf16_f32 v121, v82, v83
  v_cvt_pk_bf16_f32 v122, v84, v85
  v_cvt_pk_bf16_f32 v123, v86, v87
  v_cvt_pk_bf16_f32 v124, v88, v89
  v_cvt_pk_bf16_f32 v125, v90, v91
  v_cvt_pk_bf16_f32 v126, v92, v93
  v_cvt_pk_bf16_f32 v127, v94, v95
  s_setprio 2
  s_waitcnt lgkmcnt(5)
  v_mfma_f32_32x32x16_bf16 v[80:95], v[136:139], v[128:131], 0
  s_mov_b32 m0, s5
  s_nop 0
  buffer_load_dwordx4 v15, s[32:35], s54 offen offset:0 sc1 lds
  s_waitcnt lgkmcnt(4)
  v_mfma_f32_32x32x16_bf16 v[80:95], v[140:143], v[132:135], v[80:95]
  ds_read_b128 v[136:139], v246 offset:0
  ds_read_b128 v[140:143], v246 offset:1024
  s_mov_b32 m0, s5
  s_nop 0
  buffer_load_dwordx4 v15, s[32:35], s54 offen offset:1024 sc1 lds
  s_waitcnt lgkmcnt(4)
  v_mfma_f32_32x32x16_bf16 v[96:111], v[112:115], v[120:123], v[96:111]
  ds_read_b64_tr_b16 v[112:113], v2 offset:0
  ds_read_b64_tr_b16 v[114:115], v5 offset:0
  s_mov_b32 m0, s5
  s_nop 0
  buffer_load_dwordx4 v15, s[32:35], s57 offen offset:2048 sc1 lds
  s_waitcnt lgkmcnt(4)
  v_mfma_f32_32x32x16_bf16 v[96:111], v[116:119], v[124:127], v[96:111]
  ds_read_b64_tr_b16 v[116:117], v2 offset:256
  ds_read_b64_tr_b16 v[118:119], v5 offset:256
  v_exp_f32 v80, v80
  v_exp_f32 v81, v81
  v_exp_f32 v82, v82
  v_exp_f32 v83, v83
  v_exp_f32 v84, v84
  v_exp_f32 v85, v85
  v_exp_f32 v86, v86
  v_exp_f32 v87, v87
  v_exp_f32 v88, v88
  v_exp_f32 v89, v89
  v_exp_f32 v90, v90
  v_exp_f32 v91, v91
  v_exp_f32 v92, v92
  v_exp_f32 v93, v93
  v_exp_f32 v94, v94
  v_exp_f32 v95, v95
  v_cvt_pk_bf16_f32 v120, v80, v81
  v_cvt_pk_bf16_f32 v121, v82, v83
  v_cvt_pk_bf16_f32 v122, v84, v85
  v_cvt_pk_bf16_f32 v123, v86, v87
  v_cvt_pk_bf16_f32 v124, v88, v89
  v_cvt_pk_bf16_f32 v125, v90, v91
  v_cvt_pk_bf16_f32 v126, v92, v93
  v_cvt_pk_bf16_f32 v127, v94, v95
  s_setprio 1
  s_waitcnt lgkmcnt(5)
  v_mfma_f32_32x32x16_bf16 v[80:95], v[136:139], v[128:131], 0
  s_mov_b32 m0, s5
  s_nop 0
  buffer_load_dwordx4 v15, s[32:35], s57 offen offset:3072 sc1 lds
  s_add_u32 s5, s5, 16384
  s_sub_u32 s54, s5, 49152
  s_cmp_ge_i32 s54, s22
  s_cselect_b32 s5, s54, s5
  s_waitcnt lgkmcnt(4)
  v_mfma_f32_32x32x16_bf16 v[80:95], v[140:143], v[132:135], v[80:95]
  ds_read_b128 v[136:139], v246 offset:4096
  ds_read_b128 v[140:143], v246 offset:5120
  s_waitcnt lgkmcnt(4)
  v_mfma_f32_32x32x16_bf16 v[96:111], v[112:115], v[120:123], v[96:111]
  ds_read_b64_tr_b16 v[112:113], v2 offset:4096
  ds_read_b64_tr_b16 v[114:115], v5 offset:4096
  s_waitcnt lgkmcnt(4)
  v_mfma_f32_32x32x16_bf16 v[96:111], v[116:119], v[124:127], v[96:111]
  ds_read_b64_tr_b16 v[116:117], v2 offset:4352
  ds_read_b64_tr_b16 v[118:119], v5 offset:4352
  s_nop 1
  v_exp_f32 v80, v80
  v_exp_f32 v81, v81
  v_exp_f32 v82, v82
  v_exp_f32 v83, v83
  v_exp_f32 v84, v84
  v_exp_f32 v85, v85
  v_exp_f32 v86, v86
  v_exp_f32 v87, v87
  v_exp_f32 v88, v88
  v_exp_f32 v89, v89
  v_exp_f32 v90, v90
  v_exp_f32 v91, v91
  v_exp_f32 v92, v92
  v_exp_f32 v93, v93
  v_exp_f32 v94, v94
  v_exp_f32 v95, v95
  v_cvt_pk_bf16_f32 v120, v80, v81
  v_cvt_pk_bf16_f32 v121, v82, v83
  v_cvt_pk_bf16_f32 v122, v84, v85
  v_cvt_pk_bf16_f32 v123, v86, v87
  v_cvt_pk_bf16_f32 v124, v88, v89
  v_cvt_pk_bf16_f32 v125, v90, v91
  v_cvt_pk_bf16_f32 v126, v92, v93
  v_cvt_pk_bf16_f32 v127, v94, v95
  s_setprio 0
  s_waitcnt lgkmcnt(5)
  v_mfma_f32_32x32x16_bf16 v[80:95], v[136:139], v[128:131], 0
  s_waitcnt lgkmcnt(4)
  v_mfma_f32_32x32x16_bf16 v[80:95], v[140:143], v[132:135], v[80:95]
  ds_read_b128 v[136:139], v246 offset:8192
  ds_read_b128 v[140:143], v246 offset:9216
  s_waitcnt lgkmcnt(4)
  v_mfma_f32_32x32x16_bf16 v[96:111], v[112:115], v[120:123], v[96:111]
  ds_read_b64_tr_b16 v[112:113], v2 offset:8192
  ds_read_b64_tr_b16 v[114:115], v5 offset:8192
  s_waitcnt lgkmcnt(4)
  v_mfma_f32_32x32x16_bf16 v[96:111], v[116:119], v[124:127], v[96:111]
  ds_read_b64_tr_b16 v[116:117], v2 offset:8448
  ds_read_b64_tr_b16 v[118:119], v5 offset:8448
  s_nop 1
  v_exp_f32 v80, v80
  v_exp_f32 v81, v81
  v_exp_f32 v82, v82
  v_exp_f32 v83, v83
  v_exp_f32 v84, v84
  v_exp_f32 v85, v85
  v_exp_f32 v86, v86
  v_exp_f32 v87, v87
  v_exp_f32 v88, v88
  v_exp_f32 v89, v89
  v_exp_f32 v90, v90
  v_exp_f32 v91, v91
  v_exp_f32 v92, v92
  v_exp_f32 v93, v93
  v_exp_f32 v94, v94
  v_exp_f32 v95, v95
  v_cvt_pk_bf16_f32 v120, v80, v81
  v_cvt_pk_bf16_f32 v121, v82, v83
  v_cvt_pk_bf16_f32 v122, v84, v85
  v_cvt_pk_bf16_f32 v123, v86, v87
  v_cvt_pk_bf16_f32 v124, v88, v89
  v_cvt_pk_bf16_f32 v125, v90, v91
  v_cvt_pk_bf16_f32 v126, v92, v93
  v_cvt_pk_bf16_f32 v127, v94, v95
  s_cbranch_vccz L_sk23
  s_waitcnt vmcnt(4)
  s_waitcnt lgkmcnt(0)
  s_barrier
L_sk23:
  s_setprio 3
  s_waitcnt lgkmcnt(5)
  v_mfma_f32_32x32x16_bf16 v[80:95], v[136:139], v[128:131], 0
  s_mul_i32 s54, s4, 6144
  s_add_u32 s57, s4, 31
  s_add_u32 s54, s54, s21
  s_and_b32 s57, s57, 31
  s_mul_i32 s57, s57, 6144
  s_waitcnt lgkmcnt(4)
  v_mfma_f32_32x32x16_bf16 v[80:95], v[140:143], v[132:135], v[80:95]
  ds_read_b128 v[136:139], v246 offset:12288
  ds_read_b128 v[140:143], v246 offset:13312
  s_add_u32 s57, s57, s21
  s_add_u32 s4, s4, 4
  s_and_b32 s4, s4, 31
  s_waitcnt lgkmcnt(4)
  v_mfma_f32_32x32x16_bf16 v[96:111], v[112:115], v[120:123], v[96:111]
  ds_read_b64_tr_b16 v[112:113], v2 offset:12288
  ds_read_b64_tr_b16 v[114:115], v5 offset:12288
  s_waitcnt lgkmcnt(4)
  v_mfma_f32_32x32x16_bf16 v[96:111], v[116:119], v[124:127], v[96:111]
  ds_read_b64_tr_b16 v[116:117], v2 offset:12544
  ds_read_b64_tr_b16 v[118:119], v5 offset:12544
  s_cbranch_vccnz L_sk24
  s_waitcnt vmcnt(4)
  s_waitcnt lgkmcnt(0)
  s_barrier
L_sk24:
  v_exp_f32 v80, v80
  v_exp_f32 v81, v81
  v_exp_f32 v82, v82
  v_exp_f32 v83, v83
  v_exp_f32 v84, v84
  v_exp_f32 v85, v85
  v_exp_f32 v86, v86
  v_exp_f32 v87, v87
  v_exp_f32 v88, v88
  v_exp_f32 v89, v89
  v_exp_f32 v90, v90
  v_exp_f32 v91, v91
  v_exp_f32 v92, v92
  v_exp_f32 v93, v93
  v_exp_f32 v94, v94
  v_exp_f32 v95, v95
  v_cvt_pk_bf16_f32 v120, v80, v81
  v_cvt_pk_bf16_f32 v121, v82, v83
  v_cvt_pk_bf16_f32 v122, v84, v85
  v_cvt_pk_bf16_f32 v123, v86, v87
  v_cvt_pk_bf16_f32 v124, v88, v89
  v_cvt_pk_bf16_f32 v125, v90, v91
  v_cvt_pk_bf16_f32 v126, v92, v93
  v_cvt_pk_bf16_f32 v127, v94, v95
  s_setprio 2
  s_waitcnt lgkmcnt(5)
  v_mfma_f32_32x32x16_bf16 v[80:95], v[136:139], v[128:131], 0
  s_mov_b32 m0, s5
  s_nop 0
  buffer_load_dwordx4 v15, s[32:35], s54 offen offset:0 sc1 lds
  s_waitcnt lgkmcnt(4)
  v_mfma_f32_32x32x16_bf16 v[80:95], v[140:143], v[132:135], v[80:95]
  ds_read_b128 v[136:139], v246 offset:16384
  ds_read_b128 v[140:143], v246 offset:17408
  s_mov_b32 m0, s5
  s_nop 0
  buffer_load_dwordx4 v15, s[32:35], s54 offen offset:1024 sc1 lds
  s_waitcnt lgkmcnt(4)
  v_mfma_f32_32x32x16_bf16 v[96:111], v[112:115], v[120:123], v[96:111]
  ds_read_b64_tr_b16 v[112:113], v2 offset:16384
  ds_read_b64_tr_b16 v[114:115], v5 offset:16384
  s_mov_b32 m0, s5
  s_nop 0
  buffer_load_dwordx4 v15, s[32:35], s57 offen offset:2048 sc1 lds
  s_waitcnt lgkmcnt(4)
  v_mfma_f32_32x32x16_bf16 v[96:111], v[116:119], v[124:127], v[96:111]
  ds_read_b64_tr_b16 v[116:117], v2 offset:16640
  ds_read_b64_tr_b16 v[118:119], v5 offset:16640
  v_exp_f32 v80, v80
  v_exp_f32 v81, v81
  v_exp_f32 v82, v82
  v_exp_f32 v83, v83
  v_exp_f32 v84, v84
  v_exp_f32 v85, v85
  v_exp_f32 v86, v86
  v_exp_f32 v87, v87
  v_exp_f32 v88, v88
  v_exp_f32 v89, v89
  v_exp_f32 v90, v90
  v_exp_f32 v91, v91
  v_exp_f32 v92, v92
  v_exp_f32 v93, v93
  v_exp_f32 v94, v94
  v_exp_f32 v95, v95
  v_cvt_pk_bf16_f32 v120, v80, v81
  v_cvt_pk_bf16_f32 v121, v82, v83
  v_cvt_pk_bf16_f32 v122, v84, v85
  v_cvt_pk_bf16_f32 v123, v86, v87
  v_cvt_pk_bf16_f32 v124, v88, v89
  v_cvt_pk_bf16_f32 v125, v90, v91
  v_cvt_pk_bf16_f32 v126, v92, v93
  v_cvt_pk_bf16_f32 v127, v94, v95
  s_setprio 1
  s_waitcnt lgkmcnt(5)
  v_mfma_f32_32x32x16_bf16 v[80:95], v[136:139], v[128:131], 0
  s_mov_b32 m0, s5
  s_nop 0
  buffer_load_dwordx4 v15, s[32:35], s57 offen offset:3072 sc1 lds
  s_add_u32 s5, s5, 16384
  s_sub_u32 s54, s5, 49152
  s_cmp_ge_i32 s54, s22
  s_cselect_b32 s5, s54, s5
  s_waitcnt lgkmcnt(4)
  v_mfma_f32_32x32x16_bf16 v[80:95], v[140:143], v[132:135], v[80:95]
  ds_read_b128 v[136:139], v246 offset:20480
  ds_read_b128 v[140:143], v246 offset:21504
  s_waitcnt lgkmcnt(4)
  v_mfma_f32_32x32x16_bf16 v[96:111], v[112:115], v[120:123], v[96:111]
  ds_read_b64_tr_b16 v[112:113], v2 offset:20480
  ds_read_b64_tr_b16 v[114:115], v5 offset:20480
  s_waitcnt lgkmcnt(4)
  v_mfma_f32_32x32x16_bf16 v[96:111], v[116:119], v[124:127], v[96:111]
  ds_read_b64_tr_b16 v[116:117], v2 offset:20736
  ds_read_b64_tr_b16 v[118:119], v5 offset:20736
  s_nop 1
  v_exp_f32 v80, v80
  v_exp_f32 v81, v81
  v_exp_f32 v82, v82
  v_exp_f32 v83, v83
  v_exp_f32 v84, v84
  v_exp_f32 v85, v85
  v_exp_f32 v86, v86
  v_exp_f32 v87, v87
  v_exp_f32 v88, v88
  v_exp_f32 v89, v89
  v_exp_f32 v90, v90
  v_exp_f32 v91, v91
  v_exp_f32 v92, v92
  v_exp_f32 v93, v93
  v_exp_f32 v94, v94
  v_exp_f32 v95, v95
  v_cvt_pk_bf16_f32 v120, v80, v81
  v_cvt_pk_bf16_f32 v121, v82, v83
  v_cvt_pk_bf16_f32 v122, v84, v85
  v_cvt_pk_bf16_f32 v123, v86, v87
  v_cvt_pk_bf16_f32 v124, v88, v89
  v_cvt_pk_bf16_f32 v125, v90, v91
  v_cvt_pk_bf16_f32 v126, v92, v93
  v_cvt_pk_bf16_f32 v127, v94, v95
  s_setprio 0
  s_waitcnt lgkmcnt(5)
  v_mfma_f32_32x32x16_bf16 v[80:95], v[136:139], v[128:131], 0
  s_waitcnt lgkmcnt(4)
  v_mfma_f32_32x32x16_bf16 v[80:95], v[140:143], v[132:135], v[80:95]
  ds_read_b128 v[136:139], v246 offset:24576
  ds_read_b128 v[140:143], v246 offset:25600
  s_waitcnt lgkmcnt(4)
  v_mfma_f32_32x32x16_bf16 v[96:111], v[112:115], v[120:123], v[96:111]
  ds_read_b64_tr_b16 v[112:113], v2 offset:24576
  ds_read_b64_tr_b16 v[114:115], v5 offset:24576
  s_waitcnt lgkmcnt(4)
  v_mfma_f32_32x32x16_bf16 v[96:111], v[116:119], v[124:127], v[96:111]
  ds_read_b64_tr_b16 v[116:117], v2 offset:24832
  ds_read_b64_tr_b16 v[118:119], v5 offset:24832
  s_nop 1
  v_exp_f32 v80, v80
  v_exp_f32 v81, v81
  v_exp_f32 v82, v82
  v_exp_f32 v83, v83
  v_exp_f32 v84, v84
  v_exp_f32 v85, v85
  v_exp_f32 v86, v86
  v_exp_f32 v87, v87
  v_exp_f32 v88, v88
  v_exp_f32 v89, v89
  v_exp_f32 v90, v90
  v_exp_f32 v91, v91
  v_exp_f32 v92, v92
  v_exp_f32 v93, v93
  v_exp_f32 v94, v94
  v_exp_f32 v95, v95
  v_cvt_pk_bf16_f32 v120, v80, v81
  v_cvt_pk_bf16_f32 v121, v82, v83
  v_cvt_pk_bf16_f32 v122, v84, v85
  v_cvt_pk_bf16_f32 v123, v86, v87
  v_cvt_pk_bf16_f32 v124, v88, v89
  v_cvt_pk_bf16_f32 v125, v90, v91
  v_cvt_pk_bf16_f32 v126, v92, v93
  v_cvt_pk_bf16_f32 v127, v94, v95
  s_cbranch_vccz L_sk25
  s_waitcnt vmcnt(4)
  s_waitcnt lgkmcnt(0)
  s_barrier
L_sk25:
  s_setprio 3
  s_waitcnt lgkmcnt(5)
  v_mfma_f32_32x32x16_bf16 v[80:95], v[136:139], v[128:131], 0
  s_mul_i32 s54, s4, 6144
  s_add_u32 s57, s4, 31
  s_add_u32 s54, s54, s21
  s_and_b32 s57, s57, 31
  s_mul_i32 s57, s57, 6144
  s_waitcnt lgkmcnt(4)
  v_mfma_f32_32x32x16_bf16 v[80:95], v[140:143], v[132:135], v[80:95]
  ds_read_b128 v[136:139], v246 offset:28672
  ds_read_b128 v[140:143], v246 offset:29696
  s_add_u32 s57, s57, s21
  s_add_u32 s4, s4, 4
  s_and_b32 s4, s4, 31
  s_waitcnt lgkmcnt(4)
  v_mfma_f32_32x32x16_bf16 v[96:111], v[112:115], v[120:123], v[96:111]
  ds_read_b64_tr_b16 v[112:113], v2 offset:28672
  ds_read_b64_tr_b16 v[114:115], v5 offset:28672
  s_waitcnt lgkmcnt(4)
  v_mfma_f32_32x32x16_bf16 v[96:111], v[116:119], v[124:127], v[96:111]
  ds_read_b64_tr_b16 v[116:117], v2 offset:28928
  ds_read_b64_tr_b16 v[118:119], v5 offset:28928
  s_cbranch_vccnz L_sk26
  s_waitcnt vmcnt(4)
  s_waitcnt lgkmcnt(0)
  s_barrier
L_sk26:
  v_exp_f32 v80, v80
  v_exp_f32 v81, v81
  v_exp_f32 v82, v82
  v_exp_f32 v83, v83
  v_exp_f32 v84, v84
  v_exp_f32 v85, v85
  v_exp_f32 v86, v86
  v_exp_f32 v87, v87
  v_exp_f32 v88, v88
  v_exp_f32 v89, v89
  v_exp_f32 v90, v90
  v_exp_f32 v91, v91
  v_exp_f32 v92, v92
  v_exp_f32 v93, v93
  v_exp_f32 v94, v94
  v_exp_f32 v95, v95
  v_cvt_pk_bf16_f32 v120, v80, v81
  v_cvt_pk_bf16_f32 v121, v82, v83
  v_cvt_pk_bf16_f32 v122, v84, v85
  v_cvt_pk_bf16_f32 v123, v86, v87
  v_cvt_pk_bf16_f32 v124, v88, v89
  v_cvt_pk_bf16_f32 v125, v90, v91
  v_cvt_pk_bf16_f32 v126, v92, v93
  v_cvt_pk_bf16_f32 v127, v94, v95
  s_setprio 2
  s_waitcnt lgkmcnt(5)
  v_mfma_f32_32x32x16_bf16 v[80:95], v[136:139], v[128:131], 0
  s_mov_b32 m0, s5
  s_nop 0
  buffer_load_dwordx4 v15, s[32:35], s54 offen offset:0 sc1 lds
  s_waitcnt lgkmcnt(4)
  v_mfma_f32_32x32x16_bf16 v[80:95], v[140:143], v[132:135], v[80:95]
  ds_read_b128 v[136:139], v246 offset:32768
  ds_read_b128 v[140:143], v246 offset:33792
  s_mov_b32 m0, s5
  s_nop 0
  buffer_load_dwordx4 v15, s[32:35], s54 offen offset:1024 sc1 lds
  s_waitcnt lgkmcnt(4)
  v_mfma_f32_32x32x16_bf16 v[96:111], v[112:115], v[120:123], v[96:111]
  ds_read_b64_tr_b16 v[112:113], v2 offset:32768
  ds_read_b64_tr_b16 v[114:115], v5 offset:32768
  s_mov_b32 m0, s5
  s_nop 0
  buffer_load_dwordx4 v15, s[32:35], s57 offen offset:2048 sc1 lds
  s_waitcnt lgkmcnt(4)
  v_mfma_f32_32x32x16_bf16 v[96:111], v[116:119], v[124:127], v[96:111]
  ds_read_b64_tr_b16 v[116:117], v2 offset:33024
  ds_read_b64_tr_b16 v[118:119], v5 offset:33024
  v_exp_f32 v80, v80
  v_exp_f32 v81, v81
  v_exp_f32 v82, v82
  v_exp_f32 v83, v83
  v_exp_f32 v84, v84
  v_exp_f32 v85, v85
  v_exp_f32 v86, v86
  v_exp_f32 v87, v87
  v_exp_f32 v88, v88
  v_exp_f32 v89, v89
  v_exp_f32 v90, v90
  v_exp_f32 v91, v91
  v_exp_f32 v92, v92
  v_exp_f32 v93, v93
  v_exp_f32 v94, v94
  v_exp_f32 v95, v95
  v_cvt_pk_bf16_f32 v120, v80, v81
  v_cvt_pk_bf16_f32 v121, v82, v83
  v_cvt_pk_bf16_f32 v122, v84, v85
  v_cvt_pk_bf16_f32 v123, v86, v87
  v_cvt_pk_bf16_f32 v124, v88, v89
  v_cvt_pk_bf16_f32 v125, v90, v91
  v_cvt_pk_bf16_f32 v126, v92, v93
  v_cvt_pk_bf16_f32 v127, v94, v95
  s_setprio 1
  s_waitcnt lgkmcnt(5)
  v_mfma_f32_32x32x16_bf16 v[80:95], v[136:139], v[128:131], 0
  s_mov_b32 m0, s5
  s_nop 0
  buffer_load_dwordx4 v15, s[32:35], s57 offen offset:3072 sc1 lds
  s_add_u32 s5, s5, 16384
  s_sub_u32 s54, s5, 49152
  s_cmp_ge_i32 s54, s22
  s_cselect_b32 s5, s54, s5
  s_waitcnt lgkmcnt(4)
  v_mfma_f32_32x32x16_bf16 v[80:95], v[140:143], v[132:135], v[80:95]
  ds_read_b128 v[136:139], v246 offset:36864
  ds_read_b128 v[140:143], v246 offset:37888
  s_waitcnt lgkmcnt(4)
  v_mfma_f32_32x32x16_bf16 v[96:111], v[112:115], v[120:123], v[96:111]
  ds_read_b64_tr_b16 v[112:113], v2 offset:36864
  ds_read_b64_tr_b16 v[114:115], v5 offset:36864
  s_waitcnt lgkmcnt(4)
  v_mfma_f32_32x32x16_bf16 v[96:111], v[116:119], v[124:127], v[96:111]
  ds_read_b64_tr_b16 v[116:117], v2 offset:37120
  ds_read_b64_tr_b16 v[118:119], v5 offset:37120
  s_nop 1
  v_exp_f32 v80, v80
  v_exp_f32 v81, v81
  v_exp_f32 v82, v82
  v_exp_f32 v83, v83
  v_exp_f32 v84, v84
  v_exp_f32 v85, v85
  v_exp_f32 v86, v86
  v_exp_f32 v87, v87
  v_exp_f32 v88, v88
  v_exp_f32 v89, v89
  v_exp_f32 v90, v90
  v_exp_f32 v91, v91
  v_exp_f32 v92, v92
  v_exp_f32 v93, v93
  v_exp_f32 v94, v94
  v_exp_f32 v95, v95
  v_cvt_pk_bf16_f32 v120, v80, v81
  v_cvt_pk_bf16_f32 v121, v82, v83
  v_cvt_pk_bf16_f32 v122, v84, v85
  v_cvt_pk_bf16_f32 v123, v86, v87
  v_cvt_pk_bf16_f32 v124, v88, v89
  v_cvt_pk_bf16_f32 v125, v90, v91
  v_cvt_pk_bf16_f32 v126, v92, v93
  v_cvt_pk_bf16_f32 v127, v94, v95
  s_setprio 0
  s_waitcnt lgkmcnt(5)
  v_mfma_f32_32x32x16_bf16 v[80:95], v[136:139], v[128:131], 0
  s_waitcnt lgkmcnt(4)
  v_mfma_f32_32x32x16_bf16 v[80:95], v[140:143], v[132:135], v[80:95]
  ds_read_b128 v[136:139], v246 offset:40960
  ds_read_b128 v[140:143], v246 offset:41984
  s_waitcnt lgkmcnt(4)
  v_mfma_f32_32x32x16_bf16 v[96:111], v[112:115], v[120:123], v[96:111]
  ds_read_b64_tr_b16 v[112:113], v2 offset:40960
  ds_read_b64_tr_b16 v[114:115], v5 offset:40960
  s_waitcnt lgkmcnt(4)
  v_mfma_f32_32x32x16_bf16 v[96:111], v[116:119], v[124:127], v[96:111]
  ds_read_b64_tr_b16 v[116:117], v2 offset:41216
  ds_read_b64_tr_b16 v[118:119], v5 offset:41216
  s_nop 1
  v_exp_f32 v80, v80
  v_exp_f32 v81, v81
  v_exp_f32 v82, v82
  v_exp_f32 v83, v83
  v_exp_f32 v84, v84
  v_exp_f32 v85, v85
  v_exp_f32 v86, v86
  v_exp_f32 v87, v87
  v_exp_f32 v88, v88
  v_exp_f32 v89, v89
  v_exp_f32 v90, v90
  v_exp_f32 v91, v91
  v_exp_f32 v92, v92
  v_exp_f32 v93, v93
  v_exp_f32 v94, v94
  v_exp_f32 v95, v95
  v_cvt_pk_bf16_f32 v120, v80, v81
  v_cvt_pk_bf16_f32 v121, v82, v83
  v_cvt_pk_bf16_f32 v122, v84, v85
  v_cvt_pk_bf16_f32 v123, v86, v87
  v_cvt_pk_bf16_f32 v124, v88, v89
  v_cvt_pk_bf16_f32 v125, v90, v91
  v_cvt_pk_bf16_f32 v126, v92, v93
  v_cvt_pk_bf16_f32 v127, v94, v95
  s_cbranch_vccz L_sk27
  s_waitcnt vmcnt(4)
  s_waitcnt lgkmcnt(0)
  s_barrier
L_sk27:
  s_setprio 3
  s_waitcnt lgkmcnt(5)
  v_mfma_f32_32x32x16_bf16 v[80:95], v[136:139], v[128:131], 0
  s_mul_i32 s54, s4, 6144
  s_add_u32 s57, s4, 31
  s_add_u32 s54, s54, s21
  s_and_b32 s57, s57, 31
  s_mul_i32 s57, s57, 6144
  s_waitcnt lgkmcnt(4)
  v_mfma_f32_32x32x16_bf16 v[80:95], v[140:143], v[132:135], v[80:95]
  ds_read_b128 v[136:139], v246 offset:45056
  ds_read_b128 v[140:143], v246 offset:46080
  s_add_u32 s57, s57, s21
  s_add_u32 s4, s4, 4
  s_and_b32 s4, s4, 31
  s_waitcnt lgkmcnt(4)
  v_mfma_f32_32x32x16_bf16 v[96:111], v[112:115], v[120:123], v[96:111]
  ds_read_b64_tr_b16 v[112:113], v2 offset:45056
  ds_read_b64_tr_b16 v[114:115], v5 offset:45056
  s_cmp_lg_u32 s23, 0
  s_cselect_b32 s54, 2130706432, s54
  s_cmp_ge_u32 s23, 2
  s_cselect_b32 s57, 2130706432, s57
  s_waitcnt lgkmcnt(4)
  v_mfma_f32_32x32x16_bf16 v[96:111], v[116:119], v[124:127], v[96:111]
  ds_read_b64_tr_b16 v[116:117], v2 offset:45312
  ds_read_b64_tr_b16 v[118:119], v5 offset:45312
  s_cbranch_vccnz L_sk28
  s_waitcnt vmcnt(4)
  s_waitcnt lgkmcnt(0)
  s_barrier
L_sk28:
  v_exp_f32 v80, v80
  v_exp_f32 v81, v81
  v_exp_f32 v82, v82
  v_exp_f32 v83, v83
  v_exp_f32 v84, v84
  v_exp_f32 v85, v85
  v_exp_f32 v86, v86
  v_exp_f32 v87, v87
  v_exp_f32 v88, v88
  v_exp_f32 v89, v89
  v_exp_f32 v90, v90
  v_exp_f32 v91, v91
  v_exp_f32 v92, v92
  v_exp_f32 v93, v93
  v_exp_f32 v94, v94
  v_exp_f32 v95, v95
  v_cvt_pk_bf16_f32 v120, v80, v81
  v_cvt_pk_bf16_f32 v121, v82, v83
  v_cvt_pk_bf16_f32 v122, v84, v85
  v_cvt_pk_bf16_f32 v123, v86, v87
  v_cvt_pk_bf16_f32 v124, v88, v89
  v_cvt_pk_bf16_f32 v125, v90, v91
  v_cvt_pk_bf16_f32 v126, v92, v93
  v_cvt_pk_bf16_f32 v127, v94, v95
  s_setprio 2
  s_waitcnt lgkmcnt(5)
  v_mfma_f32_32x32x16_bf16 v[80:95], v[136:139], v[128:131], 0
  s_bitcmp1_b32 s54, 30
  s_cselect_b32 m0, 0x30000, s5
  s_nop 0
  buffer_load_dwordx4 v15, s[32:35], s54 offen offset:0 sc1 lds
  s_waitcnt lgkmcnt(4)
  v_mfma_f32_32x32x16_bf16 v[80:95], v[140:143], v[132:135], v[80:95]
  ds_read_b128 v[136:139], v246 offset:0
  ds_read_b128 v[140:143], v246 offset:1024
  s_bitcmp1_b32 s54, 30
  s_cselect_b32 m0, 0x30000, s5
  s_nop 0
  buffer_load_dwordx4 v15, s[32:35], s54 offen offset:1024 sc1 lds
  s_waitcnt lgkmcnt(4)
  v_mfma_f32_32x32x16_bf16 v[96:111], v[112:115], v[120:123], v[96:111]
  ds_read_b64_tr_b16 v[112:113], v2 offset:0
  ds_read_b64_tr_b16 v[114:115], v5 offset:0
  s_bitcmp1_b32 s57, 30
  s_cselect_b32 m0, 0x30000, s5
  s_nop 0
  buffer_load_dwordx4 v15, s[32:35], s57 offen offset:2048 sc1 lds
  s_waitcnt lgkmcnt(4)
  v_mfma_f32_32x32x16_bf16 v[96:111], v[116:119], v[124:127], v[96:111]
  ds_read_b64_tr_b16 v[116:117], v2 offset:256
  ds_read_b64_tr_b16 v[118:119], v5 offset:256
  v_exp_f32 v80, v80
  v_exp_f32 v81, v81
  v_exp_f32 v82, v82
  v_exp_f32 v83, v83
  v_exp_f32 v84, v84
  v_exp_f32 v85, v85
  v_exp_f32 v86, v86
  v_exp_f32 v87, v87
  v_exp_f32 v88, v88
  v_exp_f32 v89, v89
  v_exp_f32 v90, v90
  v_exp_f32 v91, v91
  v_exp_f32 v92, v92
  v_exp_f32 v93, v93
  v_exp_f32 v94, v94
  v_exp_f32 v95, v95
  v_cvt_pk_bf16_f32 v120, v80, v81
  v_cvt_pk_bf16_f32 v121, v82, v83
  v_cvt_pk_bf16_f32 v122, v84, v85
  v_cvt_pk_bf16_f32 v123, v86, v87
  v_cvt_pk_bf16_f32 v124, v88, v89
  v_cvt_pk_bf16_f32 v125, v90, v91
  v_cvt_pk_bf16_f32 v126, v92, v93
  v_cvt_pk_bf16_f32 v127, v94, v95
  s_setprio 1
  s_waitcnt lgkmcnt(5)
  v_mfma_f32_32x32x16_bf16 v[80:95], v[136:139], v[128:131], 0
  s_bitcmp1_b32 s57, 30
  s_cselect_b32 m0, 0x30000, s5
  s_nop 0
  buffer_load_dwordx4 v15, s[32:35], s57 offen offset:3072 sc1 lds
  s_add_u32 s5, s5, 16384
  s_sub_u32 s54, s5, 49152
  s_waitcnt lgkmcnt(4)
  v_mfma_f32_32x32x16_bf16 v[80:95], v[140:143], v[132:135], v[80:95]
  ds_read_b128 v[136:139], v246 offset:4096
  ds_read_b128 v[140:143], v246 offset:5120
  s_cmp_ge_i32 s54, s22
  s_cselect_b32 s5, s54, s5
  s_waitcnt lgkmcnt(4)
  v_mfma_f32_32x32x16_bf16 v[96:111], v[112:115], v[120:123], v[96:111]
  ds_read_b64_tr_b16 v[112:113], v2 offset:4096
  ds_read_b64_tr_b16 v[114:115], v5 offset:4096
  s_waitcnt lgkmcnt(4)
  v_mfma_f32_32x32x16_bf16 v[96:111], v[116:119], v[124:127], v[96:111]
  ds_read_b64_tr_b16 v[116:117], v2 offset:4352
  ds_read_b64_tr_b16 v[118:119], v5 offset:4352
  v_exp_f32 v80, v80
  v_exp_f32 v81, v81
  v_exp_f32 v82, v82
  v_exp_f32 v83, v83
  v_exp_f32 v84, v84
  v_exp_f32 v85, v85
  v_exp_f32 v86, v86
  v_exp_f32 v87, v87
  v_exp_f32 v88, v88
  v_exp_f32 v89, v89
  v_exp_f32 v90, v90
  v_exp_f32 v91, v91
  v_exp_f32 v92, v92
  v_exp_f32 v93, v93
  v_exp_f32 v94, v94
  v_exp_f32 v95, v95
  v_cvt_pk_bf16_f32 v120, v80, v81
  v_cvt_pk_bf16_f32 v121, v82, v83
  v_cvt_pk_bf16_f32 v122, v84, v85
  v_cvt_pk_bf16_f32 v123, v86, v87
  v_cvt_pk_bf16_f32 v124, v88, v89
  v_cvt_pk_bf16_f32 v125, v90, v91
  v_cvt_pk_bf16_f32 v126, v92, v93
  v_cvt_pk_bf16_f32 v127, v94, v95
  s_setprio 0
  s_waitcnt lgkmcnt(5)
  v_mfma_f32_32x32x16_bf16 v[80:95], v[136:139], v[128:131], 0
  s_waitcnt lgkmcnt(4)
  v_mfma_f32_32x32x16_bf16 v[80:95], v[140:143], v[132:135], v[80:95]
  ds_read_b128 v[136:139], v246 offset:8192
  ds_read_b128 v[140:143], v246 offset:9216
  s_waitcnt lgkmcnt(4)
  v_mfma_f32_32x32x16_bf16 v[96:111], v[112:115], v[120:123], v[96:111]
  ds_read_b64_tr_b16 v[112:113], v2 offset:8192
  ds_read_b64_tr_b16 v[114:115], v5 offset:8192
  s_waitcnt lgkmcnt(4)
  v_mfma_f32_32x32x16_bf16 v[96:111], v[116:119], v[124:127], v[96:111]
  ds_read_b64_tr_b16 v[116:117], v2 offset:8448
  ds_read_b64_tr_b16 v[118:119], v5 offset:8448
  s_nop 1
  v_exp_f32 v80, v80
  v_exp_f32 v81, v81
  v_exp_f32 v82, v82
  v_exp_f32 v83, v83
  v_exp_f32 v84, v84
  v_exp_f32 v85, v85
  v_exp_f32 v86, v86
  v_exp_f32 v87, v87
  v_exp_f32 v88, v88
  v_exp_f32 v89, v89
  v_exp_f32 v90, v90
  v_exp_f32 v91, v91
  v_exp_f32 v92, v92
  v_exp_f32 v93, v93
  v_exp_f32 v94, v94
  v_exp_f32 v95, v95
  v_cvt_pk_bf16_f32 v120, v80, v81
  v_cvt_pk_bf16_f32 v121, v82, v83
  v_cvt_pk_bf16_f32 v122, v84, v85
  v_cvt_pk_bf16_f32 v123, v86, v87
  v_cvt_pk_bf16_f32 v124, v88, v89
  v_cvt_pk_bf16_f32 v125, v90, v91
  v_cvt_pk_bf16_f32 v126, v92, v93
  v_cvt_pk_bf16_f32 v127, v94, v95
  s_cbranch_vccz L_sk29
  s_waitcnt vmcnt(4)
  s_waitcnt lgkmcnt(0)
  s_barrier
L_sk29:
  s_setprio 3
  s_waitcnt lgkmcnt(5)
  v_mfma_f32_32x32x16_bf16 v[80:95], v[136:139], v[128:131], 0
  s_waitcnt lgkmcnt(4)
  v_mfma_f32_32x32x16_bf16 v[80:95], v[140:143], v[132:135], v[80:95]
  ds_read_b128 v[136:139], v246 offset:12288
  ds_read_b128 v[140:143], v246 offset:13312
  s_waitcnt lgkmcnt(4)
  v_mfma_f32_32x32x16_bf16 v[96:111], v[112:115], v[120:123], v[96:111]
  ds_read_b64_tr_b16 v[112:113], v2 offset:12288
  ds_read_b64_tr_b16 v[114:115], v5 offset:12288
  s_waitcnt lgkmcnt(4)
  v_mfma_f32_32x32x16_bf16 v[96:111], v[116:119], v[124:127], v[96:111]
  ds_read_b64_tr_b16 v[116:117], v2 offset:12544
  ds_read_b64_tr_b16 v[118:119], v5 offset:12544
  s_cbranch_vccnz L_sk30
  s_waitcnt vmcnt(4)
  s_waitcnt lgkmcnt(0)
  s_barrier
L_sk30:
  s_nop 0
  v_exp_f32 v80, v80
  v_exp_f32 v81, v81
  v_exp_f32 v82, v82
  v_exp_f32 v83, v83
  v_exp_f32 v84, v84
  v_exp_f32 v85, v85
  v_exp_f32 v86, v86
  v_exp_f32 v87, v87
  v_exp_f32 v88, v88
  v_exp_f32 v89, v89
  v_exp_f32 v90, v90
  v_exp_f32 v91, v91
  v_exp_f32 v92, v92
  v_exp_f32 v93, v93
  v_exp_f32 v94, v94
  v_exp_f32 v95, v95
  v_cvt_pk_bf16_f32 v120, v80, v81
  v_cvt_pk_bf16_f32 v121, v82, v83
  v_cvt_pk_bf16_f32 v122, v84, v85
  v_cvt_pk_bf16_f32 v123, v86, v87
  v_cvt_pk_bf16_f32 v124, v88, v89
  v_cvt_pk_bf16_f32 v125, v90, v91
  v_cvt_pk_bf16_f32 v126, v92, v93
  v_cvt_pk_bf16_f32 v127, v94, v95
  s_setprio 2
  s_waitcnt lgkmcnt(5)
  v_mfma_f32_32x32x16_bf16 v[80:95], v[136:139], v[128:131], 0
  s_waitcnt lgkmcnt(4)
  v_mfma_f32_32x32x16_bf16 v[80:95], v[140:143], v[132:135], v[80:95]
  ds_read_b128 v[136:139], v246 offset:16384
  ds_read_b128 v[140:143], v246 offset:17408
  s_waitcnt lgkmcnt(4)
  v_mfma_f32_32x32x16_bf16 v[96:111], v[112:115], v[120:123], v[96:111]
  ds_read_b64_tr_b16 v[112:113], v2 offset:16384
  ds_read_b64_tr_b16 v[114:115], v5 offset:16384
  s_waitcnt lgkmcnt(4)
  v_mfma_f32_32x32x16_bf16 v[96:111], v[116:119], v[124:127], v[96:111]
  ds_read_b64_tr_b16 v[116:117], v2 offset:16640
  ds_read_b64_tr_b16 v[118:119], v5 offset:16640
  s_nop 1
  v_exp_f32 v80, v80
  v_exp_f32 v81, v81
  v_exp_f32 v82, v82
  v_exp_f32 v83, v83
  v_exp_f32 v84, v84
  v_exp_f32 v85, v85
  v_exp_f32 v86, v86
  v_exp_f32 v87, v87
  v_exp_f32 v88, v88
  v_exp_f32 v89, v89
  v_exp_f32 v90, v90
  v_exp_f32 v91, v91
  v_exp_f32 v92, v92
  v_exp_f32 v93, v93
  v_exp_f32 v94, v94
  v_exp_f32 v95, v95
  v_cvt_pk_bf16_f32 v120, v80, v81
  v_cvt_pk_bf16_f32 v121, v82, v83
  v_cvt_pk_bf16_f32 v122, v84, v85
  v_cvt_pk_bf16_f32 v123, v86, v87
  v_cvt_pk_bf16_f32 v124, v88, v89
  v_cvt_pk_bf16_f32 v125, v90, v91
  v_cvt_pk_bf16_f32 v126, v92, v93
  v_cvt_pk_bf16_f32 v127, v94, v95
  s_setprio 1
  s_waitcnt lgkmcnt(5)
  v_mfma_f32_32x32x16_bf16 v[80:95], v[136:139], v[128:131], 0
  s_waitcnt lgkmcnt(4)
  v_mfma_f32_32x32x16_bf16 v[80:95], v[140:143], v[132:135], v[80:95]
  ds_read_b128 v[136:139], v246 offset:20480
  ds_read_b128 v[140:143], v246 offset:21504
  s_waitcnt lgkmcnt(4)
  v_mfma_f32_32x32x16_bf16 v[96:111], v[112:115], v[120:123], v[96:111]
  ds_read_b64_tr_b16 v[112:113], v2 offset:20480
  ds_read_b64_tr_b16 v[114:115], v5 offset:20480
  s_waitcnt lgkmcnt(4)
  v_mfma_f32_32x32x16_bf16 v[96:111], v[116:119], v[124:127], v[96:111]
  ds_read_b64_tr_b16 v[116:117], v2 offset:20736
  ds_read_b64_tr_b16 v[118:119], v5 offset:20736
  s_nop 1
  v_exp_f32 v80, v80
  v_exp_f32 v81, v81
  v_exp_f32 v82, v82
  v_exp_f32 v83, v83
  v_exp_f32 v84, v84
  v_exp_f32 v85, v85
  v_exp_f32 v86, v86
  v_exp_f32 v87, v87
  v_exp_f32 v88, v88
  v_exp_f32 v89, v89
  v_exp_f32 v90, v90
  v_exp_f32 v91, v91
  v_exp_f32 v92, v92
  v_exp_f32 v93, v93
  v_exp_f32 v94, v94
  v_exp_f32 v95, v95
  v_cvt_pk_bf16_f32 v120, v80, v81
  v_cvt_pk_bf16_f32 v121, v82, v83
  v_cvt_pk_bf16_f32 v122, v84, v85
  v_cvt_pk_bf16_f32 v123, v86, v87
  v_cvt_pk_bf16_f32 v124, v88, v89
  v_cvt_pk_bf16_f32 v125, v90, v91
  v_cvt_pk_bf16_f32 v126, v92, v93
  v_cvt_pk_bf16_f32 v127, v94, v95
  s_setprio 0
  s_waitcnt lgkmcnt(5)
  v_mfma_f32_32x32x16_bf16 v[80:95], v[136:139], v[128:131], 0
  s_waitcnt lgkmcnt(4)
  v_mfma_f32_32x32x16_bf16 v[80:95], v[140:143], v[132:135], v[80:95]
  ds_read_b128 v[136:139], v246 offset:24576
  ds_read_b128 v[140:143], v246 offset:25600
  s_waitcnt lgkmcnt(4)
  v_mfma_f32_32x32x16_bf16 v[96:111], v[112:115], v[120:123], v[96:111]
  ds_read_b64_tr_b16 v[112:113], v2 offset:24576
  ds_read_b64_tr_b16 v[114:115], v5 offset:24576
  s_waitcnt lgkmcnt(4)
  v_mfma_f32_32x32x16_bf16 v[96:111], v[116:119], v[124:127], v[96:111]
  ds_read_b64_tr_b16 v[116:117], v2 offset:24832
  ds_read_b64_tr_b16 v[118:119], v5 offset:24832
  s_nop 1
  v_exp_f32 v80, v80
  v_exp_f32 v81, v81
  v_exp_f32 v82, v82
  v_exp_f32 v83, v83
  v_exp_f32 v84, v84
  v_exp_f32 v85, v85
  v_exp_f32 v86, v86
  v_exp_f32 v87, v87
  v_exp_f32 v88, v88
  v_exp_f32 v89, v89
  v_exp_f32 v90, v90
  v_exp_f32 v91, v91
  v_exp_f32 v92, v92
  v_exp_f32 v93, v93
  v_exp_f32 v94, v94
  v_exp_f32 v95, v95
  v_cvt_pk_bf16_f32 v120, v80, v81
  v_cvt_pk_bf16_f32 v121, v82, v83
  v_cvt_pk_bf16_f32 v122, v84, v85
  v_cvt_pk_bf16_f32 v123, v86, v87
  v_cvt_pk_bf16_f32 v124, v88, v89
  v_cvt_pk_bf16_f32 v125, v90, v91
  v_cvt_pk_bf16_f32 v126, v92, v93
  v_cvt_pk_bf16_f32 v127, v94, v95
  s_cbranch_vccz L_sk31
  s_waitcnt vmcnt(0)
  s_waitcnt lgkmcnt(0)
  s_barrier
L_sk31:
  s_setprio 3
  s_waitcnt lgkmcnt(5)
  v_mfma_f32_32x32x16_bf16 v[80:95], v[136:139], v[128:131], 0
  s_waitcnt lgkmcnt(4)
  v_mfma_f32_32x32x16_bf16 v[80:95], v[140:143], v[132:135], v[80:95]
  ds_read_b128 v[136:139], v246 offset:28672
  ds_read_b128 v[140:143], v246 offset:29696
  s_waitcnt lgkmcnt(4)
  v_mfma_f32_32x32x16_bf16 v[96:111], v[112:115], v[120:123], v[96:111]
  ds_read_b64_tr_b16 v[112:113], v2 offset:28672
  ds_read_b64_tr_b16 v[114:115], v5 offset:28672
  s_waitcnt lgkmcnt(4)
  v_mfma_f32_32x32x16_bf16 v[96:111], v[116:119], v[124:127], v[96:111]
  ds_read_b64_tr_b16 v[116:117], v2 offset:28928
  ds_read_b64_tr_b16 v[118:119], v5 offset:28928
  s_cbranch_vccnz L_sk32
  s_waitcnt vmcnt(0)
  s_waitcnt lgkmcnt(0)
  s_barrier
L_sk32:
  s_nop 0
  v_exp_f32 v80, v80
  v_exp_f32 v81, v81
  v_exp_f32 v82, v82
  v_exp_f32 v83, v83
  v_exp_f32 v84, v84
  v_exp_f32 v85, v85
  v_exp_f32 v86, v86
  v_exp_f32 v87, v87
  v_exp_f32 v88, v88
  v_exp_f32 v89, v89
  v_exp_f32 v90, v90
  v_exp_f32 v91, v91
  v_exp_f32 v92, v92
  v_exp_f32 v93, v93
  v_exp_f32 v94, v94
  v_exp_f32 v95, v95
  v_cvt_pk_bf16_f32 v120, v80, v81
  v_cvt_pk_bf16_f32 v121, v82, v83
  v_cvt_pk_bf16_f32 v122, v84, v85
  v_cvt_pk_bf16_f32 v123, v86, v87
  v_cvt_pk_bf16_f32 v124, v88, v89
  v_cvt_pk_bf16_f32 v125, v90, v91
  v_cvt_pk_bf16_f32 v126, v92, v93
  v_cvt_pk_bf16_f32 v127, v94, v95
  s_setprio 2
  s_waitcnt lgkmcnt(5)
  v_mfma_f32_32x32x16_bf16 v[80:95], v[136:139], v[128:131], 0
  s_waitcnt lgkmcnt(4)
  v_mfma_f32_32x32x16_bf16 v[80:95], v[140:143], v[132:135], v[80:95]
  s_waitcnt lgkmcnt(2)
  v_mfma_f32_32x32x16_bf16 v[96:111], v[112:115], v[120:123], v[96:111]
  ds_read_b64_tr_b16 v[112:113], v2 offset:32768
  ds_read_b64_tr_b16 v[114:115], v5 offset:32768
  s_waitcnt lgkmcnt(2)
  v_mfma_f32_32x32x16_bf16 v[96:111], v[116:119], v[124:127], v[96:111]
  ds_read_b64_tr_b16 v[116:117], v2 offset:33024
  ds_read_b64_tr_b16 v[118:119], v5 offset:33024
  s_nop 3
  v_exp_f32 v80, v80
  v_exp_f32 v81, v81
  v_exp_f32 v82, v82
  v_exp_f32 v83, v83
  v_exp_f32 v84, v84
  v_exp_f32 v85, v85
  v_exp_f32 v86, v86
  v_exp_f32 v87, v87
  v_exp_f32 v88, v88
  v_exp_f32 v89, v89
  v_exp_f32 v90, v90
  v_exp_f32 v91, v91
  v_exp_f32 v92, v92
  v_exp_f32 v93, v93
  v_exp_f32 v94, v94
  v_exp_f32 v95, v95
  v_cvt_pk_bf16_f32 v120, v80, v81
  v_cvt_pk_bf16_f32 v121, v82, v83
  v_cvt_pk_bf16_f32 v122, v84, v85
  v_cvt_pk_bf16_f32 v123, v86, v87
  v_cvt_pk_bf16_f32 v124, v88, v89
  v_cvt_pk_bf16_f32 v125, v90, v91
  v_cvt_pk_bf16_f32 v126, v92, v93
  v_cvt_pk_bf16_f32 v127, v94, v95
  s_waitcnt lgkmcnt(2)
  v_mfma_f32_32x32x16_bf16 v[96:111], v[112:115], v[120:123], v[96:111]
  s_waitcnt lgkmcnt(0)
  v_mfma_f32_32x32x16_bf16 v[96:111], v[116:119], v[124:127], v[96:111]
L_attn_done:
  s_setprio 0
  s_lshl_b32 s54, s3, 2
  s_add_u32 s54, s54, 65536
  v_mov_b32 v8, s54
  s_lshl_b32 s54, s10, 13
  s_add_u32 s54, s54, 98304
  v_add_u32 v9, s54, v15
  v_and_b32 v4, 7, v0
  v_lshlrev_b32 v10, 2, v4
  v_add_u32 v10, 65536, v10
  s_nop 1
  v_and_b32 v3, v108, v253
  v_mov_b32 v4, 1317011456
  v_cmp_ngt_f32 s[48:49], v4, v3
  s_nop 0
  s_cmp_lg_u64 s[48:49], 0
  s_cselect_b32 s54, 1, 0
  v_mov_b32 v4, s54
  ds_write_b32 v8, v4
  s_cbranch_vccnz L_nowr
  s_waitcnt lgkmcnt(0)
  ds_write_b128 v9, v[96:99] offset:0
  ds_write_b128 v9, v[100:103] offset:1024
  ds_write_b128 v9, v[104:107] offset:2048
  ds_write_b128 v9, v[108:111] offset:3072
L_nowr:
  s_waitcnt vmcnt(5)
  s_waitcnt lgkmcnt(0)
  s_barrier
  s_cbranch_vccz L_lead
  s_setprio 3
  ds_read_b128 v[188:191], v9 offset:3072
  ds_read_b128 v[176:179], v9 offset:0
  ds_read_b128 v[180:183], v9 offset:1024
  ds_read_b128 v[184:187], v9 offset:2048
  ds_read_b32 v8, v10
  s_waitcnt lgkmcnt(4)
  v_add_f32 v3, v108, v188
  s_waitcnt lgkmcnt(3)
  v_add_f32 v96, v96, v176
  v_add_f32 v97, v97, v177
  v_add_f32 v98, v98, v178
  v_add_f32 v99, v99, v179
  s_waitcnt lgkmcnt(2)
  v_add_f32 v100, v100, v180
  v_add_f32 v101, v101, v181
  v_add_f32 v102, v102, v182
  v_add_f32 v103, v103, v183
  s_waitcnt lgkmcnt(1)
  v_add_f32 v104, v104, v184
  v_add_f32 v105, v105, v185
  v_add_f32 v106, v106, v186
  v_add_f32 v107, v107, v187
  v_mov_b32 v4, v3
  v_mov_b32 v108, v3
  v_add_f32 v109, v109, v189
  v_add_f32 v110, v110, v190
  v_add_f32 v111, v111, v191
  v_permlane32_swap_b32 v3, v4
  v_rcp_f32 v4, v4
  s_waitcnt lgkmcnt(0)
  v_cmp_ne_u32 s[48:49], 0, v8
  s_nop 0
  s_cmp_lg_u64 s[48:49], 0
  s_cselect_b32 s54, 1, 0
  s_andn2_b32 s54, s54, s60
  s_cmp_lg_u32 s54, 0
  s_cbranch_scc1 L_fallback
  v_mul_f32 v96, v96, v4
  v_mul_f32 v97, v97, v4
  v_mul_f32 v98, v98, v4
  v_mul_f32 v99, v99, v4
  v_mul_f32 v100, v100, v4
  v_mul_f32 v101, v101, v4
  v_mul_f32 v102, v102, v4
  v_mul_f32 v103, v103, v4
  v_cvt_pk_bf16_f32 v176, v96, v97
  v_cvt_pk_bf16_f32 v177, v98, v99
  v_cvt_pk_bf16_f32 v178, v100, v101
  v_cvt_pk_bf16_f32 v179, v102, v103
  v_min_u32 v176, -2, v176
  v_min_u32 v177, -2, v177
  v_min_u32 v178, -2, v178
  v_min_u32 v179, -2, v179
  buffer_store_dwordx4 v[176:179], v15, s[32:35], s75 offen offset:0 sc1
  v_mul_f32 v104, v104, v4
  v_mul_f32 v105, v105, v4
  v_mul_f32 v106, v106, v4
  v_mul_f32 v107, v107, v4
  v_mul_f32 v108, v108, v4
  v_mul_f32 v109, v109, v4
  v_mul_f32 v110, v110, v4
  v_mul_f32 v111, v111, v4
  v_cvt_pk_bf16_f32 v180, v104, v105
  v_cvt_pk_bf16_f32 v181, v106, v107
  v_cvt_pk_bf16_f32 v182, v108, v109
  v_cvt_pk_bf16_f32 v183, v110, v111
  v_and_b32 v182, v182, v252
  v_and_b32 v183, v183, v252
  v_min_u32 v180, -2, v180
  v_min_u32 v181, -2, v181
  v_min_u32 v182, -2, v182
  v_min_u32 v183, -2, v183
  buffer_store_dwordx4 v[180:183], v15, s[32:35], s75 offen offset:1024 sc1
  s_setprio 0
  s_cmp_eq_u32 s65, 0
  s_cbranch_scc1 L_lagflag
  s_mul_i32 s63, s10, 14336
  s_add_u32 s63, s63, s78
  s_add_u32 s63, s63, 1605632
  s_add_u32 s62, s61, 110592
  s_branch L_laggo
L_lagflag:
  s_branch L_end
L_laggo:
  v_mfma_f32_32x32x16_bf16 v[16:31], v[208:211], v[168:171], v[16:31]
  v_mfma_f32_32x32x16_bf16 v[48:63], v[212:215], v[168:171], v[48:63]
  s_waitcnt vmcnt(6)
  v_mfma_f32_32x32x16_bf16 v[32:47], v[208:211], v[172:175], v[32:47]
  v_mfma_f32_32x32x16_bf16 v[64:79], v[212:215], v[172:175], v[64:79]
  s_waitcnt vmcnt(5)
  v_mfma_f32_32x32x16_bf16 v[16:31], v[216:219], v[144:147], v[16:31]
  v_mfma_f32_32x32x16_bf16 v[48:63], v[220:223], v[144:147], v[48:63]
  s_waitcnt vmcnt(4)
  v_mfma_f32_32x32x16_bf16 v[32:47], v[216:219], v[148:151], v[32:47]
  v_mfma_f32_32x32x16_bf16 v[64:79], v[220:223], v[148:151], v[64:79]
  s_waitcnt vmcnt(3)
  v_mfma_f32_32x32x16_bf16 v[16:31], v[224:227], v[152:155], v[16:31]
  v_mfma_f32_32x32x16_bf16 v[48:63], v[228:231], v[152:155], v[48:63]
  s_waitcnt vmcnt(2)
  v_mfma_f32_32x32x16_bf16 v[32:47], v[224:227], v[156:159], v[32:47]
  v_mfma_f32_32x32x16_bf16 v[64:79], v[228:231], v[156:159], v[64:79]
  s_bfe_u32 s54, s3, 0x10001
  s_lshl_b32 s55, s77, 1
  s_add_u32 s54, s54, s55
  s_mul_i32 s54, s54, 28672
  s_lshl_b32 s55, s52, 6
  s_add_u32 s54, s54, s55
  s_and_b32 s55, s3, 1
  s_lshl_b32 s55, s55, 5
  s_add_u32 s54, s54, s55
  s_add_u32 s54, s54, s78
  v_and_b32 v3, 31, v0
  v_mul_u32_u24 v11, 896, v3
  v_lshrrev_b32 v4, 5, v0
  v_lshl_add_u32 v11, v4, 4, v11
  v_add_u32 v11, s54, v11
  buffer_load_dwordx4 v[236:239], v11, s[24:27], 0 offen
  v_lshlrev_b32 v3, 4, v3
  v_lshl_add_u32 v3, v4, 10, v3
  s_lshl_b32 s54, s3, 11
  v_add_u32 v2, s54, v3
  s_lshl_b32 s54, s10, 11
  s_lshl_b32 s55, s52, 15
  s_add_u32 s54, s54, s55
  s_add_u32 s54, s54, 98304
  v_add_u32 v5, s54, v3
  v_subrev_u32 v3, 32768, v242
  v_subrev_u32 v4, 32768, v243
  ds_write_b128 v9, v[16:19] offset:0
  ds_write_b128 v9, v[20:23] offset:1024
  ds_write_b128 v9, v[24:27] offset:2048
  ds_write_b128 v9, v[28:31] offset:3072
  ds_write_b128 v9, v[32:35] offset:4096
  ds_write_b128 v9, v[36:39] offset:5120
  ds_write_b128 v9, v[40:43] offset:6144
  ds_write_b128 v9, v[44:47] offset:7168
  ds_write_b128 v9, v[48:51] offset:32768
  ds_write_b128 v9, v[52:55] offset:33792
  ds_write_b128 v9, v[56:59] offset:34816
  ds_write_b128 v9, v[60:63] offset:35840
  ds_write_b128 v9, v[64:67] offset:36864
  ds_write_b128 v9, v[68:71] offset:37888
  ds_write_b128 v9, v[72:75] offset:38912
  ds_write_b128 v9, v[76:79] offset:39936
  s_branch L_final
L_lead:
  ds_read_b32 v8, v10
  s_mul_i32 s55, s10, 7168
  s_add_u32 s62, s55, s61
  s_add_u32 s62, s62, 114688
  s_add_u32 s63, s62, 4096
  s_waitcnt lgkmcnt(0)
  v_cmp_ne_u32 s[48:49], 0, v8
  s_nop 0
  s_cmp_lg_u64 s[48:49], 0
  s_cselect_b32 s54, 1, 0
  s_andn2_b32 s54, s54, s60
  s_cmp_lg_u32 s54, 0
  s_cbranch_scc1 L_fallback
  s_cmp_eq_u32 s65, 0
  s_cbranch_scc1 L_end
  s_cmp_eq_u32 s60, 0
  s_cbranch_scc1 L_wo_ok
  s_mov_b32 s67, 0
  s_lshr_b32 s71, s67, 1
  s_mul_i32 s71, s71, -3584
  s_mul_i32 s72, s67, 14336
  s_add_u32 s71, s71, s72
  s_add_u32 s71, s71, s69
  s_add_u32 s72, s67, s70
  s_and_b32 s72, s72, 7
  s_lshl_b32 s72, s72, 11
  s_add_u32 s72, s72, s68
  s_mov_b32 m0, s72
  s_nop 0
  buffer_load_dwordx4 v6, s[44:47], s71 offen offset:0 lds
  s_mov_b32 m0, s72
  s_nop 0
  buffer_load_dwordx4 v7, s[44:47], s71 offen offset:1024 lds
  s_mov_b32 s67, 1
  s_lshr_b32 s71, s67, 1
  s_mul_i32 s71, s71, -3584
  s_mul_i32 s72, s67, 14336
  s_add_u32 s71, s71, s72
  s_add_u32 s71, s71, s69
  s_add_u32 s72, s67, s70
  s_and_b32 s72, s72, 7
  s_lshl_b32 s72, s72, 11
  s_add_u32 s72, s72, s68
  s_mov_b32 m0, s72
  s_nop 0
  buffer_load_dwordx4 v6, s[44:47], s71 offen offset:0 lds
  s_mov_b32 m0, s72
  s_nop 0
  buffer_load_dwordx4 v7, s[44:47], s71 offen offset:1024 lds
  s_mov_b32 s67, 2
  s_lshr_b32 s71, s67, 1
  s_mul_i32 s71, s71, -3584
  s_mul_i32 s72, s67, 14336
  s_add_u32 s71, s71, s72
  s_add_u32 s71, s71, s69
  s_add_u32 s72, s67, s70
  s_and_b32 s72, s72, 7
  s_lshl_b32 s72, s72, 11
  s_add_u32 s72, s72, s68
  s_mov_b32 m0, s72
  s_nop 0
  buffer_load_dwordx4 v6, s[44:47], s71 offen offset:0 lds
  s_mov_b32 m0, s72
  s_nop 0
  buffer_load_dwordx4 v7, s[44:47], s71 offen offset:1024 lds
  s_mov_b32 s67, 3
  s_lshr_b32 s71, s67, 1
  s_mul_i32 s71, s71, -3584
  s_mul_i32 s72, s67, 14336
  s_add_u32 s71, s71, s72
  s_add_u32 s71, s71, s69
  s_add_u32 s72, s67, s70
  s_and_b32 s72, s72, 7
  s_lshl_b32 s72, s72, 11
  s_add_u32 s72, s72, s68
  s_mov_b32 m0, s72
  s_nop 0
  buffer_load_dwordx4 v6, s[44:47], s71 offen offset:0 lds
  s_mov_b32 m0, s72
  s_nop 0
  buffer_load_dwordx4 v7, s[44:47], s71 offen offset:1024 lds
  s_mov_b32 s67, 4
  s_lshr_b32 s71, s67, 1
  s_mul_i32 s71, s71, -3584
  s_mul_i32 s72, s67, 14336
  s_add_u32 s71, s71, s72
  s_add_u32 s71, s71, s69
  s_add_u32 s72, s67, s70
  s_and_b32 s72, s72, 7
  s_lshl_b32 s72, s72, 11
  s_add_u32 s72, s72, s68
  s_mov_b32 m0, s72
  s_nop 0
  buffer_load_dwordx4 v6, s[44:47], s71 offen offset:0 lds
  s_mov_b32 m0, s72
  s_nop 0
  buffer_load_dwordx4 v7, s[44:47], s71 offen offset:1024 lds
  s_mov_b32 s67, 5
  s_lshr_b32 s71, s67, 1
  s_mul_i32 s71, s71, -3584
  s_mul_i32 s72, s67, 14336
  s_add_u32 s71, s71, s72
  s_add_u32 s71, s71, s69
  s_add_u32 s72, s67, s70
  s_and_b32 s72, s72, 7
  s_lshl_b32 s72, s72, 11
  s_add_u32 s72, s72, s68
  s_mov_b32 m0, s72
  s_nop 0
  buffer_load_dwordx4 v6, s[44:47], s71 offen offset:0 lds
  s_mov_b32 m0, s72
  s_nop 0
  buffer_load_dwordx4 v7, s[44:47], s71 offen offset:1024 lds
  s_waitcnt vmcnt(0)
L_wo_ok:
  s_mov_b32 s67, 6
  s_lshr_b32 s71, s67, 1
  s_mul_i32 s71, s71, -3584
  s_mul_i32 s72, s67, 14336
  s_add_u32 s71, s71, s72
  s_add_u32 s71, s71, s69
  s_add_u32 s72, s67, s70
  s_and_b32 s72, s72, 7
  s_lshl_b32 s72, s72, 11
  s_add_u32 s72, s72, s68
  s_mov_b32 m0, s72
  s_nop 0
  buffer_load_dwordx4 v6, s[44:47], s71 offen offset:0 lds
  s_mov_b32 m0, s72
  s_nop 0
  buffer_load_dwordx4 v7, s[44:47], s71 offen offset:1024 lds
  s_mov_b32 s67, 7
  s_lshr_b32 s71, s67, 1
  s_mul_i32 s71, s71, -3584
  s_mul_i32 s72, s67, 14336
  s_add_u32 s71, s71, s72
  s_add_u32 s71, s71, s69
  s_add_u32 s72, s67, s70
  s_and_b32 s72, s72, 7
  s_lshl_b32 s72, s72, 11
  s_add_u32 s72, s72, s68
  s_mov_b32 m0, s72
  s_nop 0
  buffer_load_dwordx4 v6, s[44:47], s71 offen offset:0 lds
  s_mov_b32 m0, s72
  s_nop 0
  buffer_load_dwordx4 v7, s[44:47], s71 offen offset:1024 lds
  s_lshl_b32 s55, s70, 11
  s_sub_u32 s54, s68, s64
  s_add_u32 s54, s54, s55
  v_add_u32 v8, s54, v242
  v_add_u32 v9, s54, v243
  ds_read_b64_tr_b16 v[80:81], v8 offset:0
  ds_read_b64_tr_b16 v[82:83], v8 offset:1024
  ds_read_b64_tr_b16 v[84:85], v9 offset:0
  ds_read_b64_tr_b16 v[86:87], v9 offset:1024
  ds_read_b64_tr_b16 v[88:89], v8 offset:2048
  ds_read_b64_tr_b16 v[90:91], v8 offset:3072
  ds_read_b64_tr_b16 v[92:93], v9 offset:2048
  ds_read_b64_tr_b16 v[94:95], v9 offset:3072
  ds_read_b64_tr_b16 v[96:97], v8 offset:4096
  ds_read_b64_tr_b16 v[98:99], v8 offset:5120
  ds_read_b64_tr_b16 v[100:101], v9 offset:4096
  ds_read_b64_tr_b16 v[102:103], v9 offset:5120
  ds_read_b64_tr_b16 v[104:105], v8 offset:6144
  ds_read_b64_tr_b16 v[106:107], v8 offset:7168
  ds_read_b64_tr_b16 v[108:109], v9 offset:6144
  ds_read_b64_tr_b16 v[110:111], v9 offset:7168
  ds_read_b64_tr_b16 v[112:113], v8 offset:8192
  ds_read_b64_tr_b16 v[114:115], v8 offset:9216
  ds_read_b64_tr_b16 v[116:117], v9 offset:8192
  ds_read_b64_tr_b16 v[118:119], v9 offset:9216
  ds_read_b64_tr_b16 v[120:121], v8 offset:10240
  ds_read_b64_tr_b16 v[122:123], v8 offset:11264
  ds_read_b64_tr_b16 v[124:125], v9 offset:10240
  ds_read_b64_tr_b16 v[126:127], v9 offset:11264
  v_mfma_f32_32x32x16_bf16 v[16:31], v[208:211], v[168:171], v[16:31]
  v_mfma_f32_32x32x16_bf16 v[48:63], v[212:215], v[168:171], v[48:63]
  s_waitcnt vmcnt(8)
  v_mfma_f32_32x32x16_bf16 v[32:47], v[208:211], v[172:175], v[32:47]
  v_mfma_f32_32x32x16_bf16 v[64:79], v[212:215], v[172:175], v[64:79]
  s_waitcnt vmcnt(7)
  v_mfma_f32_32x32x16_bf16 v[16:31], v[216:219], v[144:147], v[16:31]
  v_mfma_f32_32x32x16_bf16 v[48:63], v[220:223], v[144:147], v[48:63]
  s_waitcnt vmcnt(6)
  v_mfma_f32_32x32x16_bf16 v[32:47], v[216:219], v[148:151], v[32:47]
  v_mfma_f32_32x32x16_bf16 v[64:79], v[220:223], v[148:151], v[64:79]
  s_waitcnt vmcnt(5)
  v_mfma_f32_32x32x16_bf16 v[16:31], v[224:227], v[152:155], v[16:31]
  v_mfma_f32_32x32x16_bf16 v[48:63], v[228:231], v[152:155], v[48:63]
  s_waitcnt vmcnt(4)
  v_mfma_f32_32x32x16_bf16 v[32:47], v[224:227], v[156:159], v[32:47]
  v_mfma_f32_32x32x16_bf16 v[64:79], v[228:231], v[156:159], v[64:79]
  buffer_load_dwordx4 v[176:179], v15, s[32:35], s62 offen offset:0 sc1
  buffer_load_dwordx4 v[180:183], v254, s[32:35], s62 offen offset:0 sc1
  buffer_load_dwordx4 v[184:187], v15, s[32:35], s62 offen offset:1024 sc1
  buffer_load_dwordx4 v[188:191], v254, s[32:35], s62 offen offset:1024 sc1
  buffer_load_dwordx4 v[192:195], v15, s[32:35], s62 offen offset:2048 sc1
  buffer_load_dwordx4 v[196:199], v254, s[32:35], s62 offen offset:2048 sc1
  buffer_load_dwordx4 v[200:203], v15, s[32:35], s62 offen offset:3072 sc1
  buffer_load_dwordx4 v[204:207], v254, s[32:35], s62 offen offset:3072 sc1
  buffer_load_dwordx4 v[144:147], v15, s[32:35], s63 offen offset:0 sc1
  buffer_load_dwordx4 v[148:151], v254, s[32:35], s63 offen offset:0 sc1
  buffer_load_dwordx4 v[152:155], v15, s[32:35], s63 offen offset:1024 sc1
  buffer_load_dwordx4 v[156:159], v254, s[32:35], s63 offen offset:1024 sc1
  buffer_load_dwordx4 v[160:163], v15, s[32:35], s63 offen offset:2048 sc1
  buffer_load_dwordx4 v[164:167], v254, s[32:35], s63 offen offset:2048 sc1
  buffer_load_dwordx4 v[168:171], v15, s[32:35], s63 offen offset:3072 sc1
  buffer_load_dwordx4 v[172:175], v254, s[32:35], s63 offen offset:3072 sc1
  s_lshl_b32 s55, s70, 13
  v_subrev_u32 v8, s55, v8
  v_subrev_u32 v9, s55, v9
  s_waitcnt vmcnt(16)
  ds_read_b64_tr_b16 v[128:129], v8 offset:12288
  ds_read_b64_tr_b16 v[130:131], v8 offset:13312
  ds_read_b64_tr_b16 v[132:133], v9 offset:12288
  ds_read_b64_tr_b16 v[134:135], v9 offset:13312
  ds_read_b64_tr_b16 v[136:137], v8 offset:14336
  ds_read_b64_tr_b16 v[138:139], v8 offset:15360
  ds_read_b64_tr_b16 v[140:141], v9 offset:14336
  ds_read_b64_tr_b16 v[142:143], v9 offset:15360
  s_bfe_u32 s54, s3, 0x10001
  s_lshl_b32 s55, s77, 1
  s_add_u32 s54, s54, s55
  s_mul_i32 s54, s54, 28672
  s_lshl_b32 s55, s52, 6
  s_add_u32 s54, s54, s55
  s_and_b32 s55, s3, 1
  s_lshl_b32 s55, s55, 5
  s_add_u32 s54, s54, s55
  s_add_u32 s54, s54, s78
  v_and_b32 v3, 31, v0
  v_mul_u32_u24 v11, 896, v3
  v_lshrrev_b32 v4, 5, v0
  v_lshl_add_u32 v11, v4, 4, v11
  v_add_u32 v11, s54, v11
  buffer_load_dwordx4 v[236:239], v11, s[24:27], 0 offen
  v_lshlrev_b32 v3, 4, v3
  v_lshl_add_u32 v3, v4, 10, v3
  s_lshl_b32 s54, s3, 11
  v_add_u32 v2, s54, v3
  s_lshl_b32 s54, s10, 11
  s_lshl_b32 s55, s52, 15
  s_add_u32 s54, s54, s55
  s_add_u32 s54, s54, 98304
  v_add_u32 v5, s54, v3
  s_lshl_b32 s54, s3, 14
  v_add_u32 v3, s54, v15
  s_waitcnt lgkmcnt(0)
  s_nop 1
  s_mov_b32 s57, 0
  s_mov_b32 s56, 0
  s_waitcnt vmcnt(13)
  v_max3_u32 v4, v176, v177, v178
  v_max3_u32 v10, v179, v180, v181
  v_max3_u32 v4, v4, v182, v183
  v_max3_u32 v10, v10, v184, v185
  v_max3_u32 v4, v4, v186, v187
  v_max3_u32 v10, v10, v188, v189
  v_max3_u32 v4, v4, v190, v191
  v_max_u32 v4, v4, v10
  v_cmp_eq_u32 s[48:49], -1, v4
  s_nop 1
  s_cmp_eq_u64 s[48:49], 0
  s_cbranch_scc0 L_ha0
  s_bitset1_b32 s56, 0
L_ha0v:
  s_cmp_eq_u32 s57, 0
  s_cbranch_scc0 L_ha0
  v_mfma_f32_32x32x16_bf16 v[16:31], v[80:83], v[176:179], v[16:31]
  v_mfma_f32_32x32x16_bf16 v[48:63], v[84:87], v[176:179], v[48:63]
  v_mfma_f32_32x32x16_bf16 v[32:47], v[80:83], v[180:183], v[32:47]
  v_mfma_f32_32x32x16_bf16 v[64:79], v[84:87], v[180:183], v[64:79]
  v_mfma_f32_32x32x16_bf16 v[16:31], v[88:91], v[184:187], v[16:31]
  v_mfma_f32_32x32x16_bf16 v[48:63], v[92:95], v[184:187], v[48:63]
  v_mfma_f32_32x32x16_bf16 v[32:47], v[88:91], v[188:191], v[32:47]
  v_mfma_f32_32x32x16_bf16 v[64:79], v[92:95], v[188:191], v[64:79]
  s_bitset1_b32 s57, 0
L_ha0:
  s_waitcnt vmcnt(9)
  v_max3_u32 v4, v192, v193, v194
  v_max3_u32 v10, v195, v196, v197
  v_max3_u32 v4, v4, v198, v199
  v_max3_u32 v10, v10, v200, v201
  v_max3_u32 v4, v4, v202, v203
  v_max3_u32 v10, v10, v204, v205
  v_max3_u32 v4, v4, v206, v207
  v_max_u32 v4, v4, v10
  v_cmp_eq_u32 s[48:49], -1, v4
  s_nop 1
  s_cmp_eq_u64 s[48:49], 0
  s_cbranch_scc0 L_ha1
  s_bitset1_b32 s56, 1
L_ha1v:
  s_cmp_eq_u32 s57, 1
  s_cbranch_scc0 L_ha1
  v_mfma_f32_32x32x16_bf16 v[16:31], v[96:99], v[192:195], v[16:31]
  v_mfma_f32_32x32x16_bf16 v[48:63], v[100:103], v[192:195], v[48:63]
  v_mfma_f32_32x32x16_bf16 v[32:47], v[96:99], v[196:199], v[32:47]
  v_mfma_f32_32x32x16_bf16 v[64:79], v[100:103], v[196:199], v[64:79]
  v_mfma_f32_32x32x16_bf16 v[16:31], v[104:107], v[200:203], v[16:31]
  v_mfma_f32_32x32x16_bf16 v[48:63], v[108:111], v[200:203], v[48:63]
  v_mfma_f32_32x32x16_bf16 v[32:47], v[104:107], v[204:207], v[32:47]
  v_mfma_f32_32x32x16_bf16 v[64:79], v[108:111], v[204:207], v[64:79]
  s_bitset1_b32 s57, 1
L_ha1:
  s_waitcnt vmcnt(5)
  v_max3_u32 v4, v144, v145, v146
  v_max3_u32 v10, v147, v148, v149
  v_max3_u32 v4, v4, v150, v151
  v_max3_u32 v10, v10, v152, v153
  v_max3_u32 v4, v4, v154, v155
  v_max3_u32 v10, v10, v156, v157
  v_max3_u32 v4, v4, v158, v159
  v_max_u32 v4, v4, v10
  v_cmp_eq_u32 s[48:49], -1, v4
  s_nop 1
  s_cmp_eq_u64 s[48:49], 0
  s_cbranch_scc0 L_ha2
  s_bitset1_b32 s56, 2
L_ha2v:
  s_cmp_eq_u32 s57, 3
  s_cbranch_scc0 L_ha2
  v_mfma_f32_32x32x16_bf16 v[16:31], v[112:115], v[144:147], v[16:31]
  v_mfma_f32_32x32x16_bf16 v[48:63], v[116:119], v[144:147], v[48:63]
  v_mfma_f32_32x32x16_bf16 v[32:47], v[112:115], v[148:151], v[32:47]
  v_mfma_f32_32x32x16_bf16 v[64:79], v[116:119], v[148:151], v[64:79]
  v_mfma_f32_32x32x16_bf16 v[16:31], v[120:123], v[152:155], v[16:31]
  v_mfma_f32_32x32x16_bf16 v[48:63], v[124:127], v[152:155], v[48:63]
  v_mfma_f32_32x32x16_bf16 v[32:47], v[120:123], v[156:159], v[32:47]
  v_mfma_f32_32x32x16_bf16 v[64:79], v[124:127], v[156:159], v[64:79]
  s_bitset1_b32 s57, 2
L_ha2:
  s_waitcnt vmcnt(1)
  v_max3_u32 v4, v160, v161, v162
  v_max3_u32 v10, v163, v164, v165
  v_max3_u32 v4, v4, v166, v167
  v_max3_u32 v10, v10, v168, v169
  v_max3_u32 v4, v4, v170, v171
  v_max3_u32 v10, v10, v172, v173
  v_max3_u32 v4, v4, v174, v175
  v_max_u32 v4, v4, v10
  v_cmp_eq_u32 s[48:49], -1, v4
  s_nop 1
  s_cmp_eq_u64 s[48:49], 0
  s_cbranch_scc0 L_ha3
  s_bitset1_b32 s56, 3
L_ha3v:
  s_cmp_eq_u32 s57, 7
  s_cbranch_scc0 L_ha3
  v_mfma_f32_32x32x16_bf16 v[16:31], v[128:131], v[160:163], v[16:31]
  v_mfma_f32_32x32x16_bf16 v[48:63], v[132:135], v[160:163], v[48:63]
  v_mfma_f32_32x32x16_bf16 v[32:47], v[128:131], v[164:167], v[32:47]
  v_mfma_f32_32x32x16_bf16 v[64:79], v[132:135], v[164:167], v[64:79]
  v_mfma_f32_32x32x16_bf16 v[16:31], v[136:139], v[168:171], v[16:31]
  v_mfma_f32_32x32x16_bf16 v[48:63], v[140:143], v[168:171], v[48:63]
  v_mfma_f32_32x32x16_bf16 v[32:47], v[136:139], v[172:175], v[32:47]
  v_mfma_f32_32x32x16_bf16 v[64:79], v[140:143], v[172:175], v[64:79]
  s_bitset1_b32 s57, 3
L_ha3:
L_hloop:
  s_cmp_eq_u32 s57, 15
  s_cbranch_scc1 L_hdone
  s_sub_u32 s58, s58, 1
  s_cmp_lt_i32 s58, 1
  s_cbranch_scc1 L_hdone
  s_sleep 5
  s_bitcmp1_b32 s56, 0
  s_cbranch_scc1 L_hr0
  buffer_load_dwordx4 v[176:179], v15, s[32:35], s62 offen offset:0 sc1
  buffer_load_dwordx4 v[180:183], v254, s[32:35], s62 offen offset:0 sc1
  buffer_load_dwordx4 v[184:187], v15, s[32:35], s62 offen offset:1024 sc1
  buffer_load_dwordx4 v[188:191], v254, s[32:35], s62 offen offset:1024 sc1
L_hr0:
  s_bitcmp1_b32 s56, 1
  s_cbranch_scc1 L_hr1
  buffer_load_dwordx4 v[192:195], v15, s[32:35], s62 offen offset:2048 sc1
  buffer_load_dwordx4 v[196:199], v254, s[32:35], s62 offen offset:2048 sc1
  buffer_load_dwordx4 v[200:203], v15, s[32:35], s62 offen offset:3072 sc1
  buffer_load_dwordx4 v[204:207], v254, s[32:35], s62 offen offset:3072 sc1
L_hr1:
  s_bitcmp1_b32 s56, 2
  s_cbranch_scc1 L_hr2
  buffer_load_dwordx4 v[144:147], v15, s[32:35], s63 offen offset:0 sc1
  buffer_load_dwordx4 v[148:151], v254, s[32:35], s63 offen offset:0 sc1
  buffer_load_dwordx4 v[152:155], v15, s[32:35], s63 offen offset:1024 sc1
  buffer_load_dwordx4 v[156:159], v254, s[32:35], s63 offen offset:1024 sc1
L_hr2:
  s_bitcmp1_b32 s56, 3
  s_cbranch_scc1 L_hr3
  buffer_load_dwordx4 v[160:163], v15, s[32:35], s63 offen offset:2048 sc1
  buffer_load_dwordx4 v[164:167], v254, s[32:35], s63 offen offset:2048 sc1
  buffer_load_dwordx4 v[168:171], v15, s[32:35], s63 offen offset:3072 sc1
  buffer_load_dwordx4 v[172:175], v254, s[32:35], s63 offen offset:3072 sc1
L_hr3:
  s_waitcnt vmcnt(0)
  s_bitcmp1_b32 s56, 0
  s_cbranch_scc1 L_hb0v
  v_max3_u32 v4, v176, v177, v178
  v_max3_u32 v10, v179, v180, v181
  v_max3_u32 v4, v4, v182, v183
  v_max3_u32 v10, v10, v184, v185
  v_max3_u32 v4, v4, v186, v187
  v_max3_u32 v10, v10, v188, v189
  v_max3_u32 v4, v4, v190, v191
  v_max_u32 v4, v4, v10
  v_cmp_eq_u32 s[48:49], -1, v4
  s_nop 1
  s_cmp_eq_u64 s[48:49], 0
  s_cbranch_scc0 L_hb0
  s_bitset1_b32 s56, 0
L_hb0v:
  s_cmp_eq_u32 s57, 0
  s_cbranch_scc0 L_hb0
  v_mfma_f32_32x32x16_bf16 v[16:31], v[80:83], v[176:179], v[16:31]
  v_mfma_f32_32x32x16_bf16 v[48:63], v[84:87], v[176:179], v[48:63]
  v_mfma_f32_32x32x16_bf16 v[32:47], v[80:83], v[180:183], v[32:47]
  v_mfma_f32_32x32x16_bf16 v[64:79], v[84:87], v[180:183], v[64:79]
  v_mfma_f32_32x32x16_bf16 v[16:31], v[88:91], v[184:187], v[16:31]
  v_mfma_f32_32x32x16_bf16 v[48:63], v[92:95], v[184:187], v[48:63]
  v_mfma_f32_32x32x16_bf16 v[32:47], v[88:91], v[188:191], v[32:47]
  v_mfma_f32_32x32x16_bf16 v[64:79], v[92:95], v[188:191], v[64:79]
  s_bitset1_b32 s57, 0
L_hb0:
  s_bitcmp1_b32 s56, 1
  s_cbranch_scc1 L_hb1v
  v_max3_u32 v4, v192, v193, v194
  v_max3_u32 v10, v195, v196, v197
  v_max3_u32 v4, v4, v198, v199
  v_max3_u32 v10, v10, v200, v201
  v_max3_u32 v4, v4, v202, v203
  v_max3_u32 v10, v10, v204, v205
  v_max3_u32 v4, v4, v206, v207
  v_max_u32 v4, v4, v10
  v_cmp_eq_u32 s[48:49], -1, v4
  s_nop 1
  s_cmp_eq_u64 s[48:49], 0
  s_cbranch_scc0 L_hb1
  s_bitset1_b32 s56, 1
L_hb1v:
  s_cmp_eq_u32 s57, 1
  s_cbranch_scc0 L_hb1
  v_mfma_f32_32x32x16_bf16 v[16:31], v[96:99], v[192:195], v[16:31]
  v_mfma_f32_32x32x16_bf16 v[48:63], v[100:103], v[192:195], v[48:63]
  v_mfma_f32_32x32x16_bf16 v[32:47], v[96:99], v[196:199], v[32:47]
  v_mfma_f32_32x32x16_bf16 v[64:79], v[100:103], v[196:199], v[64:79]
  v_mfma_f32_32x32x16_bf16 v[16:31], v[104:107], v[200:203], v[16:31]
  v_mfma_f32_32x32x16_bf16 v[48:63], v[108:111], v[200:203], v[48:63]
  v_mfma_f32_32x32x16_bf16 v[32:47], v[104:107], v[204:207], v[32:47]
  v_mfma_f32_32x32x16_bf16 v[64:79], v[108:111], v[204:207], v[64:79]
  s_bitset1_b32 s57, 1
L_hb1:
  s_bitcmp1_b32 s56, 2
  s_cbranch_scc1 L_hb2v
  v_max3_u32 v4, v144, v145, v146
  v_max3_u32 v10, v147, v148, v149
  v_max3_u32 v4, v4, v150, v151
  v_max3_u32 v10, v10, v152, v153
  v_max3_u32 v4, v4, v154, v155
  v_max3_u32 v10, v10, v156, v157
  v_max3_u32 v4, v4, v158, v159
  v_max_u32 v4, v4, v10
  v_cmp_eq_u32 s[48:49], -1, v4
  s_nop 1
  s_cmp_eq_u64 s[48:49], 0
  s_cbranch_scc0 L_hb2
  s_bitset1_b32 s56, 2
L_hb2v:
  s_cmp_eq_u32 s57, 3
  s_cbranch_scc0 L_hb2
  v_mfma_f32_32x32x16_bf16 v[16:31], v[112:115], v[144:147], v[16:31]
  v_mfma_f32_32x32x16_bf16 v[48:63], v[116:119], v[144:147], v[48:63]
  v_mfma_f32_32x32x16_bf16 v[32:47], v[112:115], v[148:151], v[32:47]
  v_mfma_f32_32x32x16_bf16 v[64:79], v[116:119], v[148:151], v[64:79]
  v_mfma_f32_32x32x16_bf16 v[16:31], v[120:123], v[152:155], v[16:31]
  v_mfma_f32_32x32x16_bf16 v[48:63], v[124:127], v[152:155], v[48:63]
  v_mfma_f32_32x32x16_bf16 v[32:47], v[120:123], v[156:159], v[32:47]
  v_mfma_f32_32x32x16_bf16 v[64:79], v[124:127], v[156:159], v[64:79]
  s_bitset1_b32 s57, 2
L_hb2:
  s_bitcmp1_b32 s56, 3
  s_cbranch_scc1 L_hb3v
  v_max3_u32 v4, v160, v161, v162
  v_max3_u32 v10, v163, v164, v165
  v_max3_u32 v4, v4, v166, v167
  v_max3_u32 v10, v10, v168, v169
  v_max3_u32 v4, v4, v170, v171
  v_max3_u32 v10, v10, v172, v173
  v_max3_u32 v4, v4, v174, v175
  v_max_u32 v4, v4, v10
  v_cmp_eq_u32 s[48:49], -1, v4
  s_nop 1
  s_cmp_eq_u64 s[48:49], 0
  s_cbranch_scc0 L_hb3
  s_bitset1_b32 s56, 3
L_hb3v:
  s_cmp_eq_u32 s57, 7
  s_cbranch_scc0 L_hb3
  v_mfma_f32_32x32x16_bf16 v[16:31], v[128:131], v[160:163], v[16:31]
  v_mfma_f32_32x32x16_bf16 v[48:63], v[132:135], v[160:163], v[48:63]
  v_mfma_f32_32x32x16_bf16 v[32:47], v[128:131], v[164:167], v[32:47]
  v_mfma_f32_32x32x16_bf16 v[64:79], v[132:135], v[164:167], v[64:79]
  v_mfma_f32_32x32x16_bf16 v[16:31], v[136:139], v[168:171], v[16:31]
  v_mfma_f32_32x32x16_bf16 v[48:63], v[140:143], v[168:171], v[48:63]
  v_mfma_f32_32x32x16_bf16 v[32:47], v[136:139], v[172:175], v[32:47]
  v_mfma_f32_32x32x16_bf16 v[64:79], v[140:143], v[172:175], v[64:79]
  s_bitset1_b32 s57, 3
L_hb3:
  s_branch L_hloop
L_hdone:
  s_nop 7
  s_nop 3
  s_waitcnt vmcnt(0)
  ds_write_b128 v3, v[16:19] offset:0
  ds_write_b128 v3, v[20:23] offset:1024
  ds_write_b128 v3, v[24:27] offset:2048
  ds_write_b128 v3, v[28:31] offset:3072
  ds_write_b128 v3, v[32:35] offset:4096
  ds_write_b128 v3, v[36:39] offset:5120
  ds_write_b128 v3, v[40:43] offset:6144
  ds_write_b128 v3, v[44:47] offset:7168
  ds_write_b128 v3, v[48:51] offset:8192
  ds_write_b128 v3, v[52:55] offset:9216
  ds_write_b128 v3, v[56:59] offset:10240
  ds_write_b128 v3, v[60:63] offset:11264
  ds_write_b128 v3, v[64:67] offset:12288
  ds_write_b128 v3, v[68:71] offset:13312
  ds_write_b128 v3, v[72:75] offset:14336
  ds_write_b128 v3, v[76:79] offset:15360
L_final:
  s_waitcnt vmcnt(0)
  v_lshlrev_b32 v208, 16, v236
  v_and_b32 v209, 0xffff0000, v236
  v_lshlrev_b32 v210, 16, v237
  v_and_b32 v211, 0xffff0000, v237
  v_lshlrev_b32 v212, 16, v238
  v_and_b32 v213, 0xffff0000, v238
  v_lshlrev_b32 v214, 16, v239
  v_and_b32 v215, 0xffff0000, v239
  s_waitcnt lgkmcnt(0)
  s_barrier
  ds_read_b128 v[80:83], v2 offset:0
  ds_read_b128 v[84:87], v2 offset:512
  ds_read_b128 v[88:91], v2 offset:16384
  ds_read_b128 v[92:95], v2 offset:16896
  ds_read_b128 v[96:99], v2 offset:32768
  ds_read_b128 v[100:103], v2 offset:33280
  ds_read_b128 v[104:107], v2 offset:49152
  ds_read_b128 v[108:111], v2 offset:49664
  ds_read_b128 v[112:115], v5 offset:0
  ds_read_b128 v[116:119], v5 offset:512
  ds_read_b128 v[120:123], v5 offset:8192
  ds_read_b128 v[124:127], v5 offset:8704
  ds_read_b128 v[128:131], v5 offset:16384
  ds_read_b128 v[132:135], v5 offset:16896
  ds_read_b128 v[136:139], v5 offset:24576
  ds_read_b128 v[140:143], v5 offset:25088
  s_waitcnt lgkmcnt(15)
  v_add_f32 v208, v208, v80
  v_add_f32 v209, v209, v81
  v_add_f32 v210, v210, v82
  v_add_f32 v211, v211, v83
  s_waitcnt lgkmcnt(14)
  v_add_f32 v212, v212, v84
  v_add_f32 v213, v213, v85
  v_add_f32 v214, v214, v86
  v_add_f32 v215, v215, v87
  s_waitcnt lgkmcnt(13)
  v_add_f32 v208, v208, v88
  v_add_f32 v209, v209, v89
  v_add_f32 v210, v210, v90
  v_add_f32 v211, v211, v91
  s_waitcnt lgkmcnt(12)
  v_add_f32 v212, v212, v92
  v_add_f32 v213, v213, v93
  v_add_f32 v214, v214, v94
  v_add_f32 v215, v215, v95
  s_waitcnt lgkmcnt(11)
  v_add_f32 v208, v208, v96
  v_add_f32 v209, v209, v97
  v_add_f32 v210, v210, v98
  v_add_f32 v211, v211, v99
  s_waitcnt lgkmcnt(10)
  v_add_f32 v212, v212, v100
  v_add_f32 v213, v213, v101
  v_add_f32 v214, v214, v102
  v_add_f32 v215, v215, v103
  s_waitcnt lgkmcnt(9)
  v_add_f32 v208, v208, v104
  v_add_f32 v209, v209, v105
  v_add_f32 v210, v210, v106
  v_add_f32 v211, v211, v107
  s_waitcnt lgkmcnt(8)
  v_add_f32 v212, v212, v108
  v_add_f32 v213, v213, v109
  v_add_f32 v214, v214, v110
  v_add_f32 v215, v215, v111
  s_waitcnt lgkmcnt(7)
  v_add_f32 v208, v208, v112
  v_add_f32 v209, v209, v113
  v_add_f32 v210, v210, v114
  v_add_f32 v211, v211, v115
  s_waitcnt lgkmcnt(6)
  v_add_f32 v212, v212, v116
  v_add_f32 v213, v213, v117
  v_add_f32 v214, v214, v118
  v_add_f32 v215, v215, v119
  s_waitcnt lgkmcnt(5)
  v_add_f32 v208, v208, v120
  v_add_f32 v209, v209, v121
  v_add_f32 v210, v210, v122
  v_add_f32 v211, v211, v123
  s_waitcnt lgkmcnt(4)
  v_add_f32 v212, v212, v124
  v_add_f32 v213, v213, v125
  v_add_f32 v214, v214, v126
  v_add_f32 v215, v215, v127
  s_waitcnt lgkmcnt(3)
  v_add_f32 v208, v208, v128
  v_add_f32 v209, v209, v129
  v_add_f32 v210, v210, v130
  v_add_f32 v211, v211, v131
  s_waitcnt lgkmcnt(2)
  v_add_f32 v212, v212, v132
  v_add_f32 v213, v213, v133
  v_add_f32 v214, v214, v134
  v_add_f32 v215, v215, v135
  s_waitcnt lgkmcnt(1)
  v_add_f32 v208, v208, v136
  v_add_f32 v209, v209, v137
  v_add_f32 v210, v210, v138
  v_add_f32 v211, v211, v139
  s_waitcnt lgkmcnt(0)
  v_add_f32 v212, v212, v140
  v_add_f32 v213, v213, v141
  v_add_f32 v214, v214, v142
  v_add_f32 v215, v215, v143
  v_cvt_pk_bf16_f32 v236, v208, v209
  v_cvt_pk_bf16_f32 v237, v210, v211
  v_cvt_pk_bf16_f32 v238, v212, v213
  v_cvt_pk_bf16_f32 v239, v214, v215
  buffer_store_dwordx4 v[236:239], v11, s[36:39], 0 offen
L_end:
  s_endpgm
L_fallback:
  s_waitcnt vmcnt(0) lgkmcnt(0)
  s_nop 15
  s_barrier
  s_mov_b32 s60, 1
  s_bfe_u32 s4, s2, 0x40003
  s_lshl_b32 s4, s4, 2
  s_add_u32 s4, s4, s23
  s_add_u32 s4, s4, 31
  s_and_b32 s4, s4, 31
  s_sub_u32 s5, s23, 1
  s_cmp_eq_u32 s23, 0
  s_cselect_b32 s5, 11, s5
  s_lshl_b32 s5, s5, 12
  s_add_u32 s5, s5, s22
  s_mul_i32 s54, s4, 6144
  s_add_u32 s57, s4, 31
  s_add_u32 s54, s54, s21
  s_and_b32 s57, s57, 31
  s_mul_i32 s57, s57, 6144
  s_add_u32 s57, s57, s21
  s_add_u32 s4, s4, 4
  s_and_b32 s4, s4, 31
  s_cmp_eq_u32 s23, 0
  s_cselect_b32 s54, 2130706432, s54
  s_cmp_lt_u32 s23, 2
  s_cselect_b32 s57, 2130706432, s57
  s_bitcmp1_b32 s54, 30
  s_cselect_b32 m0, 0x30000, s5
  s_nop 0
  buffer_load_dwordx4 v15, s[32:35], s54 offen offset:0 sc1 lds
  s_bitcmp1_b32 s54, 30
  s_cselect_b32 m0, 0x30000, s5
  s_nop 0
  buffer_load_dwordx4 v15, s[32:35], s54 offen offset:1024 sc1 lds
  s_bitcmp1_b32 s57, 30
  s_cselect_b32 m0, 0x30000, s5
  s_nop 0
  buffer_load_dwordx4 v15, s[32:35], s57 offen offset:2048 sc1 lds
  s_bitcmp1_b32 s57, 30
  s_cselect_b32 m0, 0x30000, s5
  s_nop 0
  buffer_load_dwordx4 v15, s[32:35], s57 offen offset:3072 sc1 lds
  s_add_u32 s5, s5, 16384
  s_sub_u32 s54, s5, 49152
  s_cmp_ge_i32 s54, s22
  s_cselect_b32 s5, s54, s5
  s_mul_i32 s54, s4, 6144
  s_add_u32 s57, s4, 31
  s_add_u32 s54, s54, s21
  s_and_b32 s57, s57, 31
  s_mul_i32 s57, s57, 6144
  s_add_u32 s57, s57, s21
  s_add_u32 s4, s4, 4
  s_and_b32 s4, s4, 31
  s_mov_b32 m0, s5
  s_nop 0
  buffer_load_dwordx4 v15, s[32:35], s54 offen offset:0 sc1 lds
  s_mov_b32 m0, s5
  s_nop 0
  buffer_load_dwordx4 v15, s[32:35], s54 offen offset:1024 sc1 lds
  s_mov_b32 m0, s5
  s_nop 0
  buffer_load_dwordx4 v15, s[32:35], s57 offen offset:2048 sc1 lds
  s_mov_b32 m0, s5
  s_nop 0
  buffer_load_dwordx4 v15, s[32:35], s57 offen offset:3072 sc1 lds
  s_add_u32 s5, s5, 16384
  s_sub_u32 s54, s5, 49152
  s_cmp_ge_i32 s54, s22
  s_cselect_b32 s5, s54, s5
  s_mul_i32 s54, s4, 6144
  s_add_u32 s57, s4, 31
  s_add_u32 s54, s54, s21
  s_and_b32 s57, s57, 31
  s_mul_i32 s57, s57, 6144
  s_add_u32 s57, s57, s21
  s_add_u32 s4, s4, 4
  s_and_b32 s4, s4, 31
  s_mov_b32 m0, s5
  s_nop 0
  buffer_load_dwordx4 v15, s[32:35], s54 offen offset:0 sc1 lds
  s_mov_b32 m0, s5
  s_nop 0
  buffer_load_dwordx4 v15, s[32:35], s54 offen offset:1024 sc1 lds
  s_mov_b32 m0, s5
  s_nop 0
  buffer_load_dwordx4 v15, s[32:35], s57 offen offset:2048 sc1 lds
  s_mov_b32 m0, s5
  s_nop 0
  buffer_load_dwordx4 v15, s[32:35], s57 offen offset:3072 sc1 lds
  s_add_u32 s5, s5, 16384
  s_sub_u32 s54, s5, 49152
  s_cmp_ge_i32 s54, s22
  s_cselect_b32 s5, s54, s5
  v_and_b32 v134, v134, v252
  v_and_b32 v135, v135, v252
  v_mov_b32 v10, 0xff800000
  s_mul_i32 s55, s52, 196608
  s_sub_u32 s54, s21, s55
  s_mov_b32 s55, 64
L_fbloop:
  buffer_load_dwordx4 v[136:139], v15, s[32:35], s54 offen sc1
  buffer_load_dwordx4 v[140:143], v15, s[32:35], s54 offen offset:1024 sc1
  s_waitcnt vmcnt(1)
  v_mfma_f32_32x32x16_bf16 v[80:95], v[136:139], v[128:131], 0
  s_waitcnt vmcnt(0)
  v_mfma_f32_32x32x16_bf16 v[80:95], v[140:143], v[132:135], v[80:95]
  s_nop 11
  v_max3_f32 v10, v10, v80, v81
  v_max3_f32 v10, v10, v82, v83
  v_max3_f32 v10, v10, v84, v85
  v_max3_f32 v10, v10, v86, v87
  v_max3_f32 v10, v10, v88, v89
  v_max3_f32 v10, v10, v90, v91
  v_max3_f32 v10, v10, v92, v93
  v_max3_f32 v10, v10, v94, v95
  s_add_u32 s54, s54, 6144
  s_sub_u32 s55, s55, 1
  s_cmp_lg_u32 s55, 0
  s_cbranch_scc1 L_fbloop
  v_mov_b32 v3, v10
  s_nop 1
  v_permlane32_swap_b32 v3, v10
  v_max_f32 v10, v10, v3
  v_sub_f32 v3, 0, v10
  v_and_b32 v4, 0xffff0000, v3
  v_sub_f32 v3, v3, v4
  v_and_b32 v8, 0xffff0000, v3
  v_sub_f32 v3, v3, v8
  v_lshrrev_b32 v4, 16, v4
  v_or_b32 v4, v4, v8
  v_lshrrev_b32 v3, 16, v3
  v_and_b32 v4, v4, v253
  v_and_b32 v3, v3, v253
  v_and_or_b32 v134, v134, v252, v4
  v_and_or_b32 v135, v135, v252, v3
  s_waitcnt vmcnt(0) lgkmcnt(0)
  s_nop 7
  s_branch L_plain
L_non0_spin:
  s_sub_u32 s58, s58, 1
  s_cmp_lt_i32 s58, 1
  s_cbranch_scc1 L_non0_ok
  s_sleep 16
  buffer_load_dwordx2 v[240:241], v247, s[44:47], 0 offen sc1
  s_waitcnt vmcnt(0)
  s_branch L_non0_chk
L_pa0_spin:
  s_sub_u32 s58, s58, 1
  s_cmp_lt_i32 s58, 1
  s_cbranch_scc1 L_pa0_ok
  s_sleep 16
  buffer_load_dwordx2 v[244:245], v14, s[32:35], 0 offen sc1
  s_waitcnt vmcnt(0)
  s_branch L_pa0_chk
L_non1_spin:
  s_sub_u32 s58, s58, 1
  s_cmp_lt_i32 s58, 1
  s_cbranch_scc1 L_non1_ok
  s_sleep 16
  buffer_load_dwordx2 v[240:241], v247, s[44:47], 0 offen sc1
  s_waitcnt vmcnt(0)
  s_branch L_non1_chk
L_pa1_spin:
  s_sub_u32 s58, s58, 1
  s_cmp_lt_i32 s58, 1
  s_cbranch_scc1 L_pa1_ok
  s_sleep 16
  buffer_load_dwordx2 v[244:245], v14, s[32:35], 0 offen sc1
  s_waitcnt vmcnt(0)
  s_branch L_pa1_chk
L_pb_spin:
  s_sub_u32 s58, s58, 1
  s_cmp_lt_i32 s58, 1
  s_cbranch_scc1 L_pb_ok
  s_sleep 16
  s_mov_b64 exec, 255
  buffer_load_dwordx2 v[244:245], v1, s[32:35], 0 offen sc1
  s_mov_b64 exec, -1
  s_waitcnt vmcnt(0)
  s_branch L_pb_chk
L_pc_spin:
  s_sub_u32 s58, s58, 1
  s_cmp_lt_i32 s58, 1
  s_cbranch_scc1 L_pc_ok
  s_sleep 16
  buffer_load_dwordx2 v[244:245], v1, s[32:35], 0 offen sc1
  s_waitcnt vmcnt(0)
  s_branch L_pc_chk
L_code_end:
  s_endpgm

.section .rodata,"a"
.p2align 6
.amdhsa_kernel parallel_sum__mha_block__glu_gated_geglu__prompt_kernel
  .amdhsa_next_free_vgpr 256
  .amdhsa_next_free_sgpr 102
  .amdhsa_accum_offset 256
  .amdhsa_group_segment_fixed_size 0
  .amdhsa_kernarg_size 80
  .amdhsa_user_sgpr_count 2
  .amdhsa_user_sgpr_kernarg_segment_ptr 1
  .amdhsa_system_sgpr_workgroup_id_x 1
.end_amdhsa_kernel
```
